```python
import torch

def _softmax(x, axis=-1):
    return torch.softmax(x, dim=axis)

def _gelu(x):
    return torch.nn.functional.gelu(x, approximate='tanh')

def _silu(x):
    return torch.nn.functional.silu(x)

def _sigmoid(x):
    return torch.sigmoid(x)

def _layernorm(x, axis=-1, eps=1e-05):
    m = x.mean(dim=axis, keepdim=True)
    v = x.var(dim=axis, keepdim=True, unbiased=False)
    return (x - m) / torch.sqrt(v + eps)

def _scatter_add(tgt, idx, src, axis=0):
    return tgt.clone().index_add_(axis, idx, src)

def _segment_sum(src, seg, n):
    out = torch.zeros((n,) + src.shape[1:], dtype=src.dtype)
    return out.index_add_(0, seg, src)

def _pad(x, pw):
    flat = tuple((v for pair in reversed(pw) for v in pair))
    return torch.nn.functional.pad(x, flat)
kernel_name = 'parallel_sum__memory_aug_recurrent_mem_tr__glu_gated_swiglu__prompt'

def setup_inputs():

    _w = lambda a: (lambda t: t.to(torch.bfloat16) if t.is_floating_point() else t)(torch.as_tensor(a))

    def _A_setup():
        B, S, Dm = (1, 2048, 1024)
        H, Dh = (32, 128)
        M, seg = (8, 32)
        seg = min(seg, S)
        S = S // seg * seg
        return {'x': _w((lambda *s: torch.randn(*s, dtype=torch.bfloat16) * 0.05)(B, S, Dm)), 'mem0': _w((lambda *s: torch.randn(*s, dtype=torch.bfloat16) * 0.2)(B, M, Dm)), 'Wq': _w((lambda *s: torch.randn(*s, dtype=torch.bfloat16) * 1.6)(Dm, H, Dh) * Dm ** (-0.5)), 'Wk': _w((lambda *s: torch.randn(*s, dtype=torch.bfloat16) * 1.6)(Dm, H, Dh) * Dm ** (-0.5)), 'Wv': _w((lambda *s: torch.randn(*s, dtype=torch.bfloat16) * 0.2)(Dm, H, Dh) * Dm ** (-0.5)), 'Wo': _w((lambda *s: torch.randn(*s, dtype=torch.bfloat16) * 0.2)(H, Dh, Dm) * (H * Dh) ** (-0.5)), 'seg_len': seg}
    _A_in = _A_setup()

    def _B_setup():
        B, S, D, F = (1, 2048, 1024, 3584)
        return {'x': _w((lambda *s: torch.randn(*s, dtype=torch.bfloat16) * 0.05)(B, S, D)), 'w1': _w((lambda *s: torch.randn(*s, dtype=torch.bfloat16) * 0.2)(D, F) * (2.0 / D) ** 0.5), 'w3': _w((lambda *s: torch.randn(*s, dtype=torch.bfloat16) * 0.2)(D, F) * (2.0 / D) ** 0.5), 'w2': _w((lambda *s: torch.randn(*s, dtype=torch.bfloat16) * 0.2)(F, D) * (2.0 / F) ** 0.5)}
    _B_in = _B_setup()
    return {'A_x': _A_in['x'], 'A_mem0': _A_in['mem0'], 'A_Wq': _A_in['Wq'], 'A_Wk': _A_in['Wk'], 'A_Wv': _A_in['Wv'], 'A_Wo': _A_in['Wo'], 'A_seg_len': _A_in['seg_len'], 'B_x': _B_in['x'], 'B_w1': _B_in['w1'], 'B_w3': _B_in['w3'], 'B_w2': _B_in['w2']}

def reference(A_x, A_mem0, A_Wq, A_Wk, A_Wv, A_Wo, A_seg_len, B_x, B_w1, B_w3, B_w2):

    def _A_ref(x, mem0, Wq, Wk, Wv, Wo, seg_len):
        B, S, Dm = x.shape
        H, Dh = (Wq.shape[1], Wq.shape[2])
        M = mem0.shape[1]
        scale = Dh ** (-0.5)
        n_seg = S // seg_len
        L = M + seg_len
        idx = torch.arange(L)
        mask = (idx[:, None] < M) | (idx[:, None] >= idx[None, :])
        mem = mem0
        outs = []
        for s in range(n_seg):
            xs = x[:, s * seg_len:(s + 1) * seg_len, :].clone()
            h = torch.concatenate([mem, xs], axis=1)
            q = torch.einsum('btd,dhe->bhte', h, Wq)
            k = torch.einsum('btd,dhe->bhte', h, Wk)
            v = torch.einsum('btd,dhe->bhte', h, Wv)
            scores = torch.einsum('bhqe,bhke->bhqk', q, k) * scale
            scores = torch.where(mask[None, None], scores, -1000000000.0)
            p = _softmax(scores, axis=-1)
            o = torch.einsum('bhqk,bhke->bhqe', p, v)
            o = torch.einsum('bhte,hed->btd', o, Wo)
            mem = o[:, :M, :].clone()
            outs.append(o[:, M:, :])
        return torch.concatenate(outs, axis=1)

    def _B_ref(x, w1, w3, w2):
        gate = torch.einsum('bsd,df->bsf', x, w1)
        up = torch.einsum('bsd,df->bsf', x, w3)
        h = _silu(gate) * up
        out = torch.einsum('bsf,fd->bsd', h, w2)
        return out
    x = A_x
    xn = _layernorm(x, axis=-1)
    return x + _A_ref(xn, A_mem0, A_Wq, A_Wk, A_Wv, A_Wo, A_seg_len) + _B_ref(xn, B_w1, B_w3, B_w2)
```

```asm
; @launch grid=(256,1,1) block=(256,1,1) lds=163840
.amdgcn_target "amdgcn-amd-amdhsa--gfx950"
.text
.globl parallel_sum__memory_aug_recurrent_mem_tr__glu_gated_swiglu__prompt_kernel
.p2align 8
.type parallel_sum__memory_aug_recurrent_mem_tr__glu_gated_swiglu__prompt_kernel,@function
parallel_sum__memory_aug_recurrent_mem_tr__glu_gated_swiglu__prompt_kernel:
    s_cmp_ge_u32 s2, 256
    s_cbranch_scc1 ub_exit
    s_load_dwordx4 s[4:7], s[0:1], 96
    s_getreg_b32 s94, hwreg(HW_REG_XCC_ID)
    s_and_b32 s94, s94, 7
    s_xor_b32 s94, s94, 2
    s_mov_b32 s95, 0x40000
    s_mov_b32 s100, 0
    v_lshrrev_b32 v9, 6, v0
    s_mov_b32 s60, 0
    v_readfirstlane_b32 s3, v9
    s_waitcnt lgkmcnt(0)
    s_mov_b32 s96, s4
    s_and_b32 s97, s5, 0xffff
    s_mov_b32 s98, 0x100
    s_mov_b32 s99, 0x20000
    s_mov_b32 s8, s6
    s_and_b32 s9, s7, 0xffff
    s_mov_b32 s10, 0x10000000
    s_mov_b32 s11, 0x20000
    s_cmp_lt_u32 s3, 2
    s_cbranch_scc1 ub_nowarm
    s_getpc_b64 s[24:25]
ub_pc0:
    s_sub_u32 s24, s24, ub_pc0-parallel_sum__memory_aug_recurrent_mem_tr__glu_gated_swiglu__prompt_kernel
    s_subb_u32 s25, s25, 0
    s_bfe_u32 s26, s2, 0x50003
    s_lshl_b32 s26, s26, 11
    s_sub_u32 s26, s26, 2048
    v_lshl_add_u32 v12, v0, 4, s26
    v_min_u32 v12, ub_table-parallel_sum__memory_aug_recurrent_mem_tr__glu_gated_swiglu__prompt_kernel, v12
    global_load_dwordx4 v[16:19], v12, s[24:25]
    s_waitcnt vmcnt(0)
    s_branch ub_n2
ub_nowarm:
    s_lshr_b32 s24, s94, 1
    s_cmp_lg_u32 s24, 2
    s_cbranch_scc1 ub_first
    s_cmp_lg_u32 s3, 1
    s_cbranch_scc1 ub_first
    s_lshr_b32 s16, s2, 3
    s_and_b32 s18, s94, 1
    s_lshl_b32 s18, s18, 5
    s_add_u32 s16, s16, s18
    s_lshl_b32 s16, s16, 7
    s_add_u32 s16, s16, 101056512
    s_add_u32 s17, s16, 0x2000
    s_mov_b64 exec, 1
    s_mov_b32 s70, -1
    s_mov_b32 s71, -1
    buffer_store_dword v0, off, s[8:11], s16 sc1
    buffer_store_dword v0, off, s[8:11], s17 sc1
    s_waitcnt vmcnt(0)
    s_memtime s[62:63]
    s_waitcnt lgkmcnt(0)
    buffer_load_dword v12, off, s[8:11], s16 sc1
    s_waitcnt vmcnt(0)
    s_memtime s[64:65]
    s_waitcnt lgkmcnt(0)
    s_sub_u32 s66, s64, s62
    s_min_u32 s70, s70, s66
    s_memtime s[62:63]
    s_waitcnt lgkmcnt(0)
    buffer_load_dword v12, off, s[8:11], s17 sc1
    s_waitcnt vmcnt(0)
    s_memtime s[64:65]
    s_waitcnt lgkmcnt(0)
    s_sub_u32 s66, s64, s62
    s_min_u32 s71, s71, s66
    buffer_store_dword v0, off, s[8:11], s16 sc1
    buffer_store_dword v0, off, s[8:11], s17 sc1
    s_waitcnt vmcnt(0)
    s_memtime s[62:63]
    s_waitcnt lgkmcnt(0)
    buffer_load_dword v12, off, s[8:11], s16 sc1
    s_waitcnt vmcnt(0)
    s_memtime s[64:65]
    s_waitcnt lgkmcnt(0)
    s_sub_u32 s66, s64, s62
    s_min_u32 s70, s70, s66
    s_memtime s[62:63]
    s_waitcnt lgkmcnt(0)
    buffer_load_dword v12, off, s[8:11], s17 sc1
    s_waitcnt vmcnt(0)
    s_memtime s[64:65]
    s_waitcnt lgkmcnt(0)
    s_sub_u32 s66, s64, s62
    s_min_u32 s71, s71, s66
    s_cmp_lt_u32 s71, s70
    s_cselect_b32 s60, 1, 0
    s_lshr_b32 s70, s94, 2
    s_xor_b32 s60, s60, s70
    s_add_u32 s60, s60, 0x10000
    v_mov_b32 v12, s60
    s_movk_i32 s16, 28
    buffer_atomic_add v12, off, s[96:99], s16
    s_mov_b64 exec, -1
ub_first:
    s_cmp_lg_u32 s3, 0
    s_cbranch_scc1 ub_n2
    s_and_b32 s24, s94, 3
    s_lshr_b32 s25, s94, 2
    s_lshl_b32 s25, s25, 5
    s_add_u32 s24, s24, s25
    s_lshl_b32 s24, s24, 2
    v_mov_b32 v10, 1
    s_mov_b64 exec, 1
    buffer_atomic_add v10, off, s[96:99], s24 sc0
    s_mov_b64 exec, -1
    s_waitcnt vmcnt(0)
    v_readfirstlane_b32 s25, v10
    s_bfe_u32 s24, s25, 0x10004
    s_lshl1_add_u32 s89, s94, s24
    s_cmp_ge_u32 s25, 32
    s_cbranch_scc1 ub_next
    s_sub_u32 s24, s89, 4
    s_lshl_b32 s24, s24, 5
    s_and_b32 s26, s25, 15
    s_or_b32 s24, s24, s26
    s_or_b32 s25, s25, 0x7fe0
    s_cmp_lt_u32 s94, 2
    s_cselect_b32 s24, s25, s24
    s_branch ub_got
ub_next:
    s_cmp_lg_u32 s3, 0
    s_cbranch_scc1 ub_n2
    s_bitcmp1_b32 s100, 0
    s_cbranch_scc1 lnok_1
    s_cmp_lt_u32 0, 2
    s_cselect_b32 s59, 192, 32
    s_lshl2_add_u32 s59, 0, s59
wait_2:
    buffer_load_dword v10, off, s[96:99], s59 sc1
    s_waitcnt vmcnt(0)
    v_readfirstlane_b32 s24, v10
    s_cmp_ge_u32 s24, 32
    s_cbranch_scc1 waitok_3
    s_sleep 8
    s_sub_u32 s95, s95, 1
    s_cbranch_scc0 wait_2
    s_mov_b32 s95, 0
waitok_3:
    s_bitset1_b32 s100, 0
lnok_1:
    s_cmp_eq_u32 s89, 17
    s_cbranch_scc1 ub_tail
    s_lshl_b32 s24, s89, 7
    s_add_u32 s24, s24, 105930752
    v_mov_b32 v10, 1
    s_mov_b64 exec, 1
    buffer_atomic_add v10, off, s[8:11], s24 sc0
    s_mov_b64 exec, -1
    s_waitcnt vmcnt(0)
    v_readfirstlane_b32 s25, v10
    s_lshr_b32 s26, s25, 4
    s_and_b32 s25, s25, 15
    s_min_u32 s26, s26, 127
    s_lshl_b32 s26, s26, 2
    s_lshl_b32 s24, s89, 9
    s_add_u32 s26, s26, s24
    s_add_u32 s26, s26, 105922560
    s_cmp_lg_u32 s25, 0
    s_cbranch_scc1 ub_n1
    s_mov_b32 s24, 105932800
    v_mov_b32 v10, 1
    s_mov_b64 exec, 1
    buffer_atomic_add v10, off, s[8:11], s24 sc0
    s_waitcnt vmcnt(0)
    v_add_u32 v10, 29, v10
    buffer_store_dword v10, off, s[8:11], s26 sc1
    s_mov_b64 exec, -1
    v_readfirstlane_b32 s24, v10
    s_branch ub_n3
ub_n1:
wait_4:
    buffer_load_dword v10, off, s[8:11], s26 sc1
    s_waitcnt vmcnt(0)
    v_readfirstlane_b32 s24, v10
    s_cmp_ge_u32 s24, 1
    s_cbranch_scc1 waitok_5
    s_sleep 2
    s_sub_u32 s95, s95, 1
    s_cbranch_scc0 wait_4
    s_mov_b32 s95, 0
waitok_5:
ub_n3:
    s_sub_u32 s24, s24, 1
    s_cmp_lt_u32 s24, 102
    s_cbranch_scc1 ub_n4
    s_mov_b32 s89, 17
ub_tail:
    s_mov_b32 s24, 105932928
    v_mov_b32 v10, 1
    s_mov_b64 exec, 1
    buffer_atomic_add v10, off, s[8:11], s24 sc0
    s_mov_b64 exec, -1
    s_waitcnt vmcnt(0)
    v_readfirstlane_b32 s25, v10
    s_lshr_b32 s24, s25, 4
    s_add_u32 s24, s24, 102
    s_and_b32 s25, s25, 15
ub_n4:
    s_min_u32 s24, s24, 0x3fe
    s_lshl_b32 s24, s24, 5
    s_or_b32 s24, s24, s25
ub_got:
    v_mov_b32 v10, s24
    v_mov_b32 v11, 163776
    ds_write_b32 v11, v10
    s_waitcnt lgkmcnt(0)
ub_n2:
    s_barrier
    v_mov_b32 v11, 163776
    ds_read_b32 v10, v11
    s_waitcnt lgkmcnt(0)
    v_readfirstlane_b32 s5, v10
    s_barrier
    s_lshr_b32 s4, s5, 5
    s_and_b32 s5, s5, 31
    s_cmp_eq_u32 s4, 0x3ff
    s_cbranch_scc1 ub_rec
    s_cmp_ge_u32 s4, 112
    s_cbranch_scc1 ub_done
ub_item:
    s_and_b32 s5, s5, 15
    s_getpc_b64 s[24:25]
ub_pc:
    s_add_u32 s24, s24, ub_table-ub_pc
    s_addc_u32 s25, s25, 0
    s_lshl_b32 s26, s4, 2
    s_load_dword s50, s[24:25], s26
    s_load_dwordx4 s[28:31], s[0:1], 16
    s_load_dwordx4 s[32:35], s[0:1], 32
    s_load_dwordx4 s[36:39], s[0:1], 64
    s_load_dwordx4 s[52:55], s[0:1], 80
    s_load_dwordx2 s[56:57], s[0:1], 0
    s_waitcnt lgkmcnt(0)
    s_lshr_b32 s101, s50, 16
    s_bfe_u32 s51, s50, 0x80008
    s_and_b32 s5, s5, 15
    s_and_b32 s24, s50, 16
    s_or_b32 s5, s5, s24
    s_and_b32 s50, s50, 15
    s_cmp_eq_u32 s50, 8
    s_cbranch_scc0 ub_notln
ub_ln:
    s_lshl_b32 s2, s51, 5
    s_add_u32 s2, s2, s5
    s_mov_b32 s61, s3
    s_mov_b32 s62, s5
    s_load_dwordx2 s[4:5], s[0:1], 0
    s_load_dwordx2 s[6:7], s[0:1], 104
    s_load_dwordx2 s[20:21], s[0:1], 8
    v_and_b32 v1, 7, v0
    v_bfe_u32 v2, v0, 3, 3
    s_lshl_b32 s3, s61, 5
    v_add_u32 v2, s3, v2
    s_lshl_b32 s3, s2, 3
    v_add_u32 v5, s3, v1
    v_lshlrev_b32 v3, 11, v5
    v_lshl_add_u32 v3, v2, 4, v3
    v_lshrrev_b32 v4, 5, v5
    v_lshlrev_b32 v4, 16, v4
    v_lshl_add_u32 v4, v2, 9, v4
    v_and_b32 v5, 31, v5
    v_lshl_add_u32 v4, v5, 4, v4
    v_lshlrev_b32 v1, 4, v1
    v_add_u32 v1, 0, v1
    s_lshl_b32 s3, s61, 2
    v_add_u32 v2, s3, v1
    s_waitcnt lgkmcnt(0)
    s_mov_b32 s8, s4
    s_and_b32 s9, s5, 0xffff
    s_mov_b32 s10, 0x400000
    s_mov_b32 s11, 0x20000
    s_mov_b32 s12, s6
    s_and_b32 s13, s7, 0xffff
    s_mov_b32 s14, 0x10000000
    s_mov_b32 s15, 0x20000
    buffer_load_dwordx4 v[8:11], v3, s[8:11], 0 offen offset:0
    buffer_load_dwordx4 v[12:15], v3, s[8:11], 0 offen offset:128
    buffer_load_dwordx4 v[16:19], v3, s[8:11], 0 offen offset:256
    buffer_load_dwordx4 v[20:23], v3, s[8:11], 0 offen offset:384
    s_waitcnt vmcnt(0)
    v_lshlrev_b32 v24, 16, v8
    v_and_b32 v25, 0xffff0000, v8
    v_lshlrev_b32 v26, 16, v9
    v_and_b32 v27, 0xffff0000, v9
    v_lshlrev_b32 v28, 16, v10
    v_and_b32 v29, 0xffff0000, v10
    v_lshlrev_b32 v30, 16, v11
    v_and_b32 v31, 0xffff0000, v11
    v_lshlrev_b32 v32, 16, v12
    v_and_b32 v33, 0xffff0000, v12
    v_lshlrev_b32 v34, 16, v13
    v_and_b32 v35, 0xffff0000, v13
    v_lshlrev_b32 v36, 16, v14
    v_and_b32 v37, 0xffff0000, v14
    v_lshlrev_b32 v38, 16, v15
    v_and_b32 v39, 0xffff0000, v15
    v_lshlrev_b32 v40, 16, v16
    v_and_b32 v41, 0xffff0000, v16
    v_lshlrev_b32 v42, 16, v17
    v_and_b32 v43, 0xffff0000, v17
    v_lshlrev_b32 v44, 16, v18
    v_and_b32 v45, 0xffff0000, v18
    v_lshlrev_b32 v46, 16, v19
    v_and_b32 v47, 0xffff0000, v19
    v_lshlrev_b32 v48, 16, v20
    v_and_b32 v49, 0xffff0000, v20
    v_lshlrev_b32 v50, 16, v21
    v_and_b32 v51, 0xffff0000, v21
    v_lshlrev_b32 v52, 16, v22
    v_and_b32 v53, 0xffff0000, v22
    v_lshlrev_b32 v54, 16, v23
    v_and_b32 v55, 0xffff0000, v23
    v_pk_add_f32 v[6:7], v[24:25], v[26:27]
    v_pk_add_f32 v[6:7], v[6:7], v[28:29]
    v_pk_add_f32 v[6:7], v[6:7], v[30:31]
    v_pk_add_f32 v[6:7], v[6:7], v[32:33]
    v_pk_add_f32 v[6:7], v[6:7], v[34:35]
    v_pk_add_f32 v[6:7], v[6:7], v[36:37]
    v_pk_add_f32 v[6:7], v[6:7], v[38:39]
    v_pk_add_f32 v[6:7], v[6:7], v[40:41]
    v_pk_add_f32 v[6:7], v[6:7], v[42:43]
    v_pk_add_f32 v[6:7], v[6:7], v[44:45]
    v_pk_add_f32 v[6:7], v[6:7], v[46:47]
    v_pk_add_f32 v[6:7], v[6:7], v[48:49]
    v_pk_add_f32 v[6:7], v[6:7], v[50:51]
    v_pk_add_f32 v[6:7], v[6:7], v[52:53]
    v_pk_add_f32 v[6:7], v[6:7], v[54:55]
    v_add_f32 v6, v6, v7
    s_nop 1
    v_add_f32_dpp v6, v6, v6 row_ror:8 row_mask:0xf bank_mask:0xf
    v_mov_b32 v7, v6
    s_nop 1
    v_permlane16_swap_b32 v7, v6
    v_add_f32 v6, v6, v7
    v_mov_b32 v7, v6
    s_nop 1
    v_permlane32_swap_b32 v7, v6
    v_add_f32 v6, v6, v7
    ds_write_b32 v2, v6 offset:0
    s_waitcnt lgkmcnt(0)
    s_barrier
    ds_read_b128 v[60:63], v1 offset:0
    s_waitcnt lgkmcnt(0)
    v_add_f32 v60, v60, v61
    v_add_f32 v62, v62, v63
    v_add_f32 v6, v60, v62
    v_mul_f32 v6, 0x3a800000, v6
    v_mov_b32 v56, 0
    v_mov_b32 v57, 0
    v_sub_f32 v58, v24, v6
    v_fmac_f32 v56, v58, v58
    v_sub_f32 v58, v25, v6
    v_fmac_f32 v57, v58, v58
    v_sub_f32 v58, v26, v6
    v_fmac_f32 v56, v58, v58
    v_sub_f32 v58, v27, v6
    v_fmac_f32 v57, v58, v58
    v_sub_f32 v58, v28, v6
    v_fmac_f32 v56, v58, v58
    v_sub_f32 v58, v29, v6
    v_fmac_f32 v57, v58, v58
    v_sub_f32 v58, v30, v6
    v_fmac_f32 v56, v58, v58
    v_sub_f32 v58, v31, v6
    v_fmac_f32 v57, v58, v58
    v_sub_f32 v58, v32, v6
    v_fmac_f32 v56, v58, v58
    v_sub_f32 v58, v33, v6
    v_fmac_f32 v57, v58, v58
    v_sub_f32 v58, v34, v6
    v_fmac_f32 v56, v58, v58
    v_sub_f32 v58, v35, v6
    v_fmac_f32 v57, v58, v58
    v_sub_f32 v58, v36, v6
    v_fmac_f32 v56, v58, v58
    v_sub_f32 v58, v37, v6
    v_fmac_f32 v57, v58, v58
    v_sub_f32 v58, v38, v6
    v_fmac_f32 v56, v58, v58
    v_sub_f32 v58, v39, v6
    v_fmac_f32 v57, v58, v58
    v_sub_f32 v58, v40, v6
    v_fmac_f32 v56, v58, v58
    v_sub_f32 v58, v41, v6
    v_fmac_f32 v57, v58, v58
    v_sub_f32 v58, v42, v6
    v_fmac_f32 v56, v58, v58
    v_sub_f32 v58, v43, v6
    v_fmac_f32 v57, v58, v58
    v_sub_f32 v58, v44, v6
    v_fmac_f32 v56, v58, v58
    v_sub_f32 v58, v45, v6
    v_fmac_f32 v57, v58, v58
    v_sub_f32 v58, v46, v6
    v_fmac_f32 v56, v58, v58
    v_sub_f32 v58, v47, v6
    v_fmac_f32 v57, v58, v58
    v_sub_f32 v58, v48, v6
    v_fmac_f32 v56, v58, v58
    v_sub_f32 v58, v49, v6
    v_fmac_f32 v57, v58, v58
    v_sub_f32 v58, v50, v6
    v_fmac_f32 v56, v58, v58
    v_sub_f32 v58, v51, v6
    v_fmac_f32 v57, v58, v58
    v_sub_f32 v58, v52, v6
    v_fmac_f32 v56, v58, v58
    v_sub_f32 v58, v53, v6
    v_fmac_f32 v57, v58, v58
    v_sub_f32 v58, v54, v6
    v_fmac_f32 v56, v58, v58
    v_sub_f32 v58, v55, v6
    v_fmac_f32 v57, v58, v58
    v_add_f32 v56, v56, v57
    s_nop 1
    v_add_f32_dpp v56, v56, v56 row_ror:8 row_mask:0xf bank_mask:0xf
    v_mov_b32 v57, v56
    s_nop 1
    v_permlane16_swap_b32 v57, v56
    v_add_f32 v56, v56, v57
    v_mov_b32 v57, v56
    s_nop 1
    v_permlane32_swap_b32 v57, v56
    v_add_f32 v56, v56, v57
    ds_write_b32 v2, v56 offset:128
    s_waitcnt lgkmcnt(0)
    s_barrier
    ds_read_b128 v[60:63], v1 offset:128
    s_waitcnt lgkmcnt(0)
    v_add_f32 v60, v60, v61
    v_add_f32 v62, v62, v63
    v_add_f32 v56, v60, v62
    v_mul_f32 v56, 0x3a800000, v56
    v_cvt_pk_bf16_f32 v56, v56, v56
    v_lshlrev_b32 v56, 16, v56
    v_add_f32 v56, 0x3727c5ac, v56
    v_cvt_pk_bf16_f32 v56, v56, v56
    v_lshlrev_b32 v56, 16, v56
    v_sqrt_f32 v56, v56
    s_nop 0
    v_cvt_pk_bf16_f32 v56, v56, v56
    v_lshlrev_b32 v56, 16, v56
    v_rcp_f32 v56, v56
    v_cvt_pk_bf16_f32 v6, v6, v6
    v_lshlrev_b32 v6, 16, v6
    v_sub_f32 v24, v24, v6
    v_sub_f32 v25, v25, v6
    v_cvt_pk_bf16_f32 v58, v24, v25
    v_lshlrev_b32 v24, 16, v58
    v_and_b32 v25, 0xffff0000, v58
    v_mul_f32 v24, v24, v56
    v_mul_f32 v25, v25, v56
    v_cvt_pk_bf16_f32 v8, v24, v25
    v_sub_f32 v26, v26, v6
    v_sub_f32 v27, v27, v6
    v_cvt_pk_bf16_f32 v58, v26, v27
    v_lshlrev_b32 v26, 16, v58
    v_and_b32 v27, 0xffff0000, v58
    v_mul_f32 v26, v26, v56
    v_mul_f32 v27, v27, v56
    v_cvt_pk_bf16_f32 v9, v26, v27
    v_sub_f32 v28, v28, v6
    v_sub_f32 v29, v29, v6
    v_cvt_pk_bf16_f32 v58, v28, v29
    v_lshlrev_b32 v28, 16, v58
    v_and_b32 v29, 0xffff0000, v58
    v_mul_f32 v28, v28, v56
    v_mul_f32 v29, v29, v56
    v_cvt_pk_bf16_f32 v10, v28, v29
    v_sub_f32 v30, v30, v6
    v_sub_f32 v31, v31, v6
    v_cvt_pk_bf16_f32 v58, v30, v31
    v_lshlrev_b32 v30, 16, v58
    v_and_b32 v31, 0xffff0000, v58
    v_mul_f32 v30, v30, v56
    v_mul_f32 v31, v31, v56
    v_cvt_pk_bf16_f32 v11, v30, v31
    s_mov_b32 s16, 0x0
    buffer_store_dwordx4 v[8:11], v4, s[12:15], s16 offen sc1
    v_sub_f32 v32, v32, v6
    v_sub_f32 v33, v33, v6
    v_cvt_pk_bf16_f32 v58, v32, v33
    v_lshlrev_b32 v32, 16, v58
    v_and_b32 v33, 0xffff0000, v58
    v_mul_f32 v32, v32, v56
    v_mul_f32 v33, v33, v56
    v_cvt_pk_bf16_f32 v12, v32, v33
    v_sub_f32 v34, v34, v6
    v_sub_f32 v35, v35, v6
    v_cvt_pk_bf16_f32 v58, v34, v35
    v_lshlrev_b32 v34, 16, v58
    v_and_b32 v35, 0xffff0000, v58
    v_mul_f32 v34, v34, v56
    v_mul_f32 v35, v35, v56
    v_cvt_pk_bf16_f32 v13, v34, v35
    v_sub_f32 v36, v36, v6
    v_sub_f32 v37, v37, v6
    v_cvt_pk_bf16_f32 v58, v36, v37
    v_lshlrev_b32 v36, 16, v58
    v_and_b32 v37, 0xffff0000, v58
    v_mul_f32 v36, v36, v56
    v_mul_f32 v37, v37, v56
    v_cvt_pk_bf16_f32 v14, v36, v37
    v_sub_f32 v38, v38, v6
    v_sub_f32 v39, v39, v6
    v_cvt_pk_bf16_f32 v58, v38, v39
    v_lshlrev_b32 v38, 16, v58
    v_and_b32 v39, 0xffff0000, v58
    v_mul_f32 v38, v38, v56
    v_mul_f32 v39, v39, v56
    v_cvt_pk_bf16_f32 v15, v38, v39
    s_mov_b32 s16, 0x1000
    buffer_store_dwordx4 v[12:15], v4, s[12:15], s16 offen sc1
    v_sub_f32 v40, v40, v6
    v_sub_f32 v41, v41, v6
    v_cvt_pk_bf16_f32 v58, v40, v41
    v_lshlrev_b32 v40, 16, v58
    v_and_b32 v41, 0xffff0000, v58
    v_mul_f32 v40, v40, v56
    v_mul_f32 v41, v41, v56
    v_cvt_pk_bf16_f32 v16, v40, v41
    v_sub_f32 v42, v42, v6
    v_sub_f32 v43, v43, v6
    v_cvt_pk_bf16_f32 v58, v42, v43
    v_lshlrev_b32 v42, 16, v58
    v_and_b32 v43, 0xffff0000, v58
    v_mul_f32 v42, v42, v56
    v_mul_f32 v43, v43, v56
    v_cvt_pk_bf16_f32 v17, v42, v43
    v_sub_f32 v44, v44, v6
    v_sub_f32 v45, v45, v6
    v_cvt_pk_bf16_f32 v58, v44, v45
    v_lshlrev_b32 v44, 16, v58
    v_and_b32 v45, 0xffff0000, v58
    v_mul_f32 v44, v44, v56
    v_mul_f32 v45, v45, v56
    v_cvt_pk_bf16_f32 v18, v44, v45
    v_sub_f32 v46, v46, v6
    v_sub_f32 v47, v47, v6
    v_cvt_pk_bf16_f32 v58, v46, v47
    v_lshlrev_b32 v46, 16, v58
    v_and_b32 v47, 0xffff0000, v58
    v_mul_f32 v46, v46, v56
    v_mul_f32 v47, v47, v56
    v_cvt_pk_bf16_f32 v19, v46, v47
    s_mov_b32 s16, 0x2000
    buffer_store_dwordx4 v[16:19], v4, s[12:15], s16 offen sc1
    v_sub_f32 v48, v48, v6
    v_sub_f32 v49, v49, v6
    v_cvt_pk_bf16_f32 v58, v48, v49
    v_lshlrev_b32 v48, 16, v58
    v_and_b32 v49, 0xffff0000, v58
    v_mul_f32 v48, v48, v56
    v_mul_f32 v49, v49, v56
    v_cvt_pk_bf16_f32 v20, v48, v49
    v_sub_f32 v50, v50, v6
    v_sub_f32 v51, v51, v6
    v_cvt_pk_bf16_f32 v58, v50, v51
    v_lshlrev_b32 v50, 16, v58
    v_and_b32 v51, 0xffff0000, v58
    v_mul_f32 v50, v50, v56
    v_mul_f32 v51, v51, v56
    v_cvt_pk_bf16_f32 v21, v50, v51
    v_sub_f32 v52, v52, v6
    v_sub_f32 v53, v53, v6
    v_cvt_pk_bf16_f32 v58, v52, v53
    v_lshlrev_b32 v52, 16, v58
    v_and_b32 v53, 0xffff0000, v58
    v_mul_f32 v52, v52, v56
    v_mul_f32 v53, v53, v56
    v_cvt_pk_bf16_f32 v22, v52, v53
    v_sub_f32 v54, v54, v6
    v_sub_f32 v55, v55, v6
    v_cvt_pk_bf16_f32 v58, v54, v55
    v_lshlrev_b32 v54, 16, v58
    v_and_b32 v55, 0xffff0000, v58
    v_mul_f32 v54, v54, v56
    v_mul_f32 v55, v55, v56
    v_cvt_pk_bf16_f32 v23, v54, v55
    s_mov_b32 s16, 0x3000
    buffer_store_dwordx4 v[20:23], v4, s[12:15], s16 offen sc1
    s_cmp_ge_u32 s2, 14
    s_cbranch_scc1 ln_noflag
    s_lshl_b32 s22, s2, 12
    v_lshl_add_u32 v56, v0, 4, s22
    v_mov_b32 v64, 0
    v_mov_b32 v65, 0
    v_mov_b32 v66, 0
    v_mov_b32 v67, 0
    s_mov_b32 s22, 0x6500000
    buffer_store_dwordx4 v[64:67], v56, s[12:15], s22 offen sc1
ln_noflag:
    s_cmp_lt_u32 s2, 192
    s_cbranch_scc1 ln_noseed
    s_sub_u32 s23, s2, 192
    s_lshl_b32 s22, s23, 12
    v_lshl_add_u32 v56, v0, 4, s22
    v_mov_b32 v64, -1
    v_mov_b32 v65, -1
    v_mov_b32 v66, -1
    v_mov_b32 v67, -1
    s_mov_b32 s22, 0x7780000
    buffer_store_dwordx4 v[64:67], v56, s[12:15], s22 offen sc1
    s_mov_b32 s22, 0x77c0000
    buffer_store_dwordx4 v[64:67], v56, s[12:15], s22 offen sc1
    s_mov_b32 s22, 0x8080000
    buffer_store_dwordx4 v[64:67], v56, s[12:15], s22 offen sc1
    s_mov_b32 s22, 0x80c0000
    buffer_store_dwordx4 v[64:67], v56, s[12:15], s22 offen sc1
    s_mov_b32 s16, s12
    s_mov_b32 s17, s13
    s_mov_b32 s18, 0x6150000
    s_mov_b32 s19, 0x20000
    s_lshl_b32 s22, s23, 12
    v_lshl_add_u32 v56, v0, 4, s22
    v_mov_b32 v60, -1
    v_mov_b32 v61, -1
    v_mov_b32 v62, -1
    v_mov_b32 v63, -1
    s_mov_b32 s22, 0x6020000
    buffer_store_dwordx4 v[60:63], v56, s[16:19], s22 offen sc1
    s_mov_b32 s22, 0x6060000
    buffer_store_dwordx4 v[60:63], v56, s[16:19], s22 offen sc1
    s_mov_b32 s22, 0x60a0000
    buffer_store_dwordx4 v[60:63], v56, s[16:19], s22 offen sc1
    s_mov_b32 s22, 0x60e0000
    buffer_store_dwordx4 v[60:63], v56, s[16:19], s22 offen sc1
    s_mov_b32 s22, 0x6120000
    buffer_store_dwordx4 v[60:63], v56, s[16:19], s22 offen sc1
    s_cmp_ge_u32 s23, 16
    s_cbranch_scc1 ln_noseed
    s_mov_b32 s24, s20
    s_and_b32 s25, s21, 0xffff
    s_mov_b32 s26, 0x4000
    s_mov_b32 s27, 0x20000
    v_lshrrev_b32 v57, 4, v56
    v_bfe_u32 v58, v57, 6, 5
    v_lshlrev_b32 v58, 5, v58
    v_bfe_u32 v59, v57, 2, 2
    v_lshl_add_u32 v58, v59, 3, v58
    v_bfe_u32 v59, v57, 4, 1
    v_lshl_add_u32 v58, v59, 2, v58
    v_and_b32 v59, 3, v57
    v_add_u32 v58, v58, v59
    v_lshlrev_b32 v58, 1, v58
    v_and_b32 v59, 0x820, v57
    v_lshl_add_u32 v58, v59, 12, v58
    s_movk_i32 s22, 0
    buffer_load_ushort v64, v58, s[24:27], s22 offen
    s_movk_i32 s22, 2048
    buffer_load_ushort v65, v58, s[24:27], s22 offen
    s_movk_i32 s22, 4096
    buffer_load_ushort v66, v58, s[24:27], s22 offen
    s_movk_i32 s22, 6144
    buffer_load_ushort v67, v58, s[24:27], s22 offen
    s_movk_i32 s22, 8192
    buffer_load_ushort v68, v58, s[24:27], s22 offen
    s_movk_i32 s22, 10240
    buffer_load_ushort v69, v58, s[24:27], s22 offen
    s_movk_i32 s22, 12288
    buffer_load_ushort v70, v58, s[24:27], s22 offen
    s_movk_i32 s22, 14336
    buffer_load_ushort v71, v58, s[24:27], s22 offen
    s_waitcnt vmcnt(0)
    v_lshl_or_b32 v60, v65, 16, v64
    v_lshl_or_b32 v61, v67, 16, v66
    v_lshl_or_b32 v62, v69, 16, v68
    v_lshl_or_b32 v63, v71, 16, v70
    v_lshrrev_b32 v58, 13, v56
    v_lshlrev_b32 v58, 14, v58
    v_and_b32 v59, 0x1fff, v56
    v_add_u32 v58, v58, v59
    s_mov_b32 s22, 0x6000000
    buffer_store_dwordx4 v[60:63], v58, s[16:19], s22 offen sc1
    s_mov_b32 s22, 0x6002000
    buffer_store_dwordx4 v[60:63], v58, s[16:19], s22 offen sc1
ln_noseed:
    s_mov_b32 s3, s61
    s_mov_b32 s5, s62
    s_mov_b32 s4, s101
    s_mov_b32 s8, s12
    s_mov_b32 s9, s13
    s_mov_b32 s10, s14
    s_mov_b32 s11, s15
    s_cmp_lt_u32 s51, 2
    s_cselect_b32 s58, 192, 32
    s_lshl2_add_u32 s58, s51, s58
    s_waitcnt vmcnt(0)
    s_barrier
    s_cmp_lg_u32 s3, 0
    s_cbranch_scc1 ub_item
    v_mov_b32 v10, 1
    s_mov_b64 exec, 1
    buffer_atomic_add v10, off, s[96:99], s58
    s_mov_b64 exec, -1
    s_branch ub_item
ub_notln:
    s_bitcmp1_b32 s100, 0
    s_cbranch_scc1 lnok_6
    s_cmp_lt_u32 0, 2
    s_cselect_b32 s59, 192, 32
    s_lshl2_add_u32 s59, 0, s59
wait_7:
    buffer_load_dword v10, off, s[96:99], s59 sc1
    s_waitcnt vmcnt(0)
    v_readfirstlane_b32 s24, v10
    s_cmp_ge_u32 s24, 32
    s_cbranch_scc1 waitok_8
    s_sleep 8
    s_sub_u32 s95, s95, 1
    s_cbranch_scc0 wait_7
    s_mov_b32 s95, 0
waitok_8:
    s_bitset1_b32 s100, 0
lnok_6:
    s_cmp_ge_u32 s50, 3
    s_cbranch_scc1 ub_late
    s_cmp_eq_u32 s50, 2
    s_cbranch_scc1 ub_ffn
    s_cmp_eq_u32 s50, 0
    s_cbranch_scc0 ub_q
    s_mov_b32 s40, s51
    s_add_u32 s41, s5, 16
    s_lshl_b32 s58, s40, 7
    s_add_u32 s58, s58, 105907200
    s_branch ub_qkv
ub_q:
    s_lshl_b32 s40, s51, 1
    s_lshr_b32 s24, s5, 4
    s_add_u32 s40, s40, s24
    s_and_b32 s41, s5, 15
    s_lshl_b32 s58, s40, 7
    s_add_u32 s58, s58, 105908224
ub_qkv:
    s_bitcmp1_b32 s100, s40
    s_cbranch_scc1 lnok_9
    s_cmp_lt_u32 s40, 2
    s_cselect_b32 s59, 192, 32
    s_lshl2_add_u32 s59, s40, s59
wait_10:
    buffer_load_dword v10, off, s[96:99], s59 sc1
    s_waitcnt vmcnt(0)
    v_readfirstlane_b32 s24, v10
    s_cmp_ge_u32 s24, 32
    s_cbranch_scc1 waitok_11
    s_sleep 8
    s_sub_u32 s95, s95, 1
    s_cbranch_scc0 wait_10
    s_mov_b32 s95, 0
waitok_11:
    s_bitset1_b32 s100, s40
lnok_9:
    s_lshl_b32 s16, s40, 3
    s_lshl_b32 s24, s3, 1
    s_add_u32 s16, s16, s24
    s_lshl_b32 s16, s16, 16
    s_add_u32 s16, s16, 0
    s_add_u32 s17, s16, 0x10000 - 2048
    s_lshr_b32 s42, s41, 4
    s_and_b32 s43, s41, 15
    s_cmp_eq_u32 s42, 0
    s_cselect_b32 s12, s28, s30
    s_cselect_b32 s13, s29, s31
    s_cmp_eq_u32 s42, 2
    s_cselect_b32 s12, s32, s12
    s_cselect_b32 s13, s33, s13
    s_and_b32 s13, s13, 0xffff
    s_mov_b32 s14, 0x800000
    s_mov_b32 s15, 0x20000
    s_mov_b32 s44, 8192
    s_and_b32 s24, s3, 1
    s_lshl_b32 s18, s24, 17
    s_lshl_b32 s24, s43, 9
    s_add_u32 s18, s18, s24
    s_lshr_b32 s24, s3, 1
    s_lshl_b32 s24, s24, 8
    s_add_u32 s18, s18, s24
    s_mov_b32 s20, 0x40000
    v_and_b32 v9, 63, v0
    v_lshlrev_b32 v1, 4, v9
    v_lshrrev_b32 v10, 4, v9
    v_bfe_u32 v11, v9, 2, 2
    v_xor_b32 v11, v11, v10
    v_lshlrev_b32 v11, 6, v11
    v_and_b32 v12, 3, v9
    v_lshl_add_u32 v11, v12, 4, v11
    v_mul_lo_u32 v10, v10, s44
    v_add_u32 v2, v10, v11
    s_lshl_b32 s24, s44, 2
    s_sub_u32 s24, s24, 1024
    v_add_u32 v3, s24, v2
    v_add_u32 v4, s24, v3
    v_add_u32 v5, s24, v4
    s_lshr_b32 s24, s3, 1
    s_lshl_b32 s24, s24, 13
    v_add_u32 v6, s24, v1
    v_add_u32 v7, 0x10000, v6
    v_lshrrev_b32 v10, 5, v9
    v_lshlrev_b32 v10, 3, v10
    v_bfe_u32 v11, v9, 2, 2
    v_add_u32 v10, v10, v11
    v_lshlrev_b32 v10, 8, v10
    v_bfe_u32 v12, v9, 4, 1
    v_lshl_add_u32 v10, v12, 5, v10
    v_and_b32 v12, 3, v9
    v_lshl_add_u32 v10, v12, 3, v10
    v_add_u32 v10, 0x4000, v10
    s_and_b32 s24, s3, 1
    s_lshl_b32 s24, s24, 1
    v_xor_b32 v12, s24, v11
    v_lshl_add_u32 v48, v12, 6, v10
    v_add_u32 v50, 0x10000, v48
    v_xor_b32 v12, s24, v11
    v_xor_b32 v12, 1, v12
    v_lshl_add_u32 v49, v12, 6, v10
    v_add_u32 v51, 0x10000, v49
    s_lshl_b32 s22, s3, 12
    s_lshl_b32 s45, s42, 24
    s_add_u32 s45, s45, 4194304
    s_lshl_b32 s24, s40, 21
    s_add_u32 s45, s45, s24
    s_lshr_b32 s24, s3, 1
    s_lshl_b32 s24, s24, 20
    s_add_u32 s45, s45, s24
    s_lshl_b32 s24, s43, 14
    s_add_u32 s45, s45, s24
    s_and_b32 s24, s3, 1
    s_lshl_b32 s24, s24, 12
    s_add_u32 s45, s45, s24
    s_cmp_eq_u32 s42, 2
    s_cbranch_scc1 ub_v
ub_wa:
    s_add_u32 m0, s22, 0
    s_nop 0
    buffer_load_dwordx4 v1, s[8:11], s16 offen offset:0 sc1 lds
    buffer_load_dwordx4 v1, s[8:11], s16 offen offset:1024 sc1 lds
    buffer_load_dwordx4 v1, s[8:11], s17 offen offset:2048 sc1 lds
    buffer_load_dwordx4 v1, s[8:11], s17 offen offset:3072 sc1 lds
    s_add_u32 m0, s22, 16384
    s_add_u32 s16, s16, 2048
    buffer_load_dwordx4 v2, s[12:15], s18 offen offset:0 lds
    s_add_u32 s17, s17, 2048
    buffer_load_dwordx4 v3, s[12:15], s18 offen offset:1024 lds
    buffer_load_dwordx4 v4, s[12:15], s18 offen offset:2048 lds
    buffer_load_dwordx4 v5, s[12:15], s18 offen offset:3072 lds
    s_add_u32 s18, s18, s20
    s_add_u32 m0, s22, 32768
    s_nop 0
    buffer_load_dwordx4 v1, s[8:11], s16 offen offset:0 sc1 lds
    buffer_load_dwordx4 v1, s[8:11], s16 offen offset:1024 sc1 lds
    buffer_load_dwordx4 v1, s[8:11], s17 offen offset:2048 sc1 lds
    buffer_load_dwordx4 v1, s[8:11], s17 offen offset:3072 sc1 lds
    s_add_u32 m0, s22, 49152
    s_add_u32 s16, s16, 2048
    buffer_load_dwordx4 v2, s[12:15], s18 offen offset:0 lds
    s_add_u32 s17, s17, 2048
    buffer_load_dwordx4 v3, s[12:15], s18 offen offset:1024 lds
    buffer_load_dwordx4 v4, s[12:15], s18 offen offset:2048 lds
    buffer_load_dwordx4 v5, s[12:15], s18 offen offset:3072 lds
    s_add_u32 s18, s18, s20
    s_add_u32 m0, s22, 65536
    s_nop 0
    buffer_load_dwordx4 v1, s[8:11], s16 offen offset:0 sc1 lds
    buffer_load_dwordx4 v1, s[8:11], s16 offen offset:1024 sc1 lds
    buffer_load_dwordx4 v1, s[8:11], s17 offen offset:2048 sc1 lds
    buffer_load_dwordx4 v1, s[8:11], s17 offen offset:3072 sc1 lds
    s_add_u32 m0, s22, 81920
    s_add_u32 s16, s16, 2048
    buffer_load_dwordx4 v2, s[12:15], s18 offen offset:0 lds
    s_add_u32 s17, s17, 2048
    buffer_load_dwordx4 v3, s[12:15], s18 offen offset:1024 lds
    buffer_load_dwordx4 v4, s[12:15], s18 offen offset:2048 lds
    buffer_load_dwordx4 v5, s[12:15], s18 offen offset:3072 lds
    s_add_u32 s18, s18, s20
    s_add_u32 m0, s22, 98304
    s_nop 0
    buffer_load_dwordx4 v1, s[8:11], s16 offen offset:0 sc1 lds
    buffer_load_dwordx4 v1, s[8:11], s16 offen offset:1024 sc1 lds
    buffer_load_dwordx4 v1, s[8:11], s17 offen offset:2048 sc1 lds
    buffer_load_dwordx4 v1, s[8:11], s17 offen offset:3072 sc1 lds
    s_add_u32 m0, s22, 114688
    s_add_u32 s16, s16, 2048
    buffer_load_dwordx4 v2, s[12:15], s18 offen offset:0 lds
    s_add_u32 s17, s17, 2048
    buffer_load_dwordx4 v3, s[12:15], s18 offen offset:1024 lds
    buffer_load_dwordx4 v4, s[12:15], s18 offen offset:2048 lds
    buffer_load_dwordx4 v5, s[12:15], s18 offen offset:3072 lds
    s_add_u32 s18, s18, s20
    v_accvgpr_write_b32 a0, 0
    v_accvgpr_write_b32 a1, 0
    v_accvgpr_write_b32 a2, 0
    v_accvgpr_write_b32 a3, 0
    v_accvgpr_write_b32 a4, 0
    v_accvgpr_write_b32 a5, 0
    v_accvgpr_write_b32 a6, 0
    v_accvgpr_write_b32 a7, 0
    v_accvgpr_write_b32 a8, 0
    v_accvgpr_write_b32 a9, 0
    v_accvgpr_write_b32 a10, 0
    v_accvgpr_write_b32 a11, 0
    v_accvgpr_write_b32 a12, 0
    v_accvgpr_write_b32 a13, 0
    v_accvgpr_write_b32 a14, 0
    v_accvgpr_write_b32 a15, 0
    v_accvgpr_write_b32 a16, 0
    v_accvgpr_write_b32 a17, 0
    v_accvgpr_write_b32 a18, 0
    v_accvgpr_write_b32 a19, 0
    v_accvgpr_write_b32 a20, 0
    v_accvgpr_write_b32 a21, 0
    v_accvgpr_write_b32 a22, 0
    v_accvgpr_write_b32 a23, 0
    v_accvgpr_write_b32 a24, 0
    v_accvgpr_write_b32 a25, 0
    v_accvgpr_write_b32 a26, 0
    v_accvgpr_write_b32 a27, 0
    v_accvgpr_write_b32 a28, 0
    v_accvgpr_write_b32 a29, 0
    v_accvgpr_write_b32 a30, 0
    v_accvgpr_write_b32 a31, 0
    v_accvgpr_write_b32 a32, 0
    v_accvgpr_write_b32 a33, 0
    v_accvgpr_write_b32 a34, 0
    v_accvgpr_write_b32 a35, 0
    v_accvgpr_write_b32 a36, 0
    v_accvgpr_write_b32 a37, 0
    v_accvgpr_write_b32 a38, 0
    v_accvgpr_write_b32 a39, 0
    v_accvgpr_write_b32 a40, 0
    v_accvgpr_write_b32 a41, 0
    v_accvgpr_write_b32 a42, 0
    v_accvgpr_write_b32 a43, 0
    v_accvgpr_write_b32 a44, 0
    v_accvgpr_write_b32 a45, 0
    v_accvgpr_write_b32 a46, 0
    v_accvgpr_write_b32 a47, 0
    v_accvgpr_write_b32 a48, 0
    v_accvgpr_write_b32 a49, 0
    v_accvgpr_write_b32 a50, 0
    v_accvgpr_write_b32 a51, 0
    v_accvgpr_write_b32 a52, 0
    v_accvgpr_write_b32 a53, 0
    v_accvgpr_write_b32 a54, 0
    v_accvgpr_write_b32 a55, 0
    v_accvgpr_write_b32 a56, 0
    v_accvgpr_write_b32 a57, 0
    v_accvgpr_write_b32 a58, 0
    v_accvgpr_write_b32 a59, 0
    v_accvgpr_write_b32 a60, 0
    v_accvgpr_write_b32 a61, 0
    v_accvgpr_write_b32 a62, 0
    v_accvgpr_write_b32 a63, 0
    v_accvgpr_write_b32 a64, 0
    v_accvgpr_write_b32 a65, 0
    v_accvgpr_write_b32 a66, 0
    v_accvgpr_write_b32 a67, 0
    v_accvgpr_write_b32 a68, 0
    v_accvgpr_write_b32 a69, 0
    v_accvgpr_write_b32 a70, 0
    v_accvgpr_write_b32 a71, 0
    v_accvgpr_write_b32 a72, 0
    v_accvgpr_write_b32 a73, 0
    v_accvgpr_write_b32 a74, 0
    v_accvgpr_write_b32 a75, 0
    v_accvgpr_write_b32 a76, 0
    v_accvgpr_write_b32 a77, 0
    v_accvgpr_write_b32 a78, 0
    v_accvgpr_write_b32 a79, 0
    v_accvgpr_write_b32 a80, 0
    v_accvgpr_write_b32 a81, 0
    v_accvgpr_write_b32 a82, 0
    v_accvgpr_write_b32 a83, 0
    v_accvgpr_write_b32 a84, 0
    v_accvgpr_write_b32 a85, 0
    v_accvgpr_write_b32 a86, 0
    v_accvgpr_write_b32 a87, 0
    v_accvgpr_write_b32 a88, 0
    v_accvgpr_write_b32 a89, 0
    v_accvgpr_write_b32 a90, 0
    v_accvgpr_write_b32 a91, 0
    v_accvgpr_write_b32 a92, 0
    v_accvgpr_write_b32 a93, 0
    v_accvgpr_write_b32 a94, 0
    v_accvgpr_write_b32 a95, 0
    v_accvgpr_write_b32 a96, 0
    v_accvgpr_write_b32 a97, 0
    v_accvgpr_write_b32 a98, 0
    v_accvgpr_write_b32 a99, 0
    v_accvgpr_write_b32 a100, 0
    v_accvgpr_write_b32 a101, 0
    v_accvgpr_write_b32 a102, 0
    v_accvgpr_write_b32 a103, 0
    v_accvgpr_write_b32 a104, 0
    v_accvgpr_write_b32 a105, 0
    v_accvgpr_write_b32 a106, 0
    v_accvgpr_write_b32 a107, 0
    v_accvgpr_write_b32 a108, 0
    v_accvgpr_write_b32 a109, 0
    v_accvgpr_write_b32 a110, 0
    v_accvgpr_write_b32 a111, 0
    v_accvgpr_write_b32 a112, 0
    v_accvgpr_write_b32 a113, 0
    v_accvgpr_write_b32 a114, 0
    v_accvgpr_write_b32 a115, 0
    v_accvgpr_write_b32 a116, 0
    v_accvgpr_write_b32 a117, 0
    v_accvgpr_write_b32 a118, 0
    v_accvgpr_write_b32 a119, 0
    v_accvgpr_write_b32 a120, 0
    v_accvgpr_write_b32 a121, 0
    v_accvgpr_write_b32 a122, 0
    v_accvgpr_write_b32 a123, 0
    v_accvgpr_write_b32 a124, 0
    v_accvgpr_write_b32 a125, 0
    v_accvgpr_write_b32 a126, 0
    v_accvgpr_write_b32 a127, 0
    v_accvgpr_write_b32 a128, 0
    v_accvgpr_write_b32 a129, 0
    v_accvgpr_write_b32 a130, 0
    v_accvgpr_write_b32 a131, 0
    v_accvgpr_write_b32 a132, 0
    v_accvgpr_write_b32 a133, 0
    v_accvgpr_write_b32 a134, 0
    v_accvgpr_write_b32 a135, 0
    v_accvgpr_write_b32 a136, 0
    v_accvgpr_write_b32 a137, 0
    v_accvgpr_write_b32 a138, 0
    v_accvgpr_write_b32 a139, 0
    v_accvgpr_write_b32 a140, 0
    v_accvgpr_write_b32 a141, 0
    v_accvgpr_write_b32 a142, 0
    v_accvgpr_write_b32 a143, 0
    v_accvgpr_write_b32 a144, 0
    v_accvgpr_write_b32 a145, 0
    v_accvgpr_write_b32 a146, 0
    v_accvgpr_write_b32 a147, 0
    v_accvgpr_write_b32 a148, 0
    v_accvgpr_write_b32 a149, 0
    v_accvgpr_write_b32 a150, 0
    v_accvgpr_write_b32 a151, 0
    v_accvgpr_write_b32 a152, 0
    v_accvgpr_write_b32 a153, 0
    v_accvgpr_write_b32 a154, 0
    v_accvgpr_write_b32 a155, 0
    v_accvgpr_write_b32 a156, 0
    v_accvgpr_write_b32 a157, 0
    v_accvgpr_write_b32 a158, 0
    v_accvgpr_write_b32 a159, 0
    v_accvgpr_write_b32 a160, 0
    v_accvgpr_write_b32 a161, 0
    v_accvgpr_write_b32 a162, 0
    v_accvgpr_write_b32 a163, 0
    v_accvgpr_write_b32 a164, 0
    v_accvgpr_write_b32 a165, 0
    v_accvgpr_write_b32 a166, 0
    v_accvgpr_write_b32 a167, 0
    v_accvgpr_write_b32 a168, 0
    v_accvgpr_write_b32 a169, 0
    v_accvgpr_write_b32 a170, 0
    v_accvgpr_write_b32 a171, 0
    v_accvgpr_write_b32 a172, 0
    v_accvgpr_write_b32 a173, 0
    v_accvgpr_write_b32 a174, 0
    v_accvgpr_write_b32 a175, 0
    v_accvgpr_write_b32 a176, 0
    v_accvgpr_write_b32 a177, 0
    v_accvgpr_write_b32 a178, 0
    v_accvgpr_write_b32 a179, 0
    v_accvgpr_write_b32 a180, 0
    v_accvgpr_write_b32 a181, 0
    v_accvgpr_write_b32 a182, 0
    v_accvgpr_write_b32 a183, 0
    v_accvgpr_write_b32 a184, 0
    v_accvgpr_write_b32 a185, 0
    v_accvgpr_write_b32 a186, 0
    v_accvgpr_write_b32 a187, 0
    v_accvgpr_write_b32 a188, 0
    v_accvgpr_write_b32 a189, 0
    v_accvgpr_write_b32 a190, 0
    v_accvgpr_write_b32 a191, 0
    v_accvgpr_write_b32 a192, 0
    v_accvgpr_write_b32 a193, 0
    v_accvgpr_write_b32 a194, 0
    v_accvgpr_write_b32 a195, 0
    v_accvgpr_write_b32 a196, 0
    v_accvgpr_write_b32 a197, 0
    v_accvgpr_write_b32 a198, 0
    v_accvgpr_write_b32 a199, 0
    v_accvgpr_write_b32 a200, 0
    v_accvgpr_write_b32 a201, 0
    v_accvgpr_write_b32 a202, 0
    v_accvgpr_write_b32 a203, 0
    v_accvgpr_write_b32 a204, 0
    v_accvgpr_write_b32 a205, 0
    v_accvgpr_write_b32 a206, 0
    v_accvgpr_write_b32 a207, 0
    v_accvgpr_write_b32 a208, 0
    v_accvgpr_write_b32 a209, 0
    v_accvgpr_write_b32 a210, 0
    v_accvgpr_write_b32 a211, 0
    v_accvgpr_write_b32 a212, 0
    v_accvgpr_write_b32 a213, 0
    v_accvgpr_write_b32 a214, 0
    v_accvgpr_write_b32 a215, 0
    v_accvgpr_write_b32 a216, 0
    v_accvgpr_write_b32 a217, 0
    v_accvgpr_write_b32 a218, 0
    v_accvgpr_write_b32 a219, 0
    v_accvgpr_write_b32 a220, 0
    v_accvgpr_write_b32 a221, 0
    v_accvgpr_write_b32 a222, 0
    v_accvgpr_write_b32 a223, 0
    v_accvgpr_write_b32 a224, 0
    v_accvgpr_write_b32 a225, 0
    v_accvgpr_write_b32 a226, 0
    v_accvgpr_write_b32 a227, 0
    v_accvgpr_write_b32 a228, 0
    v_accvgpr_write_b32 a229, 0
    v_accvgpr_write_b32 a230, 0
    v_accvgpr_write_b32 a231, 0
    v_accvgpr_write_b32 a232, 0
    v_accvgpr_write_b32 a233, 0
    v_accvgpr_write_b32 a234, 0
    v_accvgpr_write_b32 a235, 0
    v_accvgpr_write_b32 a236, 0
    v_accvgpr_write_b32 a237, 0
    v_accvgpr_write_b32 a238, 0
    v_accvgpr_write_b32 a239, 0
    v_accvgpr_write_b32 a240, 0
    v_accvgpr_write_b32 a241, 0
    v_accvgpr_write_b32 a242, 0
    v_accvgpr_write_b32 a243, 0
    v_accvgpr_write_b32 a244, 0
    v_accvgpr_write_b32 a245, 0
    v_accvgpr_write_b32 a246, 0
    v_accvgpr_write_b32 a247, 0
    v_accvgpr_write_b32 a248, 0
    v_accvgpr_write_b32 a249, 0
    v_accvgpr_write_b32 a250, 0
    v_accvgpr_write_b32 a251, 0
    v_accvgpr_write_b32 a252, 0
    v_accvgpr_write_b32 a253, 0
    v_accvgpr_write_b32 a254, 0
    v_accvgpr_write_b32 a255, 0
    s_waitcnt vmcnt(24)
    s_barrier
    ds_read_b128 v[64:67], v6 offset:0
    ds_read_b64_tr_b16 v[80:81], v48 offset:0
    ds_read_b64_tr_b16 v[82:83], v48 offset:1024
    ds_read_b64_tr_b16 v[84:85], v49 offset:0
    ds_read_b64_tr_b16 v[86:87], v49 offset:1024
    ds_read_b64_tr_b16 v[88:89], v48 offset:8192
    ds_read_b64_tr_b16 v[90:91], v48 offset:9216
    ds_read_b64_tr_b16 v[92:93], v49 offset:8192
    ds_read_b64_tr_b16 v[94:95], v49 offset:9216
    ds_read_b128 v[68:71], v6 offset:2048
    ds_read_b128 v[72:75], v6 offset:4096
    ds_read_b128 v[76:79], v6 offset:6144
    s_waitcnt lgkmcnt(0)
    s_mov_b32 s21, 7
.p2align 6
uq_loop_12:
    v_mfma_f32_32x32x16_bf16 a[0:15], v[80:83], v[64:67], a[0:15]
    ds_read_b128 v[96:99], v6 offset:1024
    v_mfma_f32_32x32x16_bf16 a[16:31], v[84:87], v[64:67], a[16:31]
    ds_read_b64_tr_b16 v[112:113], v48 offset:4096
    v_mfma_f32_32x32x16_bf16 a[32:47], v[88:91], v[64:67], a[32:47]
    ds_read_b64_tr_b16 v[114:115], v48 offset:5120
    v_mfma_f32_32x32x16_bf16 a[48:63], v[92:95], v[64:67], a[48:63]
    ds_read_b64_tr_b16 v[116:117], v49 offset:4096
    v_mfma_f32_32x32x16_bf16 a[64:79], v[80:83], v[68:71], a[64:79]
    ds_read_b64_tr_b16 v[118:119], v49 offset:5120
    v_mfma_f32_32x32x16_bf16 a[80:95], v[84:87], v[68:71], a[80:95]
    ds_read_b64_tr_b16 v[120:121], v48 offset:12288
    v_mfma_f32_32x32x16_bf16 a[96:111], v[88:91], v[68:71], a[96:111]
    ds_read_b64_tr_b16 v[122:123], v48 offset:13312
    v_mfma_f32_32x32x16_bf16 a[112:127], v[92:95], v[68:71], a[112:127]
    ds_read_b64_tr_b16 v[124:125], v49 offset:12288
    v_mfma_f32_32x32x16_bf16 a[128:143], v[80:83], v[72:75], a[128:143]
    ds_read_b64_tr_b16 v[126:127], v49 offset:13312
    v_mfma_f32_32x32x16_bf16 a[144:159], v[84:87], v[72:75], a[144:159]
    ds_read_b128 v[100:103], v6 offset:3072
    v_mfma_f32_32x32x16_bf16 a[160:175], v[88:91], v[72:75], a[160:175]
    ds_read_b128 v[104:107], v6 offset:5120
    v_mfma_f32_32x32x16_bf16 a[176:191], v[92:95], v[72:75], a[176:191]
    ds_read_b128 v[108:111], v6 offset:7168
    v_mfma_f32_32x32x16_bf16 a[192:207], v[80:83], v[76:79], a[192:207]
    v_mfma_f32_32x32x16_bf16 a[208:223], v[84:87], v[76:79], a[208:223]
    v_mfma_f32_32x32x16_bf16 a[224:239], v[88:91], v[76:79], a[224:239]
    v_mfma_f32_32x32x16_bf16 a[240:255], v[92:95], v[76:79], a[240:255]
    s_waitcnt vmcnt(16) lgkmcnt(0)
    s_barrier
    v_mfma_f32_32x32x16_bf16 a[0:15], v[112:115], v[96:99], a[0:15]
    ds_read_b128 v[64:67], v6 offset:32768
    v_mfma_f32_32x32x16_bf16 a[16:31], v[116:119], v[96:99], a[16:31]
    ds_read_b64_tr_b16 v[80:81], v48 offset:32768
    s_add_u32 m0, s22, 0
    s_nop 0
    buffer_load_dwordx4 v1, s[8:11], s16 offen offset:0 sc1 lds
    v_mfma_f32_32x32x16_bf16 a[32:47], v[120:123], v[96:99], a[32:47]
    ds_read_b64_tr_b16 v[82:83], v48 offset:33792
    v_mfma_f32_32x32x16_bf16 a[48:63], v[124:127], v[96:99], a[48:63]
    ds_read_b64_tr_b16 v[84:85], v49 offset:32768
    buffer_load_dwordx4 v1, s[8:11], s16 offen offset:1024 sc1 lds
    v_mfma_f32_32x32x16_bf16 a[64:79], v[112:115], v[100:103], a[64:79]
    ds_read_b64_tr_b16 v[86:87], v49 offset:33792
    v_mfma_f32_32x32x16_bf16 a[80:95], v[116:119], v[100:103], a[80:95]
    ds_read_b64_tr_b16 v[88:89], v48 offset:40960
    buffer_load_dwordx4 v1, s[8:11], s17 offen offset:2048 sc1 lds
    v_mfma_f32_32x32x16_bf16 a[96:111], v[120:123], v[100:103], a[96:111]
    ds_read_b64_tr_b16 v[90:91], v48 offset:41984
    v_mfma_f32_32x32x16_bf16 a[112:127], v[124:127], v[100:103], a[112:127]
    ds_read_b64_tr_b16 v[92:93], v49 offset:40960
    buffer_load_dwordx4 v1, s[8:11], s17 offen offset:3072 sc1 lds
    s_add_u32 m0, s22, 16384
    s_add_u32 s16, s16, 2048
    v_mfma_f32_32x32x16_bf16 a[128:143], v[112:115], v[104:107], a[128:143]
    ds_read_b64_tr_b16 v[94:95], v49 offset:41984
    v_mfma_f32_32x32x16_bf16 a[144:159], v[116:119], v[104:107], a[144:159]
    ds_read_b128 v[68:71], v6 offset:34816
    buffer_load_dwordx4 v2, s[12:15], s18 offen offset:0 lds
    s_add_u32 s17, s17, 2048
    v_mfma_f32_32x32x16_bf16 a[160:175], v[120:123], v[104:107], a[160:175]
    ds_read_b128 v[72:75], v6 offset:36864
    v_mfma_f32_32x32x16_bf16 a[176:191], v[124:127], v[104:107], a[176:191]
    ds_read_b128 v[76:79], v6 offset:38912
    buffer_load_dwordx4 v3, s[12:15], s18 offen offset:1024 lds
    v_mfma_f32_32x32x16_bf16 a[192:207], v[112:115], v[108:111], a[192:207]
    v_mfma_f32_32x32x16_bf16 a[208:223], v[116:119], v[108:111], a[208:223]
    buffer_load_dwordx4 v4, s[12:15], s18 offen offset:2048 lds
    v_mfma_f32_32x32x16_bf16 a[224:239], v[120:123], v[108:111], a[224:239]
    v_mfma_f32_32x32x16_bf16 a[240:255], v[124:127], v[108:111], a[240:255]
    buffer_load_dwordx4 v5, s[12:15], s18 offen offset:3072 lds
    s_add_u32 s18, s18, s20
    s_waitcnt lgkmcnt(0)
    v_mfma_f32_32x32x16_bf16 a[0:15], v[80:83], v[64:67], a[0:15]
    ds_read_b128 v[96:99], v6 offset:33792
    v_mfma_f32_32x32x16_bf16 a[16:31], v[84:87], v[64:67], a[16:31]
    ds_read_b64_tr_b16 v[112:113], v48 offset:36864
    v_mfma_f32_32x32x16_bf16 a[32:47], v[88:91], v[64:67], a[32:47]
    ds_read_b64_tr_b16 v[114:115], v48 offset:37888
    v_mfma_f32_32x32x16_bf16 a[48:63], v[92:95], v[64:67], a[48:63]
    ds_read_b64_tr_b16 v[116:117], v49 offset:36864
    v_mfma_f32_32x32x16_bf16 a[64:79], v[80:83], v[68:71], a[64:79]
    ds_read_b64_tr_b16 v[118:119], v49 offset:37888
    v_mfma_f32_32x32x16_bf16 a[80:95], v[84:87], v[68:71], a[80:95]
    ds_read_b64_tr_b16 v[120:121], v48 offset:45056
    v_mfma_f32_32x32x16_bf16 a[96:111], v[88:91], v[68:71], a[96:111]
    ds_read_b64_tr_b16 v[122:123], v48 offset:46080
    v_mfma_f32_32x32x16_bf16 a[112:127], v[92:95], v[68:71], a[112:127]
    ds_read_b64_tr_b16 v[124:125], v49 offset:45056
    v_mfma_f32_32x32x16_bf16 a[128:143], v[80:83], v[72:75], a[128:143]
    ds_read_b64_tr_b16 v[126:127], v49 offset:46080
    v_mfma_f32_32x32x16_bf16 a[144:159], v[84:87], v[72:75], a[144:159]
    ds_read_b128 v[100:103], v6 offset:35840
    v_mfma_f32_32x32x16_bf16 a[160:175], v[88:91], v[72:75], a[160:175]
    ds_read_b128 v[104:107], v6 offset:37888
    v_mfma_f32_32x32x16_bf16 a[176:191], v[92:95], v[72:75], a[176:191]
    ds_read_b128 v[108:111], v6 offset:39936
    v_mfma_f32_32x32x16_bf16 a[192:207], v[80:83], v[76:79], a[192:207]
    v_mfma_f32_32x32x16_bf16 a[208:223], v[84:87], v[76:79], a[208:223]
    v_mfma_f32_32x32x16_bf16 a[224:239], v[88:91], v[76:79], a[224:239]
    v_mfma_f32_32x32x16_bf16 a[240:255], v[92:95], v[76:79], a[240:255]
    s_waitcnt vmcnt(16) lgkmcnt(0)
    s_barrier
    v_mfma_f32_32x32x16_bf16 a[0:15], v[112:115], v[96:99], a[0:15]
    ds_read_b128 v[64:67], v7 offset:0
    v_mfma_f32_32x32x16_bf16 a[16:31], v[116:119], v[96:99], a[16:31]
    ds_read_b64_tr_b16 v[80:81], v50 offset:0
    s_add_u32 m0, s22, 32768
    s_nop 0
    buffer_load_dwordx4 v1, s[8:11], s16 offen offset:0 sc1 lds
    v_mfma_f32_32x32x16_bf16 a[32:47], v[120:123], v[96:99], a[32:47]
    ds_read_b64_tr_b16 v[82:83], v50 offset:1024
    v_mfma_f32_32x32x16_bf16 a[48:63], v[124:127], v[96:99], a[48:63]
    ds_read_b64_tr_b16 v[84:85], v51 offset:0
    buffer_load_dwordx4 v1, s[8:11], s16 offen offset:1024 sc1 lds
    v_mfma_f32_32x32x16_bf16 a[64:79], v[112:115], v[100:103], a[64:79]
    ds_read_b64_tr_b16 v[86:87], v51 offset:1024
    v_mfma_f32_32x32x16_bf16 a[80:95], v[116:119], v[100:103], a[80:95]
    ds_read_b64_tr_b16 v[88:89], v50 offset:8192
    buffer_load_dwordx4 v1, s[8:11], s17 offen offset:2048 sc1 lds
    v_mfma_f32_32x32x16_bf16 a[96:111], v[120:123], v[100:103], a[96:111]
    ds_read_b64_tr_b16 v[90:91], v50 offset:9216
    v_mfma_f32_32x32x16_bf16 a[112:127], v[124:127], v[100:103], a[112:127]
    ds_read_b64_tr_b16 v[92:93], v51 offset:8192
    buffer_load_dwordx4 v1, s[8:11], s17 offen offset:3072 sc1 lds
    s_add_u32 m0, s22, 49152
    s_add_u32 s16, s16, 2048
    v_mfma_f32_32x32x16_bf16 a[128:143], v[112:115], v[104:107], a[128:143]
    ds_read_b64_tr_b16 v[94:95], v51 offset:9216
    v_mfma_f32_32x32x16_bf16 a[144:159], v[116:119], v[104:107], a[144:159]
    ds_read_b128 v[68:71], v7 offset:2048
    buffer_load_dwordx4 v2, s[12:15], s18 offen offset:0 lds
    s_add_u32 s17, s17, 2048
    v_mfma_f32_32x32x16_bf16 a[160:175], v[120:123], v[104:107], a[160:175]
    ds_read_b128 v[72:75], v7 offset:4096
    v_mfma_f32_32x32x16_bf16 a[176:191], v[124:127], v[104:107], a[176:191]
    ds_read_b128 v[76:79], v7 offset:6144
    buffer_load_dwordx4 v3, s[12:15], s18 offen offset:1024 lds
    v_mfma_f32_32x32x16_bf16 a[192:207], v[112:115], v[108:111], a[192:207]
    v_mfma_f32_32x32x16_bf16 a[208:223], v[116:119], v[108:111], a[208:223]
    buffer_load_dwordx4 v4, s[12:15], s18 offen offset:2048 lds
    v_mfma_f32_32x32x16_bf16 a[224:239], v[120:123], v[108:111], a[224:239]
    v_mfma_f32_32x32x16_bf16 a[240:255], v[124:127], v[108:111], a[240:255]
    buffer_load_dwordx4 v5, s[12:15], s18 offen offset:3072 lds
    s_add_u32 s18, s18, s20
    s_waitcnt lgkmcnt(0)
    v_mfma_f32_32x32x16_bf16 a[0:15], v[80:83], v[64:67], a[0:15]
    ds_read_b128 v[96:99], v7 offset:1024
    v_mfma_f32_32x32x16_bf16 a[16:31], v[84:87], v[64:67], a[16:31]
    ds_read_b64_tr_b16 v[112:113], v50 offset:4096
    v_mfma_f32_32x32x16_bf16 a[32:47], v[88:91], v[64:67], a[32:47]
    ds_read_b64_tr_b16 v[114:115], v50 offset:5120
    v_mfma_f32_32x32x16_bf16 a[48:63], v[92:95], v[64:67], a[48:63]
    ds_read_b64_tr_b16 v[116:117], v51 offset:4096
    v_mfma_f32_32x32x16_bf16 a[64:79], v[80:83], v[68:71], a[64:79]
    ds_read_b64_tr_b16 v[118:119], v51 offset:5120
    v_mfma_f32_32x32x16_bf16 a[80:95], v[84:87], v[68:71], a[80:95]
    ds_read_b64_tr_b16 v[120:121], v50 offset:12288
    v_mfma_f32_32x32x16_bf16 a[96:111], v[88:91], v[68:71], a[96:111]
    ds_read_b64_tr_b16 v[122:123], v50 offset:13312
    v_mfma_f32_32x32x16_bf16 a[112:127], v[92:95], v[68:71], a[112:127]
    ds_read_b64_tr_b16 v[124:125], v51 offset:12288
    v_mfma_f32_32x32x16_bf16 a[128:143], v[80:83], v[72:75], a[128:143]
    ds_read_b64_tr_b16 v[126:127], v51 offset:13312
    v_mfma_f32_32x32x16_bf16 a[144:159], v[84:87], v[72:75], a[144:159]
    ds_read_b128 v[100:103], v7 offset:3072
    v_mfma_f32_32x32x16_bf16 a[160:175], v[88:91], v[72:75], a[160:175]
    ds_read_b128 v[104:107], v7 offset:5120
    v_mfma_f32_32x32x16_bf16 a[176:191], v[92:95], v[72:75], a[176:191]
    ds_read_b128 v[108:111], v7 offset:7168
    v_mfma_f32_32x32x16_bf16 a[192:207], v[80:83], v[76:79], a[192:207]
    v_mfma_f32_32x32x16_bf16 a[208:223], v[84:87], v[76:79], a[208:223]
    v_mfma_f32_32x32x16_bf16 a[224:239], v[88:91], v[76:79], a[224:239]
    v_mfma_f32_32x32x16_bf16 a[240:255], v[92:95], v[76:79], a[240:255]
    s_waitcnt vmcnt(16) lgkmcnt(0)
    s_barrier
    v_mfma_f32_32x32x16_bf16 a[0:15], v[112:115], v[96:99], a[0:15]
    ds_read_b128 v[64:67], v7 offset:32768
    v_mfma_f32_32x32x16_bf16 a[16:31], v[116:119], v[96:99], a[16:31]
    ds_read_b64_tr_b16 v[80:81], v50 offset:32768
    s_add_u32 m0, s22, 65536
    s_nop 0
    buffer_load_dwordx4 v1, s[8:11], s16 offen offset:0 sc1 lds
    v_mfma_f32_32x32x16_bf16 a[32:47], v[120:123], v[96:99], a[32:47]
    ds_read_b64_tr_b16 v[82:83], v50 offset:33792
    v_mfma_f32_32x32x16_bf16 a[48:63], v[124:127], v[96:99], a[48:63]
    ds_read_b64_tr_b16 v[84:85], v51 offset:32768
    buffer_load_dwordx4 v1, s[8:11], s16 offen offset:1024 sc1 lds
    v_mfma_f32_32x32x16_bf16 a[64:79], v[112:115], v[100:103], a[64:79]
    ds_read_b64_tr_b16 v[86:87], v51 offset:33792
    v_mfma_f32_32x32x16_bf16 a[80:95], v[116:119], v[100:103], a[80:95]
    ds_read_b64_tr_b16 v[88:89], v50 offset:40960
    buffer_load_dwordx4 v1, s[8:11], s17 offen offset:2048 sc1 lds
    v_mfma_f32_32x32x16_bf16 a[96:111], v[120:123], v[100:103], a[96:111]
    ds_read_b64_tr_b16 v[90:91], v50 offset:41984
    v_mfma_f32_32x32x16_bf16 a[112:127], v[124:127], v[100:103], a[112:127]
    ds_read_b64_tr_b16 v[92:93], v51 offset:40960
    buffer_load_dwordx4 v1, s[8:11], s17 offen offset:3072 sc1 lds
    s_add_u32 m0, s22, 81920
    s_add_u32 s16, s16, 2048
    v_mfma_f32_32x32x16_bf16 a[128:143], v[112:115], v[104:107], a[128:143]
    ds_read_b64_tr_b16 v[94:95], v51 offset:41984
    v_mfma_f32_32x32x16_bf16 a[144:159], v[116:119], v[104:107], a[144:159]
    ds_read_b128 v[68:71], v7 offset:34816
    buffer_load_dwordx4 v2, s[12:15], s18 offen offset:0 lds
    s_add_u32 s17, s17, 2048
    v_mfma_f32_32x32x16_bf16 a[160:175], v[120:123], v[104:107], a[160:175]
    ds_read_b128 v[72:75], v7 offset:36864
    v_mfma_f32_32x32x16_bf16 a[176:191], v[124:127], v[104:107], a[176:191]
    ds_read_b128 v[76:79], v7 offset:38912
    buffer_load_dwordx4 v3, s[12:15], s18 offen offset:1024 lds
    v_mfma_f32_32x32x16_bf16 a[192:207], v[112:115], v[108:111], a[192:207]
    v_mfma_f32_32x32x16_bf16 a[208:223], v[116:119], v[108:111], a[208:223]
    buffer_load_dwordx4 v4, s[12:15], s18 offen offset:2048 lds
    v_mfma_f32_32x32x16_bf16 a[224:239], v[120:123], v[108:111], a[224:239]
    v_mfma_f32_32x32x16_bf16 a[240:255], v[124:127], v[108:111], a[240:255]
    buffer_load_dwordx4 v5, s[12:15], s18 offen offset:3072 lds
    s_add_u32 s18, s18, s20
    s_waitcnt lgkmcnt(0)
    v_mfma_f32_32x32x16_bf16 a[0:15], v[80:83], v[64:67], a[0:15]
    ds_read_b128 v[96:99], v7 offset:33792
    v_mfma_f32_32x32x16_bf16 a[16:31], v[84:87], v[64:67], a[16:31]
    ds_read_b64_tr_b16 v[112:113], v50 offset:36864
    v_mfma_f32_32x32x16_bf16 a[32:47], v[88:91], v[64:67], a[32:47]
    ds_read_b64_tr_b16 v[114:115], v50 offset:37888
    v_mfma_f32_32x32x16_bf16 a[48:63], v[92:95], v[64:67], a[48:63]
    ds_read_b64_tr_b16 v[116:117], v51 offset:36864
    v_mfma_f32_32x32x16_bf16 a[64:79], v[80:83], v[68:71], a[64:79]
    ds_read_b64_tr_b16 v[118:119], v51 offset:37888
    v_mfma_f32_32x32x16_bf16 a[80:95], v[84:87], v[68:71], a[80:95]
    ds_read_b64_tr_b16 v[120:121], v50 offset:45056
    v_mfma_f32_32x32x16_bf16 a[96:111], v[88:91], v[68:71], a[96:111]
    ds_read_b64_tr_b16 v[122:123], v50 offset:46080
    v_mfma_f32_32x32x16_bf16 a[112:127], v[92:95], v[68:71], a[112:127]
    ds_read_b64_tr_b16 v[124:125], v51 offset:45056
    v_mfma_f32_32x32x16_bf16 a[128:143], v[80:83], v[72:75], a[128:143]
    ds_read_b64_tr_b16 v[126:127], v51 offset:46080
    v_mfma_f32_32x32x16_bf16 a[144:159], v[84:87], v[72:75], a[144:159]
    ds_read_b128 v[100:103], v7 offset:35840
    v_mfma_f32_32x32x16_bf16 a[160:175], v[88:91], v[72:75], a[160:175]
    ds_read_b128 v[104:107], v7 offset:37888
    v_mfma_f32_32x32x16_bf16 a[176:191], v[92:95], v[72:75], a[176:191]
    ds_read_b128 v[108:111], v7 offset:39936
    v_mfma_f32_32x32x16_bf16 a[192:207], v[80:83], v[76:79], a[192:207]
    v_mfma_f32_32x32x16_bf16 a[208:223], v[84:87], v[76:79], a[208:223]
    v_mfma_f32_32x32x16_bf16 a[224:239], v[88:91], v[76:79], a[224:239]
    v_mfma_f32_32x32x16_bf16 a[240:255], v[92:95], v[76:79], a[240:255]
    s_waitcnt vmcnt(16) lgkmcnt(0)
    s_barrier
    v_mfma_f32_32x32x16_bf16 a[0:15], v[112:115], v[96:99], a[0:15]
    ds_read_b128 v[64:67], v6 offset:0
    v_mfma_f32_32x32x16_bf16 a[16:31], v[116:119], v[96:99], a[16:31]
    ds_read_b64_tr_b16 v[80:81], v48 offset:0
    s_add_u32 m0, s22, 98304
    s_nop 0
    buffer_load_dwordx4 v1, s[8:11], s16 offen offset:0 sc1 lds
    v_mfma_f32_32x32x16_bf16 a[32:47], v[120:123], v[96:99], a[32:47]
    ds_read_b64_tr_b16 v[82:83], v48 offset:1024
    v_mfma_f32_32x32x16_bf16 a[48:63], v[124:127], v[96:99], a[48:63]
    ds_read_b64_tr_b16 v[84:85], v49 offset:0
    buffer_load_dwordx4 v1, s[8:11], s16 offen offset:1024 sc1 lds
    v_mfma_f32_32x32x16_bf16 a[64:79], v[112:115], v[100:103], a[64:79]
    ds_read_b64_tr_b16 v[86:87], v49 offset:1024
    v_mfma_f32_32x32x16_bf16 a[80:95], v[116:119], v[100:103], a[80:95]
    ds_read_b64_tr_b16 v[88:89], v48 offset:8192
    buffer_load_dwordx4 v1, s[8:11], s17 offen offset:2048 sc1 lds
    v_mfma_f32_32x32x16_bf16 a[96:111], v[120:123], v[100:103], a[96:111]
    ds_read_b64_tr_b16 v[90:91], v48 offset:9216
    v_mfma_f32_32x32x16_bf16 a[112:127], v[124:127], v[100:103], a[112:127]
    ds_read_b64_tr_b16 v[92:93], v49 offset:8192
    buffer_load_dwordx4 v1, s[8:11], s17 offen offset:3072 sc1 lds
    s_add_u32 m0, s22, 114688
    s_add_u32 s16, s16, 2048
    v_mfma_f32_32x32x16_bf16 a[128:143], v[112:115], v[104:107], a[128:143]
    ds_read_b64_tr_b16 v[94:95], v49 offset:9216
    v_mfma_f32_32x32x16_bf16 a[144:159], v[116:119], v[104:107], a[144:159]
    ds_read_b128 v[68:71], v6 offset:2048
    buffer_load_dwordx4 v2, s[12:15], s18 offen offset:0 lds
    s_add_u32 s17, s17, 2048
    v_mfma_f32_32x32x16_bf16 a[160:175], v[120:123], v[104:107], a[160:175]
    ds_read_b128 v[72:75], v6 offset:4096
    v_mfma_f32_32x32x16_bf16 a[176:191], v[124:127], v[104:107], a[176:191]
    ds_read_b128 v[76:79], v6 offset:6144
    buffer_load_dwordx4 v3, s[12:15], s18 offen offset:1024 lds
    v_mfma_f32_32x32x16_bf16 a[192:207], v[112:115], v[108:111], a[192:207]
    v_mfma_f32_32x32x16_bf16 a[208:223], v[116:119], v[108:111], a[208:223]
    buffer_load_dwordx4 v4, s[12:15], s18 offen offset:2048 lds
    v_mfma_f32_32x32x16_bf16 a[224:239], v[120:123], v[108:111], a[224:239]
    v_mfma_f32_32x32x16_bf16 a[240:255], v[124:127], v[108:111], a[240:255]
    buffer_load_dwordx4 v5, s[12:15], s18 offen offset:3072 lds
    s_add_u32 s18, s18, s20
    s_waitcnt lgkmcnt(0)
    s_sub_u32 s21, s21, 1
    s_cmp_lg_u32 s21, 0
    s_cbranch_scc1 uq_loop_12
    v_mfma_f32_32x32x16_bf16 a[0:15], v[80:83], v[64:67], a[0:15]
    ds_read_b128 v[96:99], v6 offset:1024
    v_mfma_f32_32x32x16_bf16 a[16:31], v[84:87], v[64:67], a[16:31]
    ds_read_b64_tr_b16 v[112:113], v48 offset:4096
    v_mfma_f32_32x32x16_bf16 a[32:47], v[88:91], v[64:67], a[32:47]
    ds_read_b64_tr_b16 v[114:115], v48 offset:5120
    v_mfma_f32_32x32x16_bf16 a[48:63], v[92:95], v[64:67], a[48:63]
    ds_read_b64_tr_b16 v[116:117], v49 offset:4096
    v_mfma_f32_32x32x16_bf16 a[64:79], v[80:83], v[68:71], a[64:79]
    ds_read_b64_tr_b16 v[118:119], v49 offset:5120
    v_mfma_f32_32x32x16_bf16 a[80:95], v[84:87], v[68:71], a[80:95]
    ds_read_b64_tr_b16 v[120:121], v48 offset:12288
    v_mfma_f32_32x32x16_bf16 a[96:111], v[88:91], v[68:71], a[96:111]
    ds_read_b64_tr_b16 v[122:123], v48 offset:13312
    v_mfma_f32_32x32x16_bf16 a[112:127], v[92:95], v[68:71], a[112:127]
    ds_read_b64_tr_b16 v[124:125], v49 offset:12288
    v_mfma_f32_32x32x16_bf16 a[128:143], v[80:83], v[72:75], a[128:143]
    ds_read_b64_tr_b16 v[126:127], v49 offset:13312
    v_mfma_f32_32x32x16_bf16 a[144:159], v[84:87], v[72:75], a[144:159]
    ds_read_b128 v[100:103], v6 offset:3072
    v_mfma_f32_32x32x16_bf16 a[160:175], v[88:91], v[72:75], a[160:175]
    ds_read_b128 v[104:107], v6 offset:5120
    v_mfma_f32_32x32x16_bf16 a[176:191], v[92:95], v[72:75], a[176:191]
    ds_read_b128 v[108:111], v6 offset:7168
    v_mfma_f32_32x32x16_bf16 a[192:207], v[80:83], v[76:79], a[192:207]
    v_mfma_f32_32x32x16_bf16 a[208:223], v[84:87], v[76:79], a[208:223]
    v_mfma_f32_32x32x16_bf16 a[224:239], v[88:91], v[76:79], a[224:239]
    v_mfma_f32_32x32x16_bf16 a[240:255], v[92:95], v[76:79], a[240:255]
    s_waitcnt vmcnt(16) lgkmcnt(0)
    s_barrier
    v_mfma_f32_32x32x16_bf16 a[0:15], v[112:115], v[96:99], a[0:15]
    ds_read_b128 v[64:67], v6 offset:32768
    v_mfma_f32_32x32x16_bf16 a[16:31], v[116:119], v[96:99], a[16:31]
    ds_read_b64_tr_b16 v[80:81], v48 offset:32768
    v_mfma_f32_32x32x16_bf16 a[32:47], v[120:123], v[96:99], a[32:47]
    ds_read_b64_tr_b16 v[82:83], v48 offset:33792
    v_mfma_f32_32x32x16_bf16 a[48:63], v[124:127], v[96:99], a[48:63]
    ds_read_b64_tr_b16 v[84:85], v49 offset:32768
    v_mfma_f32_32x32x16_bf16 a[64:79], v[112:115], v[100:103], a[64:79]
    ds_read_b64_tr_b16 v[86:87], v49 offset:33792
    v_mfma_f32_32x32x16_bf16 a[80:95], v[116:119], v[100:103], a[80:95]
    ds_read_b64_tr_b16 v[88:89], v48 offset:40960
    v_mfma_f32_32x32x16_bf16 a[96:111], v[120:123], v[100:103], a[96:111]
    ds_read_b64_tr_b16 v[90:91], v48 offset:41984
    v_mfma_f32_32x32x16_bf16 a[112:127], v[124:127], v[100:103], a[112:127]
    ds_read_b64_tr_b16 v[92:93], v49 offset:40960
    v_mfma_f32_32x32x16_bf16 a[128:143], v[112:115], v[104:107], a[128:143]
    ds_read_b64_tr_b16 v[94:95], v49 offset:41984
    v_mfma_f32_32x32x16_bf16 a[144:159], v[116:119], v[104:107], a[144:159]
    ds_read_b128 v[68:71], v6 offset:34816
    v_mfma_f32_32x32x16_bf16 a[160:175], v[120:123], v[104:107], a[160:175]
    ds_read_b128 v[72:75], v6 offset:36864
    v_mfma_f32_32x32x16_bf16 a[176:191], v[124:127], v[104:107], a[176:191]
    ds_read_b128 v[76:79], v6 offset:38912
    v_mfma_f32_32x32x16_bf16 a[192:207], v[112:115], v[108:111], a[192:207]
    v_mfma_f32_32x32x16_bf16 a[208:223], v[116:119], v[108:111], a[208:223]
    v_mfma_f32_32x32x16_bf16 a[224:239], v[120:123], v[108:111], a[224:239]
    v_mfma_f32_32x32x16_bf16 a[240:255], v[124:127], v[108:111], a[240:255]
    s_waitcnt lgkmcnt(0)
    v_mfma_f32_32x32x16_bf16 a[0:15], v[80:83], v[64:67], a[0:15]
    ds_read_b128 v[96:99], v6 offset:33792
    v_mfma_f32_32x32x16_bf16 a[16:31], v[84:87], v[64:67], a[16:31]
    ds_read_b64_tr_b16 v[112:113], v48 offset:36864
    v_mfma_f32_32x32x16_bf16 a[32:47], v[88:91], v[64:67], a[32:47]
    ds_read_b64_tr_b16 v[114:115], v48 offset:37888
    v_mfma_f32_32x32x16_bf16 a[48:63], v[92:95], v[64:67], a[48:63]
    ds_read_b64_tr_b16 v[116:117], v49 offset:36864
    v_mfma_f32_32x32x16_bf16 a[64:79], v[80:83], v[68:71], a[64:79]
    ds_read_b64_tr_b16 v[118:119], v49 offset:37888
    v_mfma_f32_32x32x16_bf16 a[80:95], v[84:87], v[68:71], a[80:95]
    ds_read_b64_tr_b16 v[120:121], v48 offset:45056
    v_mfma_f32_32x32x16_bf16 a[96:111], v[88:91], v[68:71], a[96:111]
    ds_read_b64_tr_b16 v[122:123], v48 offset:46080
    v_mfma_f32_32x32x16_bf16 a[112:127], v[92:95], v[68:71], a[112:127]
    ds_read_b64_tr_b16 v[124:125], v49 offset:45056
    v_mfma_f32_32x32x16_bf16 a[128:143], v[80:83], v[72:75], a[128:143]
    ds_read_b64_tr_b16 v[126:127], v49 offset:46080
    v_mfma_f32_32x32x16_bf16 a[144:159], v[84:87], v[72:75], a[144:159]
    ds_read_b128 v[100:103], v6 offset:35840
    v_mfma_f32_32x32x16_bf16 a[160:175], v[88:91], v[72:75], a[160:175]
    ds_read_b128 v[104:107], v6 offset:37888
    v_mfma_f32_32x32x16_bf16 a[176:191], v[92:95], v[72:75], a[176:191]
    ds_read_b128 v[108:111], v6 offset:39936
    v_mfma_f32_32x32x16_bf16 a[192:207], v[80:83], v[76:79], a[192:207]
    v_mfma_f32_32x32x16_bf16 a[208:223], v[84:87], v[76:79], a[208:223]
    v_mfma_f32_32x32x16_bf16 a[224:239], v[88:91], v[76:79], a[224:239]
    v_mfma_f32_32x32x16_bf16 a[240:255], v[92:95], v[76:79], a[240:255]
    s_waitcnt vmcnt(8) lgkmcnt(0)
    s_barrier
    v_mfma_f32_32x32x16_bf16 a[0:15], v[112:115], v[96:99], a[0:15]
    ds_read_b128 v[64:67], v7 offset:0
    v_mfma_f32_32x32x16_bf16 a[16:31], v[116:119], v[96:99], a[16:31]
    ds_read_b64_tr_b16 v[80:81], v50 offset:0
    v_mfma_f32_32x32x16_bf16 a[32:47], v[120:123], v[96:99], a[32:47]
    ds_read_b64_tr_b16 v[82:83], v50 offset:1024
    v_mfma_f32_32x32x16_bf16 a[48:63], v[124:127], v[96:99], a[48:63]
    ds_read_b64_tr_b16 v[84:85], v51 offset:0
    v_mfma_f32_32x32x16_bf16 a[64:79], v[112:115], v[100:103], a[64:79]
    ds_read_b64_tr_b16 v[86:87], v51 offset:1024
    v_mfma_f32_32x32x16_bf16 a[80:95], v[116:119], v[100:103], a[80:95]
    ds_read_b64_tr_b16 v[88:89], v50 offset:8192
    v_mfma_f32_32x32x16_bf16 a[96:111], v[120:123], v[100:103], a[96:111]
    ds_read_b64_tr_b16 v[90:91], v50 offset:9216
    v_mfma_f32_32x32x16_bf16 a[112:127], v[124:127], v[100:103], a[112:127]
    ds_read_b64_tr_b16 v[92:93], v51 offset:8192
    v_mfma_f32_32x32x16_bf16 a[128:143], v[112:115], v[104:107], a[128:143]
    ds_read_b64_tr_b16 v[94:95], v51 offset:9216
    v_mfma_f32_32x32x16_bf16 a[144:159], v[116:119], v[104:107], a[144:159]
    ds_read_b128 v[68:71], v7 offset:2048
    v_mfma_f32_32x32x16_bf16 a[160:175], v[120:123], v[104:107], a[160:175]
    ds_read_b128 v[72:75], v7 offset:4096
    v_mfma_f32_32x32x16_bf16 a[176:191], v[124:127], v[104:107], a[176:191]
    ds_read_b128 v[76:79], v7 offset:6144
    v_mfma_f32_32x32x16_bf16 a[192:207], v[112:115], v[108:111], a[192:207]
    v_mfma_f32_32x32x16_bf16 a[208:223], v[116:119], v[108:111], a[208:223]
    v_mfma_f32_32x32x16_bf16 a[224:239], v[120:123], v[108:111], a[224:239]
    v_mfma_f32_32x32x16_bf16 a[240:255], v[124:127], v[108:111], a[240:255]
    s_waitcnt lgkmcnt(0)
    v_mfma_f32_32x32x16_bf16 a[0:15], v[80:83], v[64:67], a[0:15]
    ds_read_b128 v[96:99], v7 offset:1024
    v_mfma_f32_32x32x16_bf16 a[16:31], v[84:87], v[64:67], a[16:31]
    ds_read_b64_tr_b16 v[112:113], v50 offset:4096
    v_mfma_f32_32x32x16_bf16 a[32:47], v[88:91], v[64:67], a[32:47]
    ds_read_b64_tr_b16 v[114:115], v50 offset:5120
    v_mfma_f32_32x32x16_bf16 a[48:63], v[92:95], v[64:67], a[48:63]
    ds_read_b64_tr_b16 v[116:117], v51 offset:4096
    v_mfma_f32_32x32x16_bf16 a[64:79], v[80:83], v[68:71], a[64:79]
    ds_read_b64_tr_b16 v[118:119], v51 offset:5120
    v_mfma_f32_32x32x16_bf16 a[80:95], v[84:87], v[68:71], a[80:95]
    ds_read_b64_tr_b16 v[120:121], v50 offset:12288
    v_mfma_f32_32x32x16_bf16 a[96:111], v[88:91], v[68:71], a[96:111]
    ds_read_b64_tr_b16 v[122:123], v50 offset:13312
    v_mfma_f32_32x32x16_bf16 a[112:127], v[92:95], v[68:71], a[112:127]
    ds_read_b64_tr_b16 v[124:125], v51 offset:12288
    v_mfma_f32_32x32x16_bf16 a[128:143], v[80:83], v[72:75], a[128:143]
    ds_read_b64_tr_b16 v[126:127], v51 offset:13312
    v_mfma_f32_32x32x16_bf16 a[144:159], v[84:87], v[72:75], a[144:159]
    ds_read_b128 v[100:103], v7 offset:3072
    v_mfma_f32_32x32x16_bf16 a[160:175], v[88:91], v[72:75], a[160:175]
    ds_read_b128 v[104:107], v7 offset:5120
    v_mfma_f32_32x32x16_bf16 a[176:191], v[92:95], v[72:75], a[176:191]
    ds_read_b128 v[108:111], v7 offset:7168
    v_mfma_f32_32x32x16_bf16 a[192:207], v[80:83], v[76:79], a[192:207]
    v_mfma_f32_32x32x16_bf16 a[208:223], v[84:87], v[76:79], a[208:223]
    v_mfma_f32_32x32x16_bf16 a[224:239], v[88:91], v[76:79], a[224:239]
    v_mfma_f32_32x32x16_bf16 a[240:255], v[92:95], v[76:79], a[240:255]
    s_waitcnt vmcnt(0) lgkmcnt(0)
    s_barrier
    v_mfma_f32_32x32x16_bf16 a[0:15], v[112:115], v[96:99], a[0:15]
    ds_read_b128 v[64:67], v7 offset:32768
    v_mfma_f32_32x32x16_bf16 a[16:31], v[116:119], v[96:99], a[16:31]
    ds_read_b64_tr_b16 v[80:81], v50 offset:32768
    v_mfma_f32_32x32x16_bf16 a[32:47], v[120:123], v[96:99], a[32:47]
    ds_read_b64_tr_b16 v[82:83], v50 offset:33792
    v_mfma_f32_32x32x16_bf16 a[48:63], v[124:127], v[96:99], a[48:63]
    ds_read_b64_tr_b16 v[84:85], v51 offset:32768
    v_mfma_f32_32x32x16_bf16 a[64:79], v[112:115], v[100:103], a[64:79]
    ds_read_b64_tr_b16 v[86:87], v51 offset:33792
    v_mfma_f32_32x32x16_bf16 a[80:95], v[116:119], v[100:103], a[80:95]
    ds_read_b64_tr_b16 v[88:89], v50 offset:40960
    v_mfma_f32_32x32x16_bf16 a[96:111], v[120:123], v[100:103], a[96:111]
    ds_read_b64_tr_b16 v[90:91], v50 offset:41984
    v_mfma_f32_32x32x16_bf16 a[112:127], v[124:127], v[100:103], a[112:127]
    ds_read_b64_tr_b16 v[92:93], v51 offset:40960
    v_mfma_f32_32x32x16_bf16 a[128:143], v[112:115], v[104:107], a[128:143]
    ds_read_b64_tr_b16 v[94:95], v51 offset:41984
    v_mfma_f32_32x32x16_bf16 a[144:159], v[116:119], v[104:107], a[144:159]
    ds_read_b128 v[68:71], v7 offset:34816
    v_mfma_f32_32x32x16_bf16 a[160:175], v[120:123], v[104:107], a[160:175]
    ds_read_b128 v[72:75], v7 offset:36864
    v_mfma_f32_32x32x16_bf16 a[176:191], v[124:127], v[104:107], a[176:191]
    ds_read_b128 v[76:79], v7 offset:38912
    v_mfma_f32_32x32x16_bf16 a[192:207], v[112:115], v[108:111], a[192:207]
    v_mfma_f32_32x32x16_bf16 a[208:223], v[116:119], v[108:111], a[208:223]
    v_mfma_f32_32x32x16_bf16 a[224:239], v[120:123], v[108:111], a[224:239]
    v_mfma_f32_32x32x16_bf16 a[240:255], v[124:127], v[108:111], a[240:255]
    s_waitcnt lgkmcnt(0)
    v_mfma_f32_32x32x16_bf16 a[0:15], v[80:83], v[64:67], a[0:15]
    ds_read_b128 v[96:99], v7 offset:33792
    v_mfma_f32_32x32x16_bf16 a[16:31], v[84:87], v[64:67], a[16:31]
    ds_read_b64_tr_b16 v[112:113], v50 offset:36864
    v_mfma_f32_32x32x16_bf16 a[32:47], v[88:91], v[64:67], a[32:47]
    ds_read_b64_tr_b16 v[114:115], v50 offset:37888
    v_mfma_f32_32x32x16_bf16 a[48:63], v[92:95], v[64:67], a[48:63]
    ds_read_b64_tr_b16 v[116:117], v51 offset:36864
    v_mfma_f32_32x32x16_bf16 a[64:79], v[80:83], v[68:71], a[64:79]
    ds_read_b64_tr_b16 v[118:119], v51 offset:37888
    v_mfma_f32_32x32x16_bf16 a[80:95], v[84:87], v[68:71], a[80:95]
    ds_read_b64_tr_b16 v[120:121], v50 offset:45056
    v_mfma_f32_32x32x16_bf16 a[96:111], v[88:91], v[68:71], a[96:111]
    ds_read_b64_tr_b16 v[122:123], v50 offset:46080
    v_mfma_f32_32x32x16_bf16 a[112:127], v[92:95], v[68:71], a[112:127]
    ds_read_b64_tr_b16 v[124:125], v51 offset:45056
    v_mfma_f32_32x32x16_bf16 a[128:143], v[80:83], v[72:75], a[128:143]
    ds_read_b64_tr_b16 v[126:127], v51 offset:46080
    v_mfma_f32_32x32x16_bf16 a[144:159], v[84:87], v[72:75], a[144:159]
    ds_read_b128 v[100:103], v7 offset:35840
    v_mfma_f32_32x32x16_bf16 a[160:175], v[88:91], v[72:75], a[160:175]
    ds_read_b128 v[104:107], v7 offset:37888
    v_mfma_f32_32x32x16_bf16 a[176:191], v[92:95], v[72:75], a[176:191]
    ds_read_b128 v[108:111], v7 offset:39936
    v_mfma_f32_32x32x16_bf16 a[192:207], v[80:83], v[76:79], a[192:207]
    v_mfma_f32_32x32x16_bf16 a[208:223], v[84:87], v[76:79], a[208:223]
    v_mfma_f32_32x32x16_bf16 a[224:239], v[88:91], v[76:79], a[224:239]
    v_mfma_f32_32x32x16_bf16 a[240:255], v[92:95], v[76:79], a[240:255]
    s_waitcnt vmcnt(0) lgkmcnt(0)
    s_barrier
    v_mfma_f32_32x32x16_bf16 a[0:15], v[112:115], v[96:99], a[0:15]
    v_mfma_f32_32x32x16_bf16 a[16:31], v[116:119], v[96:99], a[16:31]
    v_mfma_f32_32x32x16_bf16 a[32:47], v[120:123], v[96:99], a[32:47]
    v_mfma_f32_32x32x16_bf16 a[48:63], v[124:127], v[96:99], a[48:63]
    v_mfma_f32_32x32x16_bf16 a[64:79], v[112:115], v[100:103], a[64:79]
    v_mfma_f32_32x32x16_bf16 a[80:95], v[116:119], v[100:103], a[80:95]
    v_mfma_f32_32x32x16_bf16 a[96:111], v[120:123], v[100:103], a[96:111]
    v_mfma_f32_32x32x16_bf16 a[112:127], v[124:127], v[100:103], a[112:127]
    v_mfma_f32_32x32x16_bf16 a[128:143], v[112:115], v[104:107], a[128:143]
    v_mfma_f32_32x32x16_bf16 a[144:159], v[116:119], v[104:107], a[144:159]
    v_mfma_f32_32x32x16_bf16 a[160:175], v[120:123], v[104:107], a[160:175]
    v_mfma_f32_32x32x16_bf16 a[176:191], v[124:127], v[104:107], a[176:191]
    v_mfma_f32_32x32x16_bf16 a[192:207], v[112:115], v[108:111], a[192:207]
    v_mfma_f32_32x32x16_bf16 a[208:223], v[116:119], v[108:111], a[208:223]
    v_mfma_f32_32x32x16_bf16 a[224:239], v[120:123], v[108:111], a[224:239]
    v_mfma_f32_32x32x16_bf16 a[240:255], v[124:127], v[108:111], a[240:255]
    s_nop 15
    s_cmp_eq_u32 s50, 2
    s_cbranch_scc1 ub_ffn_epi
    s_branch ub_qkv_epi
ub_v:
    s_add_u32 m0, s22, 0
    s_nop 0
    buffer_load_dwordx4 v1, s[8:11], s16 offen offset:0 sc1 lds
    buffer_load_dwordx4 v1, s[8:11], s16 offen offset:1024 sc1 lds
    buffer_load_dwordx4 v1, s[8:11], s17 offen offset:2048 sc1 lds
    buffer_load_dwordx4 v1, s[8:11], s17 offen offset:3072 sc1 lds
    s_add_u32 m0, s22, 16384
    s_add_u32 s16, s16, 2048
    buffer_load_dwordx4 v2, s[12:15], s18 offen offset:0 lds
    s_add_u32 s17, s17, 2048
    buffer_load_dwordx4 v3, s[12:15], s18 offen offset:1024 lds
    buffer_load_dwordx4 v4, s[12:15], s18 offen offset:2048 lds
    buffer_load_dwordx4 v5, s[12:15], s18 offen offset:3072 lds
    s_add_u32 s18, s18, s20
    s_add_u32 m0, s22, 32768
    s_nop 0
    buffer_load_dwordx4 v1, s[8:11], s16 offen offset:0 sc1 lds
    buffer_load_dwordx4 v1, s[8:11], s16 offen offset:1024 sc1 lds
    buffer_load_dwordx4 v1, s[8:11], s17 offen offset:2048 sc1 lds
    buffer_load_dwordx4 v1, s[8:11], s17 offen offset:3072 sc1 lds
    s_add_u32 m0, s22, 49152
    s_add_u32 s16, s16, 2048
    buffer_load_dwordx4 v2, s[12:15], s18 offen offset:0 lds
    s_add_u32 s17, s17, 2048
    buffer_load_dwordx4 v3, s[12:15], s18 offen offset:1024 lds
    buffer_load_dwordx4 v4, s[12:15], s18 offen offset:2048 lds
    buffer_load_dwordx4 v5, s[12:15], s18 offen offset:3072 lds
    s_add_u32 s18, s18, s20
    s_add_u32 m0, s22, 65536
    s_nop 0
    buffer_load_dwordx4 v1, s[8:11], s16 offen offset:0 sc1 lds
    buffer_load_dwordx4 v1, s[8:11], s16 offen offset:1024 sc1 lds
    buffer_load_dwordx4 v1, s[8:11], s17 offen offset:2048 sc1 lds
    buffer_load_dwordx4 v1, s[8:11], s17 offen offset:3072 sc1 lds
    s_add_u32 m0, s22, 81920
    s_add_u32 s16, s16, 2048
    buffer_load_dwordx4 v2, s[12:15], s18 offen offset:0 lds
    s_add_u32 s17, s17, 2048
    buffer_load_dwordx4 v3, s[12:15], s18 offen offset:1024 lds
    buffer_load_dwordx4 v4, s[12:15], s18 offen offset:2048 lds
    buffer_load_dwordx4 v5, s[12:15], s18 offen offset:3072 lds
    s_add_u32 s18, s18, s20
    s_add_u32 m0, s22, 98304
    s_nop 0
    buffer_load_dwordx4 v1, s[8:11], s16 offen offset:0 sc1 lds
    buffer_load_dwordx4 v1, s[8:11], s16 offen offset:1024 sc1 lds
    buffer_load_dwordx4 v1, s[8:11], s17 offen offset:2048 sc1 lds
    buffer_load_dwordx4 v1, s[8:11], s17 offen offset:3072 sc1 lds
    s_add_u32 m0, s22, 114688
    s_add_u32 s16, s16, 2048
    buffer_load_dwordx4 v2, s[12:15], s18 offen offset:0 lds
    s_add_u32 s17, s17, 2048
    buffer_load_dwordx4 v3, s[12:15], s18 offen offset:1024 lds
    buffer_load_dwordx4 v4, s[12:15], s18 offen offset:2048 lds
    buffer_load_dwordx4 v5, s[12:15], s18 offen offset:3072 lds
    s_add_u32 s18, s18, s20
    v_accvgpr_write_b32 a0, 0
    v_accvgpr_write_b32 a1, 0
    v_accvgpr_write_b32 a2, 0
    v_accvgpr_write_b32 a3, 0
    v_accvgpr_write_b32 a4, 0
    v_accvgpr_write_b32 a5, 0
    v_accvgpr_write_b32 a6, 0
    v_accvgpr_write_b32 a7, 0
    v_accvgpr_write_b32 a8, 0
    v_accvgpr_write_b32 a9, 0
    v_accvgpr_write_b32 a10, 0
    v_accvgpr_write_b32 a11, 0
    v_accvgpr_write_b32 a12, 0
    v_accvgpr_write_b32 a13, 0
    v_accvgpr_write_b32 a14, 0
    v_accvgpr_write_b32 a15, 0
    v_accvgpr_write_b32 a16, 0
    v_accvgpr_write_b32 a17, 0
    v_accvgpr_write_b32 a18, 0
    v_accvgpr_write_b32 a19, 0
    v_accvgpr_write_b32 a20, 0
    v_accvgpr_write_b32 a21, 0
    v_accvgpr_write_b32 a22, 0
    v_accvgpr_write_b32 a23, 0
    v_accvgpr_write_b32 a24, 0
    v_accvgpr_write_b32 a25, 0
    v_accvgpr_write_b32 a26, 0
    v_accvgpr_write_b32 a27, 0
    v_accvgpr_write_b32 a28, 0
    v_accvgpr_write_b32 a29, 0
    v_accvgpr_write_b32 a30, 0
    v_accvgpr_write_b32 a31, 0
    v_accvgpr_write_b32 a32, 0
    v_accvgpr_write_b32 a33, 0
    v_accvgpr_write_b32 a34, 0
    v_accvgpr_write_b32 a35, 0
    v_accvgpr_write_b32 a36, 0
    v_accvgpr_write_b32 a37, 0
    v_accvgpr_write_b32 a38, 0
    v_accvgpr_write_b32 a39, 0
    v_accvgpr_write_b32 a40, 0
    v_accvgpr_write_b32 a41, 0
    v_accvgpr_write_b32 a42, 0
    v_accvgpr_write_b32 a43, 0
    v_accvgpr_write_b32 a44, 0
    v_accvgpr_write_b32 a45, 0
    v_accvgpr_write_b32 a46, 0
    v_accvgpr_write_b32 a47, 0
    v_accvgpr_write_b32 a48, 0
    v_accvgpr_write_b32 a49, 0
    v_accvgpr_write_b32 a50, 0
    v_accvgpr_write_b32 a51, 0
    v_accvgpr_write_b32 a52, 0
    v_accvgpr_write_b32 a53, 0
    v_accvgpr_write_b32 a54, 0
    v_accvgpr_write_b32 a55, 0
    v_accvgpr_write_b32 a56, 0
    v_accvgpr_write_b32 a57, 0
    v_accvgpr_write_b32 a58, 0
    v_accvgpr_write_b32 a59, 0
    v_accvgpr_write_b32 a60, 0
    v_accvgpr_write_b32 a61, 0
    v_accvgpr_write_b32 a62, 0
    v_accvgpr_write_b32 a63, 0
    v_accvgpr_write_b32 a64, 0
    v_accvgpr_write_b32 a65, 0
    v_accvgpr_write_b32 a66, 0
    v_accvgpr_write_b32 a67, 0
    v_accvgpr_write_b32 a68, 0
    v_accvgpr_write_b32 a69, 0
    v_accvgpr_write_b32 a70, 0
    v_accvgpr_write_b32 a71, 0
    v_accvgpr_write_b32 a72, 0
    v_accvgpr_write_b32 a73, 0
    v_accvgpr_write_b32 a74, 0
    v_accvgpr_write_b32 a75, 0
    v_accvgpr_write_b32 a76, 0
    v_accvgpr_write_b32 a77, 0
    v_accvgpr_write_b32 a78, 0
    v_accvgpr_write_b32 a79, 0
    v_accvgpr_write_b32 a80, 0
    v_accvgpr_write_b32 a81, 0
    v_accvgpr_write_b32 a82, 0
    v_accvgpr_write_b32 a83, 0
    v_accvgpr_write_b32 a84, 0
    v_accvgpr_write_b32 a85, 0
    v_accvgpr_write_b32 a86, 0
    v_accvgpr_write_b32 a87, 0
    v_accvgpr_write_b32 a88, 0
    v_accvgpr_write_b32 a89, 0
    v_accvgpr_write_b32 a90, 0
    v_accvgpr_write_b32 a91, 0
    v_accvgpr_write_b32 a92, 0
    v_accvgpr_write_b32 a93, 0
    v_accvgpr_write_b32 a94, 0
    v_accvgpr_write_b32 a95, 0
    v_accvgpr_write_b32 a96, 0
    v_accvgpr_write_b32 a97, 0
    v_accvgpr_write_b32 a98, 0
    v_accvgpr_write_b32 a99, 0
    v_accvgpr_write_b32 a100, 0
    v_accvgpr_write_b32 a101, 0
    v_accvgpr_write_b32 a102, 0
    v_accvgpr_write_b32 a103, 0
    v_accvgpr_write_b32 a104, 0
    v_accvgpr_write_b32 a105, 0
    v_accvgpr_write_b32 a106, 0
    v_accvgpr_write_b32 a107, 0
    v_accvgpr_write_b32 a108, 0
    v_accvgpr_write_b32 a109, 0
    v_accvgpr_write_b32 a110, 0
    v_accvgpr_write_b32 a111, 0
    v_accvgpr_write_b32 a112, 0
    v_accvgpr_write_b32 a113, 0
    v_accvgpr_write_b32 a114, 0
    v_accvgpr_write_b32 a115, 0
    v_accvgpr_write_b32 a116, 0
    v_accvgpr_write_b32 a117, 0
    v_accvgpr_write_b32 a118, 0
    v_accvgpr_write_b32 a119, 0
    v_accvgpr_write_b32 a120, 0
    v_accvgpr_write_b32 a121, 0
    v_accvgpr_write_b32 a122, 0
    v_accvgpr_write_b32 a123, 0
    v_accvgpr_write_b32 a124, 0
    v_accvgpr_write_b32 a125, 0
    v_accvgpr_write_b32 a126, 0
    v_accvgpr_write_b32 a127, 0
    v_accvgpr_write_b32 a128, 0
    v_accvgpr_write_b32 a129, 0
    v_accvgpr_write_b32 a130, 0
    v_accvgpr_write_b32 a131, 0
    v_accvgpr_write_b32 a132, 0
    v_accvgpr_write_b32 a133, 0
    v_accvgpr_write_b32 a134, 0
    v_accvgpr_write_b32 a135, 0
    v_accvgpr_write_b32 a136, 0
    v_accvgpr_write_b32 a137, 0
    v_accvgpr_write_b32 a138, 0
    v_accvgpr_write_b32 a139, 0
    v_accvgpr_write_b32 a140, 0
    v_accvgpr_write_b32 a141, 0
    v_accvgpr_write_b32 a142, 0
    v_accvgpr_write_b32 a143, 0
    v_accvgpr_write_b32 a144, 0
    v_accvgpr_write_b32 a145, 0
    v_accvgpr_write_b32 a146, 0
    v_accvgpr_write_b32 a147, 0
    v_accvgpr_write_b32 a148, 0
    v_accvgpr_write_b32 a149, 0
    v_accvgpr_write_b32 a150, 0
    v_accvgpr_write_b32 a151, 0
    v_accvgpr_write_b32 a152, 0
    v_accvgpr_write_b32 a153, 0
    v_accvgpr_write_b32 a154, 0
    v_accvgpr_write_b32 a155, 0
    v_accvgpr_write_b32 a156, 0
    v_accvgpr_write_b32 a157, 0
    v_accvgpr_write_b32 a158, 0
    v_accvgpr_write_b32 a159, 0
    v_accvgpr_write_b32 a160, 0
    v_accvgpr_write_b32 a161, 0
    v_accvgpr_write_b32 a162, 0
    v_accvgpr_write_b32 a163, 0
    v_accvgpr_write_b32 a164, 0
    v_accvgpr_write_b32 a165, 0
    v_accvgpr_write_b32 a166, 0
    v_accvgpr_write_b32 a167, 0
    v_accvgpr_write_b32 a168, 0
    v_accvgpr_write_b32 a169, 0
    v_accvgpr_write_b32 a170, 0
    v_accvgpr_write_b32 a171, 0
    v_accvgpr_write_b32 a172, 0
    v_accvgpr_write_b32 a173, 0
    v_accvgpr_write_b32 a174, 0
    v_accvgpr_write_b32 a175, 0
    v_accvgpr_write_b32 a176, 0
    v_accvgpr_write_b32 a177, 0
    v_accvgpr_write_b32 a178, 0
    v_accvgpr_write_b32 a179, 0
    v_accvgpr_write_b32 a180, 0
    v_accvgpr_write_b32 a181, 0
    v_accvgpr_write_b32 a182, 0
    v_accvgpr_write_b32 a183, 0
    v_accvgpr_write_b32 a184, 0
    v_accvgpr_write_b32 a185, 0
    v_accvgpr_write_b32 a186, 0
    v_accvgpr_write_b32 a187, 0
    v_accvgpr_write_b32 a188, 0
    v_accvgpr_write_b32 a189, 0
    v_accvgpr_write_b32 a190, 0
    v_accvgpr_write_b32 a191, 0
    v_accvgpr_write_b32 a192, 0
    v_accvgpr_write_b32 a193, 0
    v_accvgpr_write_b32 a194, 0
    v_accvgpr_write_b32 a195, 0
    v_accvgpr_write_b32 a196, 0
    v_accvgpr_write_b32 a197, 0
    v_accvgpr_write_b32 a198, 0
    v_accvgpr_write_b32 a199, 0
    v_accvgpr_write_b32 a200, 0
    v_accvgpr_write_b32 a201, 0
    v_accvgpr_write_b32 a202, 0
    v_accvgpr_write_b32 a203, 0
    v_accvgpr_write_b32 a204, 0
    v_accvgpr_write_b32 a205, 0
    v_accvgpr_write_b32 a206, 0
    v_accvgpr_write_b32 a207, 0
    v_accvgpr_write_b32 a208, 0
    v_accvgpr_write_b32 a209, 0
    v_accvgpr_write_b32 a210, 0
    v_accvgpr_write_b32 a211, 0
    v_accvgpr_write_b32 a212, 0
    v_accvgpr_write_b32 a213, 0
    v_accvgpr_write_b32 a214, 0
    v_accvgpr_write_b32 a215, 0
    v_accvgpr_write_b32 a216, 0
    v_accvgpr_write_b32 a217, 0
    v_accvgpr_write_b32 a218, 0
    v_accvgpr_write_b32 a219, 0
    v_accvgpr_write_b32 a220, 0
    v_accvgpr_write_b32 a221, 0
    v_accvgpr_write_b32 a222, 0
    v_accvgpr_write_b32 a223, 0
    v_accvgpr_write_b32 a224, 0
    v_accvgpr_write_b32 a225, 0
    v_accvgpr_write_b32 a226, 0
    v_accvgpr_write_b32 a227, 0
    v_accvgpr_write_b32 a228, 0
    v_accvgpr_write_b32 a229, 0
    v_accvgpr_write_b32 a230, 0
    v_accvgpr_write_b32 a231, 0
    v_accvgpr_write_b32 a232, 0
    v_accvgpr_write_b32 a233, 0
    v_accvgpr_write_b32 a234, 0
    v_accvgpr_write_b32 a235, 0
    v_accvgpr_write_b32 a236, 0
    v_accvgpr_write_b32 a237, 0
    v_accvgpr_write_b32 a238, 0
    v_accvgpr_write_b32 a239, 0
    v_accvgpr_write_b32 a240, 0
    v_accvgpr_write_b32 a241, 0
    v_accvgpr_write_b32 a242, 0
    v_accvgpr_write_b32 a243, 0
    v_accvgpr_write_b32 a244, 0
    v_accvgpr_write_b32 a245, 0
    v_accvgpr_write_b32 a246, 0
    v_accvgpr_write_b32 a247, 0
    v_accvgpr_write_b32 a248, 0
    v_accvgpr_write_b32 a249, 0
    v_accvgpr_write_b32 a250, 0
    v_accvgpr_write_b32 a251, 0
    v_accvgpr_write_b32 a252, 0
    v_accvgpr_write_b32 a253, 0
    v_accvgpr_write_b32 a254, 0
    v_accvgpr_write_b32 a255, 0
    s_waitcnt vmcnt(24)
    s_barrier
    ds_read_b128 v[64:67], v6 offset:0
    ds_read_b64_tr_b16 v[80:81], v48 offset:0
    ds_read_b64_tr_b16 v[82:83], v48 offset:1024
    ds_read_b64_tr_b16 v[84:85], v49 offset:0
    ds_read_b64_tr_b16 v[86:87], v49 offset:1024
    ds_read_b64_tr_b16 v[88:89], v48 offset:8192
    ds_read_b64_tr_b16 v[90:91], v48 offset:9216
    ds_read_b64_tr_b16 v[92:93], v49 offset:8192
    ds_read_b64_tr_b16 v[94:95], v49 offset:9216
    ds_read_b128 v[68:71], v6 offset:2048
    ds_read_b128 v[72:75], v6 offset:4096
    ds_read_b128 v[76:79], v6 offset:6144
    s_waitcnt lgkmcnt(0)
    s_mov_b32 s21, 7
.p2align 6
uv_loop_13:
    v_mfma_f32_32x32x16_bf16 a[0:15], v[64:67], v[80:83], a[0:15]
    ds_read_b128 v[96:99], v6 offset:1024
    v_mfma_f32_32x32x16_bf16 a[16:31], v[64:67], v[84:87], a[16:31]
    ds_read_b64_tr_b16 v[112:113], v48 offset:4096
    v_mfma_f32_32x32x16_bf16 a[32:47], v[64:67], v[88:91], a[32:47]
    ds_read_b64_tr_b16 v[114:115], v48 offset:5120
    v_mfma_f32_32x32x16_bf16 a[48:63], v[64:67], v[92:95], a[48:63]
    ds_read_b64_tr_b16 v[116:117], v49 offset:4096
    v_mfma_f32_32x32x16_bf16 a[64:79], v[68:71], v[80:83], a[64:79]
    ds_read_b64_tr_b16 v[118:119], v49 offset:5120
    v_mfma_f32_32x32x16_bf16 a[80:95], v[68:71], v[84:87], a[80:95]
    ds_read_b64_tr_b16 v[120:121], v48 offset:12288
    v_mfma_f32_32x32x16_bf16 a[96:111], v[68:71], v[88:91], a[96:111]
    ds_read_b64_tr_b16 v[122:123], v48 offset:13312
    v_mfma_f32_32x32x16_bf16 a[112:127], v[68:71], v[92:95], a[112:127]
    ds_read_b64_tr_b16 v[124:125], v49 offset:12288
    v_mfma_f32_32x32x16_bf16 a[128:143], v[72:75], v[80:83], a[128:143]
    ds_read_b64_tr_b16 v[126:127], v49 offset:13312
    v_mfma_f32_32x32x16_bf16 a[144:159], v[72:75], v[84:87], a[144:159]
    ds_read_b128 v[100:103], v6 offset:3072
    v_mfma_f32_32x32x16_bf16 a[160:175], v[72:75], v[88:91], a[160:175]
    ds_read_b128 v[104:107], v6 offset:5120
    v_mfma_f32_32x32x16_bf16 a[176:191], v[72:75], v[92:95], a[176:191]
    ds_read_b128 v[108:111], v6 offset:7168
    v_mfma_f32_32x32x16_bf16 a[192:207], v[76:79], v[80:83], a[192:207]
    v_mfma_f32_32x32x16_bf16 a[208:223], v[76:79], v[84:87], a[208:223]
    v_mfma_f32_32x32x16_bf16 a[224:239], v[76:79], v[88:91], a[224:239]
    v_mfma_f32_32x32x16_bf16 a[240:255], v[76:79], v[92:95], a[240:255]
    s_waitcnt vmcnt(16) lgkmcnt(0)
    s_barrier
    v_mfma_f32_32x32x16_bf16 a[0:15], v[96:99], v[112:115], a[0:15]
    ds_read_b128 v[64:67], v6 offset:32768
    v_mfma_f32_32x32x16_bf16 a[16:31], v[96:99], v[116:119], a[16:31]
    ds_read_b64_tr_b16 v[80:81], v48 offset:32768
    s_add_u32 m0, s22, 0
    s_nop 0
    buffer_load_dwordx4 v1, s[8:11], s16 offen offset:0 sc1 lds
    v_mfma_f32_32x32x16_bf16 a[32:47], v[96:99], v[120:123], a[32:47]
    ds_read_b64_tr_b16 v[82:83], v48 offset:33792
    v_mfma_f32_32x32x16_bf16 a[48:63], v[96:99], v[124:127], a[48:63]
    ds_read_b64_tr_b16 v[84:85], v49 offset:32768
    buffer_load_dwordx4 v1, s[8:11], s16 offen offset:1024 sc1 lds
    v_mfma_f32_32x32x16_bf16 a[64:79], v[100:103], v[112:115], a[64:79]
    ds_read_b64_tr_b16 v[86:87], v49 offset:33792
    v_mfma_f32_32x32x16_bf16 a[80:95], v[100:103], v[116:119], a[80:95]
    ds_read_b64_tr_b16 v[88:89], v48 offset:40960
    buffer_load_dwordx4 v1, s[8:11], s17 offen offset:2048 sc1 lds
    v_mfma_f32_32x32x16_bf16 a[96:111], v[100:103], v[120:123], a[96:111]
    ds_read_b64_tr_b16 v[90:91], v48 offset:41984
    v_mfma_f32_32x32x16_bf16 a[112:127], v[100:103], v[124:127], a[112:127]
    ds_read_b64_tr_b16 v[92:93], v49 offset:40960
    buffer_load_dwordx4 v1, s[8:11], s17 offen offset:3072 sc1 lds
    s_add_u32 m0, s22, 16384
    s_add_u32 s16, s16, 2048
    v_mfma_f32_32x32x16_bf16 a[128:143], v[104:107], v[112:115], a[128:143]
    ds_read_b64_tr_b16 v[94:95], v49 offset:41984
    v_mfma_f32_32x32x16_bf16 a[144:159], v[104:107], v[116:119], a[144:159]
    ds_read_b128 v[68:71], v6 offset:34816
    buffer_load_dwordx4 v2, s[12:15], s18 offen offset:0 lds
    s_add_u32 s17, s17, 2048
    v_mfma_f32_32x32x16_bf16 a[160:175], v[104:107], v[120:123], a[160:175]
    ds_read_b128 v[72:75], v6 offset:36864
    v_mfma_f32_32x32x16_bf16 a[176:191], v[104:107], v[124:127], a[176:191]
    ds_read_b128 v[76:79], v6 offset:38912
    buffer_load_dwordx4 v3, s[12:15], s18 offen offset:1024 lds
    v_mfma_f32_32x32x16_bf16 a[192:207], v[108:111], v[112:115], a[192:207]
    v_mfma_f32_32x32x16_bf16 a[208:223], v[108:111], v[116:119], a[208:223]
    buffer_load_dwordx4 v4, s[12:15], s18 offen offset:2048 lds
    v_mfma_f32_32x32x16_bf16 a[224:239], v[108:111], v[120:123], a[224:239]
    v_mfma_f32_32x32x16_bf16 a[240:255], v[108:111], v[124:127], a[240:255]
    buffer_load_dwordx4 v5, s[12:15], s18 offen offset:3072 lds
    s_add_u32 s18, s18, s20
    s_waitcnt lgkmcnt(0)
    v_mfma_f32_32x32x16_bf16 a[0:15], v[64:67], v[80:83], a[0:15]
    ds_read_b128 v[96:99], v6 offset:33792
    v_mfma_f32_32x32x16_bf16 a[16:31], v[64:67], v[84:87], a[16:31]
    ds_read_b64_tr_b16 v[112:113], v48 offset:36864
    v_mfma_f32_32x32x16_bf16 a[32:47], v[64:67], v[88:91], a[32:47]
    ds_read_b64_tr_b16 v[114:115], v48 offset:37888
    v_mfma_f32_32x32x16_bf16 a[48:63], v[64:67], v[92:95], a[48:63]
    ds_read_b64_tr_b16 v[116:117], v49 offset:36864
    v_mfma_f32_32x32x16_bf16 a[64:79], v[68:71], v[80:83], a[64:79]
    ds_read_b64_tr_b16 v[118:119], v49 offset:37888
    v_mfma_f32_32x32x16_bf16 a[80:95], v[68:71], v[84:87], a[80:95]
    ds_read_b64_tr_b16 v[120:121], v48 offset:45056
    v_mfma_f32_32x32x16_bf16 a[96:111], v[68:71], v[88:91], a[96:111]
    ds_read_b64_tr_b16 v[122:123], v48 offset:46080
    v_mfma_f32_32x32x16_bf16 a[112:127], v[68:71], v[92:95], a[112:127]
    ds_read_b64_tr_b16 v[124:125], v49 offset:45056
    v_mfma_f32_32x32x16_bf16 a[128:143], v[72:75], v[80:83], a[128:143]
    ds_read_b64_tr_b16 v[126:127], v49 offset:46080
    v_mfma_f32_32x32x16_bf16 a[144:159], v[72:75], v[84:87], a[144:159]
    ds_read_b128 v[100:103], v6 offset:35840
    v_mfma_f32_32x32x16_bf16 a[160:175], v[72:75], v[88:91], a[160:175]
    ds_read_b128 v[104:107], v6 offset:37888
    v_mfma_f32_32x32x16_bf16 a[176:191], v[72:75], v[92:95], a[176:191]
    ds_read_b128 v[108:111], v6 offset:39936
    v_mfma_f32_32x32x16_bf16 a[192:207], v[76:79], v[80:83], a[192:207]
    v_mfma_f32_32x32x16_bf16 a[208:223], v[76:79], v[84:87], a[208:223]
    v_mfma_f32_32x32x16_bf16 a[224:239], v[76:79], v[88:91], a[224:239]
    v_mfma_f32_32x32x16_bf16 a[240:255], v[76:79], v[92:95], a[240:255]
    s_waitcnt vmcnt(16) lgkmcnt(0)
    s_barrier
    v_mfma_f32_32x32x16_bf16 a[0:15], v[96:99], v[112:115], a[0:15]
    ds_read_b128 v[64:67], v7 offset:0
    v_mfma_f32_32x32x16_bf16 a[16:31], v[96:99], v[116:119], a[16:31]
    ds_read_b64_tr_b16 v[80:81], v50 offset:0
    s_add_u32 m0, s22, 32768
    s_nop 0
    buffer_load_dwordx4 v1, s[8:11], s16 offen offset:0 sc1 lds
    v_mfma_f32_32x32x16_bf16 a[32:47], v[96:99], v[120:123], a[32:47]
    ds_read_b64_tr_b16 v[82:83], v50 offset:1024
    v_mfma_f32_32x32x16_bf16 a[48:63], v[96:99], v[124:127], a[48:63]
    ds_read_b64_tr_b16 v[84:85], v51 offset:0
    buffer_load_dwordx4 v1, s[8:11], s16 offen offset:1024 sc1 lds
    v_mfma_f32_32x32x16_bf16 a[64:79], v[100:103], v[112:115], a[64:79]
    ds_read_b64_tr_b16 v[86:87], v51 offset:1024
    v_mfma_f32_32x32x16_bf16 a[80:95], v[100:103], v[116:119], a[80:95]
    ds_read_b64_tr_b16 v[88:89], v50 offset:8192
    buffer_load_dwordx4 v1, s[8:11], s17 offen offset:2048 sc1 lds
    v_mfma_f32_32x32x16_bf16 a[96:111], v[100:103], v[120:123], a[96:111]
    ds_read_b64_tr_b16 v[90:91], v50 offset:9216
    v_mfma_f32_32x32x16_bf16 a[112:127], v[100:103], v[124:127], a[112:127]
    ds_read_b64_tr_b16 v[92:93], v51 offset:8192
    buffer_load_dwordx4 v1, s[8:11], s17 offen offset:3072 sc1 lds
    s_add_u32 m0, s22, 49152
    s_add_u32 s16, s16, 2048
    v_mfma_f32_32x32x16_bf16 a[128:143], v[104:107], v[112:115], a[128:143]
    ds_read_b64_tr_b16 v[94:95], v51 offset:9216
    v_mfma_f32_32x32x16_bf16 a[144:159], v[104:107], v[116:119], a[144:159]
    ds_read_b128 v[68:71], v7 offset:2048
    buffer_load_dwordx4 v2, s[12:15], s18 offen offset:0 lds
    s_add_u32 s17, s17, 2048
    v_mfma_f32_32x32x16_bf16 a[160:175], v[104:107], v[120:123], a[160:175]
    ds_read_b128 v[72:75], v7 offset:4096
    v_mfma_f32_32x32x16_bf16 a[176:191], v[104:107], v[124:127], a[176:191]
    ds_read_b128 v[76:79], v7 offset:6144
    buffer_load_dwordx4 v3, s[12:15], s18 offen offset:1024 lds
    v_mfma_f32_32x32x16_bf16 a[192:207], v[108:111], v[112:115], a[192:207]
    v_mfma_f32_32x32x16_bf16 a[208:223], v[108:111], v[116:119], a[208:223]
    buffer_load_dwordx4 v4, s[12:15], s18 offen offset:2048 lds
    v_mfma_f32_32x32x16_bf16 a[224:239], v[108:111], v[120:123], a[224:239]
    v_mfma_f32_32x32x16_bf16 a[240:255], v[108:111], v[124:127], a[240:255]
    buffer_load_dwordx4 v5, s[12:15], s18 offen offset:3072 lds
    s_add_u32 s18, s18, s20
    s_waitcnt lgkmcnt(0)
    v_mfma_f32_32x32x16_bf16 a[0:15], v[64:67], v[80:83], a[0:15]
    ds_read_b128 v[96:99], v7 offset:1024
    v_mfma_f32_32x32x16_bf16 a[16:31], v[64:67], v[84:87], a[16:31]
    ds_read_b64_tr_b16 v[112:113], v50 offset:4096
    v_mfma_f32_32x32x16_bf16 a[32:47], v[64:67], v[88:91], a[32:47]
    ds_read_b64_tr_b16 v[114:115], v50 offset:5120
    v_mfma_f32_32x32x16_bf16 a[48:63], v[64:67], v[92:95], a[48:63]
    ds_read_b64_tr_b16 v[116:117], v51 offset:4096
    v_mfma_f32_32x32x16_bf16 a[64:79], v[68:71], v[80:83], a[64:79]
    ds_read_b64_tr_b16 v[118:119], v51 offset:5120
    v_mfma_f32_32x32x16_bf16 a[80:95], v[68:71], v[84:87], a[80:95]
    ds_read_b64_tr_b16 v[120:121], v50 offset:12288
    v_mfma_f32_32x32x16_bf16 a[96:111], v[68:71], v[88:91], a[96:111]
    ds_read_b64_tr_b16 v[122:123], v50 offset:13312
    v_mfma_f32_32x32x16_bf16 a[112:127], v[68:71], v[92:95], a[112:127]
    ds_read_b64_tr_b16 v[124:125], v51 offset:12288
    v_mfma_f32_32x32x16_bf16 a[128:143], v[72:75], v[80:83], a[128:143]
    ds_read_b64_tr_b16 v[126:127], v51 offset:13312
    v_mfma_f32_32x32x16_bf16 a[144:159], v[72:75], v[84:87], a[144:159]
    ds_read_b128 v[100:103], v7 offset:3072
    v_mfma_f32_32x32x16_bf16 a[160:175], v[72:75], v[88:91], a[160:175]
    ds_read_b128 v[104:107], v7 offset:5120
    v_mfma_f32_32x32x16_bf16 a[176:191], v[72:75], v[92:95], a[176:191]
    ds_read_b128 v[108:111], v7 offset:7168
    v_mfma_f32_32x32x16_bf16 a[192:207], v[76:79], v[80:83], a[192:207]
    v_mfma_f32_32x32x16_bf16 a[208:223], v[76:79], v[84:87], a[208:223]
    v_mfma_f32_32x32x16_bf16 a[224:239], v[76:79], v[88:91], a[224:239]
    v_mfma_f32_32x32x16_bf16 a[240:255], v[76:79], v[92:95], a[240:255]
    s_waitcnt vmcnt(16) lgkmcnt(0)
    s_barrier
    v_mfma_f32_32x32x16_bf16 a[0:15], v[96:99], v[112:115], a[0:15]
    ds_read_b128 v[64:67], v7 offset:32768
    v_mfma_f32_32x32x16_bf16 a[16:31], v[96:99], v[116:119], a[16:31]
    ds_read_b64_tr_b16 v[80:81], v50 offset:32768
    s_add_u32 m0, s22, 65536
    s_nop 0
    buffer_load_dwordx4 v1, s[8:11], s16 offen offset:0 sc1 lds
    v_mfma_f32_32x32x16_bf16 a[32:47], v[96:99], v[120:123], a[32:47]
    ds_read_b64_tr_b16 v[82:83], v50 offset:33792
    v_mfma_f32_32x32x16_bf16 a[48:63], v[96:99], v[124:127], a[48:63]
    ds_read_b64_tr_b16 v[84:85], v51 offset:32768
    buffer_load_dwordx4 v1, s[8:11], s16 offen offset:1024 sc1 lds
    v_mfma_f32_32x32x16_bf16 a[64:79], v[100:103], v[112:115], a[64:79]
    ds_read_b64_tr_b16 v[86:87], v51 offset:33792
    v_mfma_f32_32x32x16_bf16 a[80:95], v[100:103], v[116:119], a[80:95]
    ds_read_b64_tr_b16 v[88:89], v50 offset:40960
    buffer_load_dwordx4 v1, s[8:11], s17 offen offset:2048 sc1 lds
    v_mfma_f32_32x32x16_bf16 a[96:111], v[100:103], v[120:123], a[96:111]
    ds_read_b64_tr_b16 v[90:91], v50 offset:41984
    v_mfma_f32_32x32x16_bf16 a[112:127], v[100:103], v[124:127], a[112:127]
    ds_read_b64_tr_b16 v[92:93], v51 offset:40960
    buffer_load_dwordx4 v1, s[8:11], s17 offen offset:3072 sc1 lds
    s_add_u32 m0, s22, 81920
    s_add_u32 s16, s16, 2048
    v_mfma_f32_32x32x16_bf16 a[128:143], v[104:107], v[112:115], a[128:143]
    ds_read_b64_tr_b16 v[94:95], v51 offset:41984
    v_mfma_f32_32x32x16_bf16 a[144:159], v[104:107], v[116:119], a[144:159]
    ds_read_b128 v[68:71], v7 offset:34816
    buffer_load_dwordx4 v2, s[12:15], s18 offen offset:0 lds
    s_add_u32 s17, s17, 2048
    v_mfma_f32_32x32x16_bf16 a[160:175], v[104:107], v[120:123], a[160:175]
    ds_read_b128 v[72:75], v7 offset:36864
    v_mfma_f32_32x32x16_bf16 a[176:191], v[104:107], v[124:127], a[176:191]
    ds_read_b128 v[76:79], v7 offset:38912
    buffer_load_dwordx4 v3, s[12:15], s18 offen offset:1024 lds
    v_mfma_f32_32x32x16_bf16 a[192:207], v[108:111], v[112:115], a[192:207]
    v_mfma_f32_32x32x16_bf16 a[208:223], v[108:111], v[116:119], a[208:223]
    buffer_load_dwordx4 v4, s[12:15], s18 offen offset:2048 lds
    v_mfma_f32_32x32x16_bf16 a[224:239], v[108:111], v[120:123], a[224:239]
    v_mfma_f32_32x32x16_bf16 a[240:255], v[108:111], v[124:127], a[240:255]
    buffer_load_dwordx4 v5, s[12:15], s18 offen offset:3072 lds
    s_add_u32 s18, s18, s20
    s_waitcnt lgkmcnt(0)
    v_mfma_f32_32x32x16_bf16 a[0:15], v[64:67], v[80:83], a[0:15]
    ds_read_b128 v[96:99], v7 offset:33792
    v_mfma_f32_32x32x16_bf16 a[16:31], v[64:67], v[84:87], a[16:31]
    ds_read_b64_tr_b16 v[112:113], v50 offset:36864
    v_mfma_f32_32x32x16_bf16 a[32:47], v[64:67], v[88:91], a[32:47]
    ds_read_b64_tr_b16 v[114:115], v50 offset:37888
    v_mfma_f32_32x32x16_bf16 a[48:63], v[64:67], v[92:95], a[48:63]
    ds_read_b64_tr_b16 v[116:117], v51 offset:36864
    v_mfma_f32_32x32x16_bf16 a[64:79], v[68:71], v[80:83], a[64:79]
    ds_read_b64_tr_b16 v[118:119], v51 offset:37888
    v_mfma_f32_32x32x16_bf16 a[80:95], v[68:71], v[84:87], a[80:95]
    ds_read_b64_tr_b16 v[120:121], v50 offset:45056
    v_mfma_f32_32x32x16_bf16 a[96:111], v[68:71], v[88:91], a[96:111]
    ds_read_b64_tr_b16 v[122:123], v50 offset:46080
    v_mfma_f32_32x32x16_bf16 a[112:127], v[68:71], v[92:95], a[112:127]
    ds_read_b64_tr_b16 v[124:125], v51 offset:45056
    v_mfma_f32_32x32x16_bf16 a[128:143], v[72:75], v[80:83], a[128:143]
    ds_read_b64_tr_b16 v[126:127], v51 offset:46080
    v_mfma_f32_32x32x16_bf16 a[144:159], v[72:75], v[84:87], a[144:159]
    ds_read_b128 v[100:103], v7 offset:35840
    v_mfma_f32_32x32x16_bf16 a[160:175], v[72:75], v[88:91], a[160:175]
    ds_read_b128 v[104:107], v7 offset:37888
    v_mfma_f32_32x32x16_bf16 a[176:191], v[72:75], v[92:95], a[176:191]
    ds_read_b128 v[108:111], v7 offset:39936
    v_mfma_f32_32x32x16_bf16 a[192:207], v[76:79], v[80:83], a[192:207]
    v_mfma_f32_32x32x16_bf16 a[208:223], v[76:79], v[84:87], a[208:223]
    v_mfma_f32_32x32x16_bf16 a[224:239], v[76:79], v[88:91], a[224:239]
    v_mfma_f32_32x32x16_bf16 a[240:255], v[76:79], v[92:95], a[240:255]
    s_waitcnt vmcnt(16) lgkmcnt(0)
    s_barrier
    v_mfma_f32_32x32x16_bf16 a[0:15], v[96:99], v[112:115], a[0:15]
    ds_read_b128 v[64:67], v6 offset:0
    v_mfma_f32_32x32x16_bf16 a[16:31], v[96:99], v[116:119], a[16:31]
    ds_read_b64_tr_b16 v[80:81], v48 offset:0
    s_add_u32 m0, s22, 98304
    s_nop 0
    buffer_load_dwordx4 v1, s[8:11], s16 offen offset:0 sc1 lds
    v_mfma_f32_32x32x16_bf16 a[32:47], v[96:99], v[120:123], a[32:47]
    ds_read_b64_tr_b16 v[82:83], v48 offset:1024
    v_mfma_f32_32x32x16_bf16 a[48:63], v[96:99], v[124:127], a[48:63]
    ds_read_b64_tr_b16 v[84:85], v49 offset:0
    buffer_load_dwordx4 v1, s[8:11], s16 offen offset:1024 sc1 lds
    v_mfma_f32_32x32x16_bf16 a[64:79], v[100:103], v[112:115], a[64:79]
    ds_read_b64_tr_b16 v[86:87], v49 offset:1024
    v_mfma_f32_32x32x16_bf16 a[80:95], v[100:103], v[116:119], a[80:95]
    ds_read_b64_tr_b16 v[88:89], v48 offset:8192
    buffer_load_dwordx4 v1, s[8:11], s17 offen offset:2048 sc1 lds
    v_mfma_f32_32x32x16_bf16 a[96:111], v[100:103], v[120:123], a[96:111]
    ds_read_b64_tr_b16 v[90:91], v48 offset:9216
    v_mfma_f32_32x32x16_bf16 a[112:127], v[100:103], v[124:127], a[112:127]
    ds_read_b64_tr_b16 v[92:93], v49 offset:8192
    buffer_load_dwordx4 v1, s[8:11], s17 offen offset:3072 sc1 lds
    s_add_u32 m0, s22, 114688
    s_add_u32 s16, s16, 2048
    v_mfma_f32_32x32x16_bf16 a[128:143], v[104:107], v[112:115], a[128:143]
    ds_read_b64_tr_b16 v[94:95], v49 offset:9216
    v_mfma_f32_32x32x16_bf16 a[144:159], v[104:107], v[116:119], a[144:159]
    ds_read_b128 v[68:71], v6 offset:2048
    buffer_load_dwordx4 v2, s[12:15], s18 offen offset:0 lds
    s_add_u32 s17, s17, 2048
    v_mfma_f32_32x32x16_bf16 a[160:175], v[104:107], v[120:123], a[160:175]
    ds_read_b128 v[72:75], v6 offset:4096
    v_mfma_f32_32x32x16_bf16 a[176:191], v[104:107], v[124:127], a[176:191]
    ds_read_b128 v[76:79], v6 offset:6144
    buffer_load_dwordx4 v3, s[12:15], s18 offen offset:1024 lds
    v_mfma_f32_32x32x16_bf16 a[192:207], v[108:111], v[112:115], a[192:207]
    v_mfma_f32_32x32x16_bf16 a[208:223], v[108:111], v[116:119], a[208:223]
    buffer_load_dwordx4 v4, s[12:15], s18 offen offset:2048 lds
    v_mfma_f32_32x32x16_bf16 a[224:239], v[108:111], v[120:123], a[224:239]
    v_mfma_f32_32x32x16_bf16 a[240:255], v[108:111], v[124:127], a[240:255]
    buffer_load_dwordx4 v5, s[12:15], s18 offen offset:3072 lds
    s_add_u32 s18, s18, s20
    s_waitcnt lgkmcnt(0)
    s_sub_u32 s21, s21, 1
    s_cmp_lg_u32 s21, 0
    s_cbranch_scc1 uv_loop_13
    v_mfma_f32_32x32x16_bf16 a[0:15], v[64:67], v[80:83], a[0:15]
    ds_read_b128 v[96:99], v6 offset:1024
    v_mfma_f32_32x32x16_bf16 a[16:31], v[64:67], v[84:87], a[16:31]
    ds_read_b64_tr_b16 v[112:113], v48 offset:4096
    v_mfma_f32_32x32x16_bf16 a[32:47], v[64:67], v[88:91], a[32:47]
    ds_read_b64_tr_b16 v[114:115], v48 offset:5120
    v_mfma_f32_32x32x16_bf16 a[48:63], v[64:67], v[92:95], a[48:63]
    ds_read_b64_tr_b16 v[116:117], v49 offset:4096
    v_mfma_f32_32x32x16_bf16 a[64:79], v[68:71], v[80:83], a[64:79]
    ds_read_b64_tr_b16 v[118:119], v49 offset:5120
    v_mfma_f32_32x32x16_bf16 a[80:95], v[68:71], v[84:87], a[80:95]
    ds_read_b64_tr_b16 v[120:121], v48 offset:12288
    v_mfma_f32_32x32x16_bf16 a[96:111], v[68:71], v[88:91], a[96:111]
    ds_read_b64_tr_b16 v[122:123], v48 offset:13312
    v_mfma_f32_32x32x16_bf16 a[112:127], v[68:71], v[92:95], a[112:127]
    ds_read_b64_tr_b16 v[124:125], v49 offset:12288
    v_mfma_f32_32x32x16_bf16 a[128:143], v[72:75], v[80:83], a[128:143]
    ds_read_b64_tr_b16 v[126:127], v49 offset:13312
    v_mfma_f32_32x32x16_bf16 a[144:159], v[72:75], v[84:87], a[144:159]
    ds_read_b128 v[100:103], v6 offset:3072
    v_mfma_f32_32x32x16_bf16 a[160:175], v[72:75], v[88:91], a[160:175]
    ds_read_b128 v[104:107], v6 offset:5120
    v_mfma_f32_32x32x16_bf16 a[176:191], v[72:75], v[92:95], a[176:191]
    ds_read_b128 v[108:111], v6 offset:7168
    v_mfma_f32_32x32x16_bf16 a[192:207], v[76:79], v[80:83], a[192:207]
    v_mfma_f32_32x32x16_bf16 a[208:223], v[76:79], v[84:87], a[208:223]
    v_mfma_f32_32x32x16_bf16 a[224:239], v[76:79], v[88:91], a[224:239]
    v_mfma_f32_32x32x16_bf16 a[240:255], v[76:79], v[92:95], a[240:255]
    s_waitcnt vmcnt(16) lgkmcnt(0)
    s_barrier
    v_mfma_f32_32x32x16_bf16 a[0:15], v[96:99], v[112:115], a[0:15]
    ds_read_b128 v[64:67], v6 offset:32768
    v_mfma_f32_32x32x16_bf16 a[16:31], v[96:99], v[116:119], a[16:31]
    ds_read_b64_tr_b16 v[80:81], v48 offset:32768
    v_mfma_f32_32x32x16_bf16 a[32:47], v[96:99], v[120:123], a[32:47]
    ds_read_b64_tr_b16 v[82:83], v48 offset:33792
    v_mfma_f32_32x32x16_bf16 a[48:63], v[96:99], v[124:127], a[48:63]
    ds_read_b64_tr_b16 v[84:85], v49 offset:32768
    v_mfma_f32_32x32x16_bf16 a[64:79], v[100:103], v[112:115], a[64:79]
    ds_read_b64_tr_b16 v[86:87], v49 offset:33792
    v_mfma_f32_32x32x16_bf16 a[80:95], v[100:103], v[116:119], a[80:95]
    ds_read_b64_tr_b16 v[88:89], v48 offset:40960
    v_mfma_f32_32x32x16_bf16 a[96:111], v[100:103], v[120:123], a[96:111]
    ds_read_b64_tr_b16 v[90:91], v48 offset:41984
    v_mfma_f32_32x32x16_bf16 a[112:127], v[100:103], v[124:127], a[112:127]
    ds_read_b64_tr_b16 v[92:93], v49 offset:40960
    v_mfma_f32_32x32x16_bf16 a[128:143], v[104:107], v[112:115], a[128:143]
    ds_read_b64_tr_b16 v[94:95], v49 offset:41984
    v_mfma_f32_32x32x16_bf16 a[144:159], v[104:107], v[116:119], a[144:159]
    ds_read_b128 v[68:71], v6 offset:34816
    v_mfma_f32_32x32x16_bf16 a[160:175], v[104:107], v[120:123], a[160:175]
    ds_read_b128 v[72:75], v6 offset:36864
    v_mfma_f32_32x32x16_bf16 a[176:191], v[104:107], v[124:127], a[176:191]
    ds_read_b128 v[76:79], v6 offset:38912
    v_mfma_f32_32x32x16_bf16 a[192:207], v[108:111], v[112:115], a[192:207]
    v_mfma_f32_32x32x16_bf16 a[208:223], v[108:111], v[116:119], a[208:223]
    v_mfma_f32_32x32x16_bf16 a[224:239], v[108:111], v[120:123], a[224:239]
    v_mfma_f32_32x32x16_bf16 a[240:255], v[108:111], v[124:127], a[240:255]
    s_waitcnt lgkmcnt(0)
    v_mfma_f32_32x32x16_bf16 a[0:15], v[64:67], v[80:83], a[0:15]
    ds_read_b128 v[96:99], v6 offset:33792
    v_mfma_f32_32x32x16_bf16 a[16:31], v[64:67], v[84:87], a[16:31]
    ds_read_b64_tr_b16 v[112:113], v48 offset:36864
    v_mfma_f32_32x32x16_bf16 a[32:47], v[64:67], v[88:91], a[32:47]
    ds_read_b64_tr_b16 v[114:115], v48 offset:37888
    v_mfma_f32_32x32x16_bf16 a[48:63], v[64:67], v[92:95], a[48:63]
    ds_read_b64_tr_b16 v[116:117], v49 offset:36864
    v_mfma_f32_32x32x16_bf16 a[64:79], v[68:71], v[80:83], a[64:79]
    ds_read_b64_tr_b16 v[118:119], v49 offset:37888
    v_mfma_f32_32x32x16_bf16 a[80:95], v[68:71], v[84:87], a[80:95]
    ds_read_b64_tr_b16 v[120:121], v48 offset:45056
    v_mfma_f32_32x32x16_bf16 a[96:111], v[68:71], v[88:91], a[96:111]
    ds_read_b64_tr_b16 v[122:123], v48 offset:46080
    v_mfma_f32_32x32x16_bf16 a[112:127], v[68:71], v[92:95], a[112:127]
    ds_read_b64_tr_b16 v[124:125], v49 offset:45056
    v_mfma_f32_32x32x16_bf16 a[128:143], v[72:75], v[80:83], a[128:143]
    ds_read_b64_tr_b16 v[126:127], v49 offset:46080
    v_mfma_f32_32x32x16_bf16 a[144:159], v[72:75], v[84:87], a[144:159]
    ds_read_b128 v[100:103], v6 offset:35840
    v_mfma_f32_32x32x16_bf16 a[160:175], v[72:75], v[88:91], a[160:175]
    ds_read_b128 v[104:107], v6 offset:37888
    v_mfma_f32_32x32x16_bf16 a[176:191], v[72:75], v[92:95], a[176:191]
    ds_read_b128 v[108:111], v6 offset:39936
    v_mfma_f32_32x32x16_bf16 a[192:207], v[76:79], v[80:83], a[192:207]
    v_mfma_f32_32x32x16_bf16 a[208:223], v[76:79], v[84:87], a[208:223]
    v_mfma_f32_32x32x16_bf16 a[224:239], v[76:79], v[88:91], a[224:239]
    v_mfma_f32_32x32x16_bf16 a[240:255], v[76:79], v[92:95], a[240:255]
    s_waitcnt vmcnt(8) lgkmcnt(0)
    s_barrier
    v_mfma_f32_32x32x16_bf16 a[0:15], v[96:99], v[112:115], a[0:15]
    ds_read_b128 v[64:67], v7 offset:0
    v_mfma_f32_32x32x16_bf16 a[16:31], v[96:99], v[116:119], a[16:31]
    ds_read_b64_tr_b16 v[80:81], v50 offset:0
    v_mfma_f32_32x32x16_bf16 a[32:47], v[96:99], v[120:123], a[32:47]
    ds_read_b64_tr_b16 v[82:83], v50 offset:1024
    v_mfma_f32_32x32x16_bf16 a[48:63], v[96:99], v[124:127], a[48:63]
    ds_read_b64_tr_b16 v[84:85], v51 offset:0
    v_mfma_f32_32x32x16_bf16 a[64:79], v[100:103], v[112:115], a[64:79]
    ds_read_b64_tr_b16 v[86:87], v51 offset:1024
    v_mfma_f32_32x32x16_bf16 a[80:95], v[100:103], v[116:119], a[80:95]
    ds_read_b64_tr_b16 v[88:89], v50 offset:8192
    v_mfma_f32_32x32x16_bf16 a[96:111], v[100:103], v[120:123], a[96:111]
    ds_read_b64_tr_b16 v[90:91], v50 offset:9216
    v_mfma_f32_32x32x16_bf16 a[112:127], v[100:103], v[124:127], a[112:127]
    ds_read_b64_tr_b16 v[92:93], v51 offset:8192
    v_mfma_f32_32x32x16_bf16 a[128:143], v[104:107], v[112:115], a[128:143]
    ds_read_b64_tr_b16 v[94:95], v51 offset:9216
    v_mfma_f32_32x32x16_bf16 a[144:159], v[104:107], v[116:119], a[144:159]
    ds_read_b128 v[68:71], v7 offset:2048
    v_mfma_f32_32x32x16_bf16 a[160:175], v[104:107], v[120:123], a[160:175]
    ds_read_b128 v[72:75], v7 offset:4096
    v_mfma_f32_32x32x16_bf16 a[176:191], v[104:107], v[124:127], a[176:191]
    ds_read_b128 v[76:79], v7 offset:6144
    v_mfma_f32_32x32x16_bf16 a[192:207], v[108:111], v[112:115], a[192:207]
    v_mfma_f32_32x32x16_bf16 a[208:223], v[108:111], v[116:119], a[208:223]
    v_mfma_f32_32x32x16_bf16 a[224:239], v[108:111], v[120:123], a[224:239]
    v_mfma_f32_32x32x16_bf16 a[240:255], v[108:111], v[124:127], a[240:255]
    s_waitcnt lgkmcnt(0)
    v_mfma_f32_32x32x16_bf16 a[0:15], v[64:67], v[80:83], a[0:15]
    ds_read_b128 v[96:99], v7 offset:1024
    v_mfma_f32_32x32x16_bf16 a[16:31], v[64:67], v[84:87], a[16:31]
    ds_read_b64_tr_b16 v[112:113], v50 offset:4096
    v_mfma_f32_32x32x16_bf16 a[32:47], v[64:67], v[88:91], a[32:47]
    ds_read_b64_tr_b16 v[114:115], v50 offset:5120
    v_mfma_f32_32x32x16_bf16 a[48:63], v[64:67], v[92:95], a[48:63]
    ds_read_b64_tr_b16 v[116:117], v51 offset:4096
    v_mfma_f32_32x32x16_bf16 a[64:79], v[68:71], v[80:83], a[64:79]
    ds_read_b64_tr_b16 v[118:119], v51 offset:5120
    v_mfma_f32_32x32x16_bf16 a[80:95], v[68:71], v[84:87], a[80:95]
    ds_read_b64_tr_b16 v[120:121], v50 offset:12288
    v_mfma_f32_32x32x16_bf16 a[96:111], v[68:71], v[88:91], a[96:111]
    ds_read_b64_tr_b16 v[122:123], v50 offset:13312
    v_mfma_f32_32x32x16_bf16 a[112:127], v[68:71], v[92:95], a[112:127]
    ds_read_b64_tr_b16 v[124:125], v51 offset:12288
    v_mfma_f32_32x32x16_bf16 a[128:143], v[72:75], v[80:83], a[128:143]
    ds_read_b64_tr_b16 v[126:127], v51 offset:13312
    v_mfma_f32_32x32x16_bf16 a[144:159], v[72:75], v[84:87], a[144:159]
    ds_read_b128 v[100:103], v7 offset:3072
    v_mfma_f32_32x32x16_bf16 a[160:175], v[72:75], v[88:91], a[160:175]
    ds_read_b128 v[104:107], v7 offset:5120
    v_mfma_f32_32x32x16_bf16 a[176:191], v[72:75], v[92:95], a[176:191]
    ds_read_b128 v[108:111], v7 offset:7168
    v_mfma_f32_32x32x16_bf16 a[192:207], v[76:79], v[80:83], a[192:207]
    v_mfma_f32_32x32x16_bf16 a[208:223], v[76:79], v[84:87], a[208:223]
    v_mfma_f32_32x32x16_bf16 a[224:239], v[76:79], v[88:91], a[224:239]
    v_mfma_f32_32x32x16_bf16 a[240:255], v[76:79], v[92:95], a[240:255]
    s_waitcnt vmcnt(0) lgkmcnt(0)
    s_barrier
    v_mfma_f32_32x32x16_bf16 a[0:15], v[96:99], v[112:115], a[0:15]
    ds_read_b128 v[64:67], v7 offset:32768
    v_mfma_f32_32x32x16_bf16 a[16:31], v[96:99], v[116:119], a[16:31]
    ds_read_b64_tr_b16 v[80:81], v50 offset:32768
    v_mfma_f32_32x32x16_bf16 a[32:47], v[96:99], v[120:123], a[32:47]
    ds_read_b64_tr_b16 v[82:83], v50 offset:33792
    v_mfma_f32_32x32x16_bf16 a[48:63], v[96:99], v[124:127], a[48:63]
    ds_read_b64_tr_b16 v[84:85], v51 offset:32768
    v_mfma_f32_32x32x16_bf16 a[64:79], v[100:103], v[112:115], a[64:79]
    ds_read_b64_tr_b16 v[86:87], v51 offset:33792
    v_mfma_f32_32x32x16_bf16 a[80:95], v[100:103], v[116:119], a[80:95]
    ds_read_b64_tr_b16 v[88:89], v50 offset:40960
    v_mfma_f32_32x32x16_bf16 a[96:111], v[100:103], v[120:123], a[96:111]
    ds_read_b64_tr_b16 v[90:91], v50 offset:41984
    v_mfma_f32_32x32x16_bf16 a[112:127], v[100:103], v[124:127], a[112:127]
    ds_read_b64_tr_b16 v[92:93], v51 offset:40960
    v_mfma_f32_32x32x16_bf16 a[128:143], v[104:107], v[112:115], a[128:143]
    ds_read_b64_tr_b16 v[94:95], v51 offset:41984
    v_mfma_f32_32x32x16_bf16 a[144:159], v[104:107], v[116:119], a[144:159]
    ds_read_b128 v[68:71], v7 offset:34816
    v_mfma_f32_32x32x16_bf16 a[160:175], v[104:107], v[120:123], a[160:175]
    ds_read_b128 v[72:75], v7 offset:36864
    v_mfma_f32_32x32x16_bf16 a[176:191], v[104:107], v[124:127], a[176:191]
    ds_read_b128 v[76:79], v7 offset:38912
    v_mfma_f32_32x32x16_bf16 a[192:207], v[108:111], v[112:115], a[192:207]
    v_mfma_f32_32x32x16_bf16 a[208:223], v[108:111], v[116:119], a[208:223]
    v_mfma_f32_32x32x16_bf16 a[224:239], v[108:111], v[120:123], a[224:239]
    v_mfma_f32_32x32x16_bf16 a[240:255], v[108:111], v[124:127], a[240:255]
    s_waitcnt lgkmcnt(0)
    v_mfma_f32_32x32x16_bf16 a[0:15], v[64:67], v[80:83], a[0:15]
    ds_read_b128 v[96:99], v7 offset:33792
    v_mfma_f32_32x32x16_bf16 a[16:31], v[64:67], v[84:87], a[16:31]
    ds_read_b64_tr_b16 v[112:113], v50 offset:36864
    v_mfma_f32_32x32x16_bf16 a[32:47], v[64:67], v[88:91], a[32:47]
    ds_read_b64_tr_b16 v[114:115], v50 offset:37888
    v_mfma_f32_32x32x16_bf16 a[48:63], v[64:67], v[92:95], a[48:63]
    ds_read_b64_tr_b16 v[116:117], v51 offset:36864
    v_mfma_f32_32x32x16_bf16 a[64:79], v[68:71], v[80:83], a[64:79]
    ds_read_b64_tr_b16 v[118:119], v51 offset:37888
    v_mfma_f32_32x32x16_bf16 a[80:95], v[68:71], v[84:87], a[80:95]
    ds_read_b64_tr_b16 v[120:121], v50 offset:45056
    v_mfma_f32_32x32x16_bf16 a[96:111], v[68:71], v[88:91], a[96:111]
    ds_read_b64_tr_b16 v[122:123], v50 offset:46080
    v_mfma_f32_32x32x16_bf16 a[112:127], v[68:71], v[92:95], a[112:127]
    ds_read_b64_tr_b16 v[124:125], v51 offset:45056
    v_mfma_f32_32x32x16_bf16 a[128:143], v[72:75], v[80:83], a[128:143]
    ds_read_b64_tr_b16 v[126:127], v51 offset:46080
    v_mfma_f32_32x32x16_bf16 a[144:159], v[72:75], v[84:87], a[144:159]
    ds_read_b128 v[100:103], v7 offset:35840
    v_mfma_f32_32x32x16_bf16 a[160:175], v[72:75], v[88:91], a[160:175]
    ds_read_b128 v[104:107], v7 offset:37888
    v_mfma_f32_32x32x16_bf16 a[176:191], v[72:75], v[92:95], a[176:191]
    ds_read_b128 v[108:111], v7 offset:39936
    v_mfma_f32_32x32x16_bf16 a[192:207], v[76:79], v[80:83], a[192:207]
    v_mfma_f32_32x32x16_bf16 a[208:223], v[76:79], v[84:87], a[208:223]
    v_mfma_f32_32x32x16_bf16 a[224:239], v[76:79], v[88:91], a[224:239]
    v_mfma_f32_32x32x16_bf16 a[240:255], v[76:79], v[92:95], a[240:255]
    s_waitcnt vmcnt(0) lgkmcnt(0)
    s_barrier
    v_mfma_f32_32x32x16_bf16 a[0:15], v[96:99], v[112:115], a[0:15]
    v_mfma_f32_32x32x16_bf16 a[16:31], v[96:99], v[116:119], a[16:31]
    v_mfma_f32_32x32x16_bf16 a[32:47], v[96:99], v[120:123], a[32:47]
    v_mfma_f32_32x32x16_bf16 a[48:63], v[96:99], v[124:127], a[48:63]
    v_mfma_f32_32x32x16_bf16 a[64:79], v[100:103], v[112:115], a[64:79]
    v_mfma_f32_32x32x16_bf16 a[80:95], v[100:103], v[116:119], a[80:95]
    v_mfma_f32_32x32x16_bf16 a[96:111], v[100:103], v[120:123], a[96:111]
    v_mfma_f32_32x32x16_bf16 a[112:127], v[100:103], v[124:127], a[112:127]
    v_mfma_f32_32x32x16_bf16 a[128:143], v[104:107], v[112:115], a[128:143]
    v_mfma_f32_32x32x16_bf16 a[144:159], v[104:107], v[116:119], a[144:159]
    v_mfma_f32_32x32x16_bf16 a[160:175], v[104:107], v[120:123], a[160:175]
    v_mfma_f32_32x32x16_bf16 a[176:191], v[104:107], v[124:127], a[176:191]
    v_mfma_f32_32x32x16_bf16 a[192:207], v[108:111], v[112:115], a[192:207]
    v_mfma_f32_32x32x16_bf16 a[208:223], v[108:111], v[116:119], a[208:223]
    v_mfma_f32_32x32x16_bf16 a[224:239], v[108:111], v[120:123], a[224:239]
    v_mfma_f32_32x32x16_bf16 a[240:255], v[108:111], v[124:127], a[240:255]
    s_nop 15
ub_qkv_epi:
    v_accvgpr_read_b32 v16, a0
    v_accvgpr_read_b32 v17, a1
    v_accvgpr_read_b32 v18, a2
    v_accvgpr_read_b32 v19, a3
    v_accvgpr_read_b32 v20, a4
    v_accvgpr_read_b32 v21, a5
    v_accvgpr_read_b32 v22, a6
    v_accvgpr_read_b32 v23, a7
    v_accvgpr_read_b32 v24, a8
    v_accvgpr_read_b32 v25, a9
    v_accvgpr_read_b32 v26, a10
    v_accvgpr_read_b32 v27, a11
    v_accvgpr_read_b32 v28, a12
    v_accvgpr_read_b32 v29, a13
    v_accvgpr_read_b32 v30, a14
    v_accvgpr_read_b32 v31, a15
    v_cvt_pk_bf16_f32 v32, v16, v17
    v_cvt_pk_bf16_f32 v33, v18, v19
    v_cvt_pk_bf16_f32 v34, v20, v21
    v_cvt_pk_bf16_f32 v35, v22, v23
    v_cvt_pk_bf16_f32 v36, v24, v25
    v_cvt_pk_bf16_f32 v37, v26, v27
    v_cvt_pk_bf16_f32 v38, v28, v29
    v_cvt_pk_bf16_f32 v39, v30, v31
    s_add_u32 s24, s45, 0
    s_nop 0
    v_permlane32_swap_b32 v32, v34
    v_permlane32_swap_b32 v33, v35
    v_permlane32_swap_b32 v36, v38
    v_permlane32_swap_b32 v37, v39
    buffer_store_dwordx4 v[32:35], v1, s[8:11], s24 offen offset:0 sc1
    buffer_store_dwordx4 v[36:39], v1, s[8:11], s24 offen offset:1024 sc1
    v_accvgpr_read_b32 v40, a16
    v_accvgpr_read_b32 v41, a17
    v_accvgpr_read_b32 v42, a18
    v_accvgpr_read_b32 v43, a19
    v_accvgpr_read_b32 v44, a20
    v_accvgpr_read_b32 v45, a21
    v_accvgpr_read_b32 v46, a22
    v_accvgpr_read_b32 v47, a23
    v_accvgpr_read_b32 v48, a24
    v_accvgpr_read_b32 v49, a25
    v_accvgpr_read_b32 v50, a26
    v_accvgpr_read_b32 v51, a27
    v_accvgpr_read_b32 v52, a28
    v_accvgpr_read_b32 v53, a29
    v_accvgpr_read_b32 v54, a30
    v_accvgpr_read_b32 v55, a31
    v_cvt_pk_bf16_f32 v56, v40, v41
    v_cvt_pk_bf16_f32 v57, v42, v43
    v_cvt_pk_bf16_f32 v58, v44, v45
    v_cvt_pk_bf16_f32 v59, v46, v47
    v_cvt_pk_bf16_f32 v60, v48, v49
    v_cvt_pk_bf16_f32 v61, v50, v51
    v_cvt_pk_bf16_f32 v62, v52, v53
    v_cvt_pk_bf16_f32 v63, v54, v55
    s_nop 0
    v_permlane32_swap_b32 v56, v58
    v_permlane32_swap_b32 v57, v59
    v_permlane32_swap_b32 v60, v62
    v_permlane32_swap_b32 v61, v63
    buffer_store_dwordx4 v[56:59], v1, s[8:11], s24 offen offset:2048 sc1
    buffer_store_dwordx4 v[60:63], v1, s[8:11], s24 offen offset:3072 sc1
    v_accvgpr_read_b32 v16, a32
    v_accvgpr_read_b32 v17, a33
    v_accvgpr_read_b32 v18, a34
    v_accvgpr_read_b32 v19, a35
    v_accvgpr_read_b32 v20, a36
    v_accvgpr_read_b32 v21, a37
    v_accvgpr_read_b32 v22, a38
    v_accvgpr_read_b32 v23, a39
    v_accvgpr_read_b32 v24, a40
    v_accvgpr_read_b32 v25, a41
    v_accvgpr_read_b32 v26, a42
    v_accvgpr_read_b32 v27, a43
    v_accvgpr_read_b32 v28, a44
    v_accvgpr_read_b32 v29, a45
    v_accvgpr_read_b32 v30, a46
    v_accvgpr_read_b32 v31, a47
    v_cvt_pk_bf16_f32 v32, v16, v17
    v_cvt_pk_bf16_f32 v33, v18, v19
    v_cvt_pk_bf16_f32 v34, v20, v21
    v_cvt_pk_bf16_f32 v35, v22, v23
    v_cvt_pk_bf16_f32 v36, v24, v25
    v_cvt_pk_bf16_f32 v37, v26, v27
    v_cvt_pk_bf16_f32 v38, v28, v29
    v_cvt_pk_bf16_f32 v39, v30, v31
    s_add_u32 s24, s45, 8192
    s_nop 0
    v_permlane32_swap_b32 v32, v34
    v_permlane32_swap_b32 v33, v35
    v_permlane32_swap_b32 v36, v38
    v_permlane32_swap_b32 v37, v39
    buffer_store_dwordx4 v[32:35], v1, s[8:11], s24 offen offset:0 sc1
    buffer_store_dwordx4 v[36:39], v1, s[8:11], s24 offen offset:1024 sc1
    v_accvgpr_read_b32 v40, a48
    v_accvgpr_read_b32 v41, a49
    v_accvgpr_read_b32 v42, a50
    v_accvgpr_read_b32 v43, a51
    v_accvgpr_read_b32 v44, a52
    v_accvgpr_read_b32 v45, a53
    v_accvgpr_read_b32 v46, a54
    v_accvgpr_read_b32 v47, a55
    v_accvgpr_read_b32 v48, a56
    v_accvgpr_read_b32 v49, a57
    v_accvgpr_read_b32 v50, a58
    v_accvgpr_read_b32 v51, a59
    v_accvgpr_read_b32 v52, a60
    v_accvgpr_read_b32 v53, a61
    v_accvgpr_read_b32 v54, a62
    v_accvgpr_read_b32 v55, a63
    v_cvt_pk_bf16_f32 v56, v40, v41
    v_cvt_pk_bf16_f32 v57, v42, v43
    v_cvt_pk_bf16_f32 v58, v44, v45
    v_cvt_pk_bf16_f32 v59, v46, v47
    v_cvt_pk_bf16_f32 v60, v48, v49
    v_cvt_pk_bf16_f32 v61, v50, v51
    v_cvt_pk_bf16_f32 v62, v52, v53
    v_cvt_pk_bf16_f32 v63, v54, v55
    s_nop 0
    v_permlane32_swap_b32 v56, v58
    v_permlane32_swap_b32 v57, v59
    v_permlane32_swap_b32 v60, v62
    v_permlane32_swap_b32 v61, v63
    buffer_store_dwordx4 v[56:59], v1, s[8:11], s24 offen offset:2048 sc1
    buffer_store_dwordx4 v[60:63], v1, s[8:11], s24 offen offset:3072 sc1
    v_accvgpr_read_b32 v16, a64
    v_accvgpr_read_b32 v17, a65
    v_accvgpr_read_b32 v18, a66
    v_accvgpr_read_b32 v19, a67
    v_accvgpr_read_b32 v20, a68
    v_accvgpr_read_b32 v21, a69
    v_accvgpr_read_b32 v22, a70
    v_accvgpr_read_b32 v23, a71
    v_accvgpr_read_b32 v24, a72
    v_accvgpr_read_b32 v25, a73
    v_accvgpr_read_b32 v26, a74
    v_accvgpr_read_b32 v27, a75
    v_accvgpr_read_b32 v28, a76
    v_accvgpr_read_b32 v29, a77
    v_accvgpr_read_b32 v30, a78
    v_accvgpr_read_b32 v31, a79
    v_cvt_pk_bf16_f32 v32, v16, v17
    v_cvt_pk_bf16_f32 v33, v18, v19
    v_cvt_pk_bf16_f32 v34, v20, v21
    v_cvt_pk_bf16_f32 v35, v22, v23
    v_cvt_pk_bf16_f32 v36, v24, v25
    v_cvt_pk_bf16_f32 v37, v26, v27
    v_cvt_pk_bf16_f32 v38, v28, v29
    v_cvt_pk_bf16_f32 v39, v30, v31
    s_add_u32 s24, s45, 262144
    s_nop 0
    v_permlane32_swap_b32 v32, v34
    v_permlane32_swap_b32 v33, v35
    v_permlane32_swap_b32 v36, v38
    v_permlane32_swap_b32 v37, v39
    buffer_store_dwordx4 v[32:35], v1, s[8:11], s24 offen offset:0 sc1
    buffer_store_dwordx4 v[36:39], v1, s[8:11], s24 offen offset:1024 sc1
    v_accvgpr_read_b32 v40, a80
    v_accvgpr_read_b32 v41, a81
    v_accvgpr_read_b32 v42, a82
    v_accvgpr_read_b32 v43, a83
    v_accvgpr_read_b32 v44, a84
    v_accvgpr_read_b32 v45, a85
    v_accvgpr_read_b32 v46, a86
    v_accvgpr_read_b32 v47, a87
    v_accvgpr_read_b32 v48, a88
    v_accvgpr_read_b32 v49, a89
    v_accvgpr_read_b32 v50, a90
    v_accvgpr_read_b32 v51, a91
    v_accvgpr_read_b32 v52, a92
    v_accvgpr_read_b32 v53, a93
    v_accvgpr_read_b32 v54, a94
    v_accvgpr_read_b32 v55, a95
    v_cvt_pk_bf16_f32 v56, v40, v41
    v_cvt_pk_bf16_f32 v57, v42, v43
    v_cvt_pk_bf16_f32 v58, v44, v45
    v_cvt_pk_bf16_f32 v59, v46, v47
    v_cvt_pk_bf16_f32 v60, v48, v49
    v_cvt_pk_bf16_f32 v61, v50, v51
    v_cvt_pk_bf16_f32 v62, v52, v53
    v_cvt_pk_bf16_f32 v63, v54, v55
    s_nop 0
    v_permlane32_swap_b32 v56, v58
    v_permlane32_swap_b32 v57, v59
    v_permlane32_swap_b32 v60, v62
    v_permlane32_swap_b32 v61, v63
    buffer_store_dwordx4 v[56:59], v1, s[8:11], s24 offen offset:2048 sc1
    buffer_store_dwordx4 v[60:63], v1, s[8:11], s24 offen offset:3072 sc1
    v_accvgpr_read_b32 v16, a96
    v_accvgpr_read_b32 v17, a97
    v_accvgpr_read_b32 v18, a98
    v_accvgpr_read_b32 v19, a99
    v_accvgpr_read_b32 v20, a100
    v_accvgpr_read_b32 v21, a101
    v_accvgpr_read_b32 v22, a102
    v_accvgpr_read_b32 v23, a103
    v_accvgpr_read_b32 v24, a104
    v_accvgpr_read_b32 v25, a105
    v_accvgpr_read_b32 v26, a106
    v_accvgpr_read_b32 v27, a107
    v_accvgpr_read_b32 v28, a108
    v_accvgpr_read_b32 v29, a109
    v_accvgpr_read_b32 v30, a110
    v_accvgpr_read_b32 v31, a111
    v_cvt_pk_bf16_f32 v32, v16, v17
    v_cvt_pk_bf16_f32 v33, v18, v19
    v_cvt_pk_bf16_f32 v34, v20, v21
    v_cvt_pk_bf16_f32 v35, v22, v23
    v_cvt_pk_bf16_f32 v36, v24, v25
    v_cvt_pk_bf16_f32 v37, v26, v27
    v_cvt_pk_bf16_f32 v38, v28, v29
    v_cvt_pk_bf16_f32 v39, v30, v31
    s_add_u32 s24, s45, 270336
    s_nop 0
    v_permlane32_swap_b32 v32, v34
    v_permlane32_swap_b32 v33, v35
    v_permlane32_swap_b32 v36, v38
    v_permlane32_swap_b32 v37, v39
    buffer_store_dwordx4 v[32:35], v1, s[8:11], s24 offen offset:0 sc1
    buffer_store_dwordx4 v[36:39], v1, s[8:11], s24 offen offset:1024 sc1
    v_accvgpr_read_b32 v40, a112
    v_accvgpr_read_b32 v41, a113
    v_accvgpr_read_b32 v42, a114
    v_accvgpr_read_b32 v43, a115
    v_accvgpr_read_b32 v44, a116
    v_accvgpr_read_b32 v45, a117
    v_accvgpr_read_b32 v46, a118
    v_accvgpr_read_b32 v47, a119
    v_accvgpr_read_b32 v48, a120
    v_accvgpr_read_b32 v49, a121
    v_accvgpr_read_b32 v50, a122
    v_accvgpr_read_b32 v51, a123
    v_accvgpr_read_b32 v52, a124
    v_accvgpr_read_b32 v53, a125
    v_accvgpr_read_b32 v54, a126
    v_accvgpr_read_b32 v55, a127
    v_cvt_pk_bf16_f32 v56, v40, v41
    v_cvt_pk_bf16_f32 v57, v42, v43
    v_cvt_pk_bf16_f32 v58, v44, v45
    v_cvt_pk_bf16_f32 v59, v46, v47
    v_cvt_pk_bf16_f32 v60, v48, v49
    v_cvt_pk_bf16_f32 v61, v50, v51
    v_cvt_pk_bf16_f32 v62, v52, v53
    v_cvt_pk_bf16_f32 v63, v54, v55
    s_nop 0
    v_permlane32_swap_b32 v56, v58
    v_permlane32_swap_b32 v57, v59
    v_permlane32_swap_b32 v60, v62
    v_permlane32_swap_b32 v61, v63
    buffer_store_dwordx4 v[56:59], v1, s[8:11], s24 offen offset:2048 sc1
    buffer_store_dwordx4 v[60:63], v1, s[8:11], s24 offen offset:3072 sc1
    v_accvgpr_read_b32 v16, a128
    v_accvgpr_read_b32 v17, a129
    v_accvgpr_read_b32 v18, a130
    v_accvgpr_read_b32 v19, a131
    v_accvgpr_read_b32 v20, a132
    v_accvgpr_read_b32 v21, a133
    v_accvgpr_read_b32 v22, a134
    v_accvgpr_read_b32 v23, a135
    v_accvgpr_read_b32 v24, a136
    v_accvgpr_read_b32 v25, a137
    v_accvgpr_read_b32 v26, a138
    v_accvgpr_read_b32 v27, a139
    v_accvgpr_read_b32 v28, a140
    v_accvgpr_read_b32 v29, a141
    v_accvgpr_read_b32 v30, a142
    v_accvgpr_read_b32 v31, a143
    v_cvt_pk_bf16_f32 v32, v16, v17
    v_cvt_pk_bf16_f32 v33, v18, v19
    v_cvt_pk_bf16_f32 v34, v20, v21
    v_cvt_pk_bf16_f32 v35, v22, v23
    v_cvt_pk_bf16_f32 v36, v24, v25
    v_cvt_pk_bf16_f32 v37, v26, v27
    v_cvt_pk_bf16_f32 v38, v28, v29
    v_cvt_pk_bf16_f32 v39, v30, v31
    s_add_u32 s24, s45, 524288
    s_nop 0
    v_permlane32_swap_b32 v32, v34
    v_permlane32_swap_b32 v33, v35
    v_permlane32_swap_b32 v36, v38
    v_permlane32_swap_b32 v37, v39
    buffer_store_dwordx4 v[32:35], v1, s[8:11], s24 offen offset:0 sc1
    buffer_store_dwordx4 v[36:39], v1, s[8:11], s24 offen offset:1024 sc1
    v_accvgpr_read_b32 v40, a144
    v_accvgpr_read_b32 v41, a145
    v_accvgpr_read_b32 v42, a146
    v_accvgpr_read_b32 v43, a147
    v_accvgpr_read_b32 v44, a148
    v_accvgpr_read_b32 v45, a149
    v_accvgpr_read_b32 v46, a150
    v_accvgpr_read_b32 v47, a151
    v_accvgpr_read_b32 v48, a152
    v_accvgpr_read_b32 v49, a153
    v_accvgpr_read_b32 v50, a154
    v_accvgpr_read_b32 v51, a155
    v_accvgpr_read_b32 v52, a156
    v_accvgpr_read_b32 v53, a157
    v_accvgpr_read_b32 v54, a158
    v_accvgpr_read_b32 v55, a159
    v_cvt_pk_bf16_f32 v56, v40, v41
    v_cvt_pk_bf16_f32 v57, v42, v43
    v_cvt_pk_bf16_f32 v58, v44, v45
    v_cvt_pk_bf16_f32 v59, v46, v47
    v_cvt_pk_bf16_f32 v60, v48, v49
    v_cvt_pk_bf16_f32 v61, v50, v51
    v_cvt_pk_bf16_f32 v62, v52, v53
    v_cvt_pk_bf16_f32 v63, v54, v55
    s_nop 0
    v_permlane32_swap_b32 v56, v58
    v_permlane32_swap_b32 v57, v59
    v_permlane32_swap_b32 v60, v62
    v_permlane32_swap_b32 v61, v63
    buffer_store_dwordx4 v[56:59], v1, s[8:11], s24 offen offset:2048 sc1
    buffer_store_dwordx4 v[60:63], v1, s[8:11], s24 offen offset:3072 sc1
    v_accvgpr_read_b32 v16, a160
    v_accvgpr_read_b32 v17, a161
    v_accvgpr_read_b32 v18, a162
    v_accvgpr_read_b32 v19, a163
    v_accvgpr_read_b32 v20, a164
    v_accvgpr_read_b32 v21, a165
    v_accvgpr_read_b32 v22, a166
    v_accvgpr_read_b32 v23, a167
    v_accvgpr_read_b32 v24, a168
    v_accvgpr_read_b32 v25, a169
    v_accvgpr_read_b32 v26, a170
    v_accvgpr_read_b32 v27, a171
    v_accvgpr_read_b32 v28, a172
    v_accvgpr_read_b32 v29, a173
    v_accvgpr_read_b32 v30, a174
    v_accvgpr_read_b32 v31, a175
    v_cvt_pk_bf16_f32 v32, v16, v17
    v_cvt_pk_bf16_f32 v33, v18, v19
    v_cvt_pk_bf16_f32 v34, v20, v21
    v_cvt_pk_bf16_f32 v35, v22, v23
    v_cvt_pk_bf16_f32 v36, v24, v25
    v_cvt_pk_bf16_f32 v37, v26, v27
    v_cvt_pk_bf16_f32 v38, v28, v29
    v_cvt_pk_bf16_f32 v39, v30, v31
    s_add_u32 s24, s45, 532480
    s_nop 0
    v_permlane32_swap_b32 v32, v34
    v_permlane32_swap_b32 v33, v35
    v_permlane32_swap_b32 v36, v38
    v_permlane32_swap_b32 v37, v39
    buffer_store_dwordx4 v[32:35], v1, s[8:11], s24 offen offset:0 sc1
    buffer_store_dwordx4 v[36:39], v1, s[8:11], s24 offen offset:1024 sc1
    v_accvgpr_read_b32 v40, a176
    v_accvgpr_read_b32 v41, a177
    v_accvgpr_read_b32 v42, a178
    v_accvgpr_read_b32 v43, a179
    v_accvgpr_read_b32 v44, a180
    v_accvgpr_read_b32 v45, a181
    v_accvgpr_read_b32 v46, a182
    v_accvgpr_read_b32 v47, a183
    v_accvgpr_read_b32 v48, a184
    v_accvgpr_read_b32 v49, a185
    v_accvgpr_read_b32 v50, a186
    v_accvgpr_read_b32 v51, a187
    v_accvgpr_read_b32 v52, a188
    v_accvgpr_read_b32 v53, a189
    v_accvgpr_read_b32 v54, a190
    v_accvgpr_read_b32 v55, a191
    v_cvt_pk_bf16_f32 v56, v40, v41
    v_cvt_pk_bf16_f32 v57, v42, v43
    v_cvt_pk_bf16_f32 v58, v44, v45
    v_cvt_pk_bf16_f32 v59, v46, v47
    v_cvt_pk_bf16_f32 v60, v48, v49
    v_cvt_pk_bf16_f32 v61, v50, v51
    v_cvt_pk_bf16_f32 v62, v52, v53
    v_cvt_pk_bf16_f32 v63, v54, v55
    s_nop 0
    v_permlane32_swap_b32 v56, v58
    v_permlane32_swap_b32 v57, v59
    v_permlane32_swap_b32 v60, v62
    v_permlane32_swap_b32 v61, v63
    buffer_store_dwordx4 v[56:59], v1, s[8:11], s24 offen offset:2048 sc1
    buffer_store_dwordx4 v[60:63], v1, s[8:11], s24 offen offset:3072 sc1
    v_accvgpr_read_b32 v16, a192
    v_accvgpr_read_b32 v17, a193
    v_accvgpr_read_b32 v18, a194
    v_accvgpr_read_b32 v19, a195
    v_accvgpr_read_b32 v20, a196
    v_accvgpr_read_b32 v21, a197
    v_accvgpr_read_b32 v22, a198
    v_accvgpr_read_b32 v23, a199
    v_accvgpr_read_b32 v24, a200
    v_accvgpr_read_b32 v25, a201
    v_accvgpr_read_b32 v26, a202
    v_accvgpr_read_b32 v27, a203
    v_accvgpr_read_b32 v28, a204
    v_accvgpr_read_b32 v29, a205
    v_accvgpr_read_b32 v30, a206
    v_accvgpr_read_b32 v31, a207
    v_cvt_pk_bf16_f32 v32, v16, v17
    v_cvt_pk_bf16_f32 v33, v18, v19
    v_cvt_pk_bf16_f32 v34, v20, v21
    v_cvt_pk_bf16_f32 v35, v22, v23
    v_cvt_pk_bf16_f32 v36, v24, v25
    v_cvt_pk_bf16_f32 v37, v26, v27
    v_cvt_pk_bf16_f32 v38, v28, v29
    v_cvt_pk_bf16_f32 v39, v30, v31
    s_add_u32 s24, s45, 786432
    s_nop 0
    v_permlane32_swap_b32 v32, v34
    v_permlane32_swap_b32 v33, v35
    v_permlane32_swap_b32 v36, v38
    v_permlane32_swap_b32 v37, v39
    buffer_store_dwordx4 v[32:35], v1, s[8:11], s24 offen offset:0 sc1
    buffer_store_dwordx4 v[36:39], v1, s[8:11], s24 offen offset:1024 sc1
    v_accvgpr_read_b32 v40, a208
    v_accvgpr_read_b32 v41, a209
    v_accvgpr_read_b32 v42, a210
    v_accvgpr_read_b32 v43, a211
    v_accvgpr_read_b32 v44, a212
    v_accvgpr_read_b32 v45, a213
    v_accvgpr_read_b32 v46, a214
    v_accvgpr_read_b32 v47, a215
    v_accvgpr_read_b32 v48, a216
    v_accvgpr_read_b32 v49, a217
    v_accvgpr_read_b32 v50, a218
    v_accvgpr_read_b32 v51, a219
    v_accvgpr_read_b32 v52, a220
    v_accvgpr_read_b32 v53, a221
    v_accvgpr_read_b32 v54, a222
    v_accvgpr_read_b32 v55, a223
    v_cvt_pk_bf16_f32 v56, v40, v41
    v_cvt_pk_bf16_f32 v57, v42, v43
    v_cvt_pk_bf16_f32 v58, v44, v45
    v_cvt_pk_bf16_f32 v59, v46, v47
    v_cvt_pk_bf16_f32 v60, v48, v49
    v_cvt_pk_bf16_f32 v61, v50, v51
    v_cvt_pk_bf16_f32 v62, v52, v53
    v_cvt_pk_bf16_f32 v63, v54, v55
    s_nop 0
    v_permlane32_swap_b32 v56, v58
    v_permlane32_swap_b32 v57, v59
    v_permlane32_swap_b32 v60, v62
    v_permlane32_swap_b32 v61, v63
    buffer_store_dwordx4 v[56:59], v1, s[8:11], s24 offen offset:2048 sc1
    buffer_store_dwordx4 v[60:63], v1, s[8:11], s24 offen offset:3072 sc1
    v_accvgpr_read_b32 v16, a224
    v_accvgpr_read_b32 v17, a225
    v_accvgpr_read_b32 v18, a226
    v_accvgpr_read_b32 v19, a227
    v_accvgpr_read_b32 v20, a228
    v_accvgpr_read_b32 v21, a229
    v_accvgpr_read_b32 v22, a230
    v_accvgpr_read_b32 v23, a231
    v_accvgpr_read_b32 v24, a232
    v_accvgpr_read_b32 v25, a233
    v_accvgpr_read_b32 v26, a234
    v_accvgpr_read_b32 v27, a235
    v_accvgpr_read_b32 v28, a236
    v_accvgpr_read_b32 v29, a237
    v_accvgpr_read_b32 v30, a238
    v_accvgpr_read_b32 v31, a239
    v_cvt_pk_bf16_f32 v32, v16, v17
    v_cvt_pk_bf16_f32 v33, v18, v19
    v_cvt_pk_bf16_f32 v34, v20, v21
    v_cvt_pk_bf16_f32 v35, v22, v23
    v_cvt_pk_bf16_f32 v36, v24, v25
    v_cvt_pk_bf16_f32 v37, v26, v27
    v_cvt_pk_bf16_f32 v38, v28, v29
    v_cvt_pk_bf16_f32 v39, v30, v31
    s_add_u32 s24, s45, 794624
    s_nop 0
    v_permlane32_swap_b32 v32, v34
    v_permlane32_swap_b32 v33, v35
    v_permlane32_swap_b32 v36, v38
    v_permlane32_swap_b32 v37, v39
    buffer_store_dwordx4 v[32:35], v1, s[8:11], s24 offen offset:0 sc1
    buffer_store_dwordx4 v[36:39], v1, s[8:11], s24 offen offset:1024 sc1
    v_accvgpr_read_b32 v40, a240
    v_accvgpr_read_b32 v41, a241
    v_accvgpr_read_b32 v42, a242
    v_accvgpr_read_b32 v43, a243
    v_accvgpr_read_b32 v44, a244
    v_accvgpr_read_b32 v45, a245
    v_accvgpr_read_b32 v46, a246
    v_accvgpr_read_b32 v47, a247
    v_accvgpr_read_b32 v48, a248
    v_accvgpr_read_b32 v49, a249
    v_accvgpr_read_b32 v50, a250
    v_accvgpr_read_b32 v51, a251
    v_accvgpr_read_b32 v52, a252
    v_accvgpr_read_b32 v53, a253
    v_accvgpr_read_b32 v54, a254
    v_accvgpr_read_b32 v55, a255
    v_cvt_pk_bf16_f32 v56, v40, v41
    v_cvt_pk_bf16_f32 v57, v42, v43
    v_cvt_pk_bf16_f32 v58, v44, v45
    v_cvt_pk_bf16_f32 v59, v46, v47
    v_cvt_pk_bf16_f32 v60, v48, v49
    v_cvt_pk_bf16_f32 v61, v50, v51
    v_cvt_pk_bf16_f32 v62, v52, v53
    v_cvt_pk_bf16_f32 v63, v54, v55
    s_nop 0
    v_permlane32_swap_b32 v56, v58
    v_permlane32_swap_b32 v57, v59
    v_permlane32_swap_b32 v60, v62
    v_permlane32_swap_b32 v61, v63
    buffer_store_dwordx4 v[56:59], v1, s[8:11], s24 offen offset:2048 sc1
    buffer_store_dwordx4 v[60:63], v1, s[8:11], s24 offen offset:3072 sc1
    s_waitcnt vmcnt(0)
    s_barrier
    s_cmp_lg_u32 s3, 0
    s_cbranch_scc1 ub_next
    v_mov_b32 v10, 4
    s_mov_b64 exec, 1
    buffer_atomic_add v10, off, s[8:11], s58
    s_mov_b64 exec, -1
    s_branch ub_next
ub_ffn:
    s_and_b32 s40, s5, 3
    s_lshr_b32 s24, s5, 4
    s_lshl2_add_u32 s40, s24, s40
    s_bfe_u32 s24, s5, 0x20002
    s_lshl2_add_u32 s43, s51, s24
    s_mov_b32 s58, 105906432
    s_bitcmp1_b32 s100, s40
    s_cbranch_scc1 lnok_14
    s_cmp_lt_u32 s40, 2
    s_cselect_b32 s59, 192, 32
    s_lshl2_add_u32 s59, s40, s59
wait_15:
    buffer_load_dword v10, off, s[96:99], s59 sc1
    s_waitcnt vmcnt(0)
    v_readfirstlane_b32 s24, v10
    s_cmp_ge_u32 s24, 32
    s_cbranch_scc1 waitok_16
    s_sleep 8
    s_sub_u32 s95, s95, 1
    s_cbranch_scc0 wait_15
    s_mov_b32 s95, 0
waitok_16:
    s_bitset1_b32 s100, s40
lnok_14:
    s_lshl_b32 s16, s40, 3
    s_lshl_b32 s24, s3, 1
    s_add_u32 s16, s16, s24
    s_lshl_b32 s16, s16, 16
    s_add_u32 s16, s16, 0
    s_add_u32 s17, s16, 0x10000 - 2048
    s_cmp_lt_u32 s3, 2
    s_cselect_b32 s12, s36, s38
    s_cselect_b32 s13, s37, s39
    s_and_b32 s13, s13, 0xffff
    s_mov_b32 s14, 0x700000
    s_mov_b32 s15, 0x20000
    s_mov_b32 s44, 7168
    s_and_b32 s24, s3, 1
    s_mul_i32 s18, s24, 114688
    s_lshl_b32 s24, s43, 8
    s_add_u32 s18, s18, s24
    s_mov_b32 s20, 229376
    v_and_b32 v9, 63, v0
    v_lshlrev_b32 v1, 4, v9
    v_lshrrev_b32 v10, 4, v9
    v_bfe_u32 v11, v9, 2, 2
    v_xor_b32 v11, v11, v10
    v_lshlrev_b32 v11, 6, v11
    v_and_b32 v12, 3, v9
    v_lshl_add_u32 v11, v12, 4, v11
    v_mul_lo_u32 v10, v10, s44
    v_add_u32 v2, v10, v11
    s_lshl_b32 s24, s44, 2
    s_sub_u32 s24, s24, 1024
    v_add_u32 v3, s24, v2
    v_add_u32 v4, s24, v3
    v_add_u32 v5, s24, v4
    s_lshr_b32 s24, s3, 1
    s_lshl_b32 s24, s24, 13
    v_add_u32 v6, s24, v1
    v_add_u32 v7, 0x10000, v6
    v_lshrrev_b32 v10, 5, v9
    v_lshlrev_b32 v10, 3, v10
    v_bfe_u32 v11, v9, 2, 2
    v_add_u32 v10, v10, v11
    v_lshlrev_b32 v10, 8, v10
    v_bfe_u32 v12, v9, 4, 1
    v_lshl_add_u32 v10, v12, 5, v10
    v_and_b32 v12, 3, v9
    v_lshl_add_u32 v10, v12, 3, v10
    v_add_u32 v10, 0x4000, v10
    s_and_b32 s24, s3, 1
    s_lshl_b32 s24, s24, 1
    v_xor_b32 v12, s24, v11
    v_lshl_add_u32 v48, v12, 6, v10
    v_add_u32 v50, 0x10000, v48
    v_xor_b32 v12, s24, v11
    v_xor_b32 v12, 1, v12
    v_lshl_add_u32 v49, v12, 6, v10
    v_add_u32 v51, 0x10000, v49
    s_lshl_b32 s22, s3, 12
    s_lshl_b32 s45, s40, 3
    s_lshr_b32 s24, s3, 1
    s_lshl_b32 s24, s24, 2
    s_add_u32 s45, s45, s24
    s_mul_i32 s45, s45, 491520
    s_add_u32 s45, s45, 54788096
    s_lshl_b32 s24, s43, 13
    s_add_u32 s45, s45, s24
    s_and_b32 s24, s3, 1
    s_lshl_b32 s24, s24, 12
    s_add_u32 s45, s45, s24
    s_branch ub_wa
ub_ffn_epi:
    s_mov_b32 s26, 0xbfb8aa3b
    v_accvgpr_read_b32 v16, a0
    v_accvgpr_read_b32 v17, a1
    v_accvgpr_read_b32 v18, a2
    v_accvgpr_read_b32 v19, a3
    v_accvgpr_read_b32 v20, a4
    v_accvgpr_read_b32 v21, a5
    v_accvgpr_read_b32 v22, a6
    v_accvgpr_read_b32 v23, a7
    v_accvgpr_read_b32 v24, a8
    v_accvgpr_read_b32 v25, a9
    v_accvgpr_read_b32 v26, a10
    v_accvgpr_read_b32 v27, a11
    v_accvgpr_read_b32 v28, a12
    v_accvgpr_read_b32 v29, a13
    v_accvgpr_read_b32 v30, a14
    v_accvgpr_read_b32 v31, a15
    v_mul_f32 v32, s26, v16
    v_mul_f32 v33, s26, v17
    v_mul_f32 v34, s26, v18
    v_mul_f32 v35, s26, v19
    v_mul_f32 v36, s26, v20
    v_mul_f32 v37, s26, v21
    v_mul_f32 v38, s26, v22
    v_mul_f32 v39, s26, v23
    v_mul_f32 v40, s26, v24
    v_mul_f32 v41, s26, v25
    v_mul_f32 v42, s26, v26
    v_mul_f32 v43, s26, v27
    v_mul_f32 v44, s26, v28
    v_mul_f32 v45, s26, v29
    v_mul_f32 v46, s26, v30
    v_mul_f32 v47, s26, v31
    v_exp_f32 v32, v32
    v_exp_f32 v33, v33
    v_exp_f32 v34, v34
    v_exp_f32 v35, v35
    v_exp_f32 v36, v36
    v_exp_f32 v37, v37
    v_exp_f32 v38, v38
    v_exp_f32 v39, v39
    v_exp_f32 v40, v40
    v_exp_f32 v41, v41
    v_exp_f32 v42, v42
    v_exp_f32 v43, v43
    v_exp_f32 v44, v44
    v_exp_f32 v45, v45
    v_exp_f32 v46, v46
    v_exp_f32 v47, v47
    v_add_f32 v32, 1.0, v32
    v_add_f32 v33, 1.0, v33
    v_add_f32 v34, 1.0, v34
    v_add_f32 v35, 1.0, v35
    v_add_f32 v36, 1.0, v36
    v_add_f32 v37, 1.0, v37
    v_add_f32 v38, 1.0, v38
    v_add_f32 v39, 1.0, v39
    v_add_f32 v40, 1.0, v40
    v_add_f32 v41, 1.0, v41
    v_add_f32 v42, 1.0, v42
    v_add_f32 v43, 1.0, v43
    v_add_f32 v44, 1.0, v44
    v_add_f32 v45, 1.0, v45
    v_add_f32 v46, 1.0, v46
    v_add_f32 v47, 1.0, v47
    v_rcp_f32 v32, v32
    v_rcp_f32 v33, v33
    v_rcp_f32 v34, v34
    v_rcp_f32 v35, v35
    v_rcp_f32 v36, v36
    v_rcp_f32 v37, v37
    v_rcp_f32 v38, v38
    v_rcp_f32 v39, v39
    v_rcp_f32 v40, v40
    v_rcp_f32 v41, v41
    v_rcp_f32 v42, v42
    v_rcp_f32 v43, v43
    v_rcp_f32 v44, v44
    v_rcp_f32 v45, v45
    v_rcp_f32 v46, v46
    v_rcp_f32 v47, v47
    v_mul_f32 v16, v16, v32
    v_mul_f32 v17, v17, v33
    v_mul_f32 v18, v18, v34
    v_mul_f32 v19, v19, v35
    v_mul_f32 v20, v20, v36
    v_mul_f32 v21, v21, v37
    v_mul_f32 v22, v22, v38
    v_mul_f32 v23, v23, v39
    v_mul_f32 v24, v24, v40
    v_mul_f32 v25, v25, v41
    v_mul_f32 v26, v26, v42
    v_mul_f32 v27, v27, v43
    v_mul_f32 v28, v28, v44
    v_mul_f32 v29, v29, v45
    v_mul_f32 v30, v30, v46
    v_mul_f32 v31, v31, v47
    v_accvgpr_read_b32 v32, a32
    v_accvgpr_read_b32 v33, a33
    v_accvgpr_read_b32 v34, a34
    v_accvgpr_read_b32 v35, a35
    v_accvgpr_read_b32 v36, a36
    v_accvgpr_read_b32 v37, a37
    v_accvgpr_read_b32 v38, a38
    v_accvgpr_read_b32 v39, a39
    v_accvgpr_read_b32 v40, a40
    v_accvgpr_read_b32 v41, a41
    v_accvgpr_read_b32 v42, a42
    v_accvgpr_read_b32 v43, a43
    v_accvgpr_read_b32 v44, a44
    v_accvgpr_read_b32 v45, a45
    v_accvgpr_read_b32 v46, a46
    v_accvgpr_read_b32 v47, a47
    v_mul_f32 v16, v16, v32
    v_mul_f32 v17, v17, v33
    v_mul_f32 v18, v18, v34
    v_mul_f32 v19, v19, v35
    v_mul_f32 v20, v20, v36
    v_mul_f32 v21, v21, v37
    v_mul_f32 v22, v22, v38
    v_mul_f32 v23, v23, v39
    v_mul_f32 v24, v24, v40
    v_mul_f32 v25, v25, v41
    v_mul_f32 v26, v26, v42
    v_mul_f32 v27, v27, v43
    v_mul_f32 v28, v28, v44
    v_mul_f32 v29, v29, v45
    v_mul_f32 v30, v30, v46
    v_mul_f32 v31, v31, v47
    v_cvt_pk_bf16_f32 v48, v16, v17
    v_cvt_pk_bf16_f32 v49, v18, v19
    v_cvt_pk_bf16_f32 v50, v20, v21
    v_cvt_pk_bf16_f32 v51, v22, v23
    v_cvt_pk_bf16_f32 v52, v24, v25
    v_cvt_pk_bf16_f32 v53, v26, v27
    v_cvt_pk_bf16_f32 v54, v28, v29
    v_cvt_pk_bf16_f32 v55, v30, v31
    s_add_u32 s24, s45, 0
    s_nop 0
    v_permlane32_swap_b32 v48, v50
    v_permlane32_swap_b32 v49, v51
    v_permlane32_swap_b32 v52, v54
    v_permlane32_swap_b32 v53, v55
    buffer_store_dwordx4 v[48:51], v1, s[8:11], s24 offen offset:0 sc1
    buffer_store_dwordx4 v[52:55], v1, s[8:11], s24 offen offset:1024 sc1
    v_accvgpr_read_b32 v16, a16
    v_accvgpr_read_b32 v17, a17
    v_accvgpr_read_b32 v18, a18
    v_accvgpr_read_b32 v19, a19
    v_accvgpr_read_b32 v20, a20
    v_accvgpr_read_b32 v21, a21
    v_accvgpr_read_b32 v22, a22
    v_accvgpr_read_b32 v23, a23
    v_accvgpr_read_b32 v24, a24
    v_accvgpr_read_b32 v25, a25
    v_accvgpr_read_b32 v26, a26
    v_accvgpr_read_b32 v27, a27
    v_accvgpr_read_b32 v28, a28
    v_accvgpr_read_b32 v29, a29
    v_accvgpr_read_b32 v30, a30
    v_accvgpr_read_b32 v31, a31
    v_mul_f32 v32, s26, v16
    v_mul_f32 v33, s26, v17
    v_mul_f32 v34, s26, v18
    v_mul_f32 v35, s26, v19
    v_mul_f32 v36, s26, v20
    v_mul_f32 v37, s26, v21
    v_mul_f32 v38, s26, v22
    v_mul_f32 v39, s26, v23
    v_mul_f32 v40, s26, v24
    v_mul_f32 v41, s26, v25
    v_mul_f32 v42, s26, v26
    v_mul_f32 v43, s26, v27
    v_mul_f32 v44, s26, v28
    v_mul_f32 v45, s26, v29
    v_mul_f32 v46, s26, v30
    v_mul_f32 v47, s26, v31
    v_exp_f32 v32, v32
    v_exp_f32 v33, v33
    v_exp_f32 v34, v34
    v_exp_f32 v35, v35
    v_exp_f32 v36, v36
    v_exp_f32 v37, v37
    v_exp_f32 v38, v38
    v_exp_f32 v39, v39
    v_exp_f32 v40, v40
    v_exp_f32 v41, v41
    v_exp_f32 v42, v42
    v_exp_f32 v43, v43
    v_exp_f32 v44, v44
    v_exp_f32 v45, v45
    v_exp_f32 v46, v46
    v_exp_f32 v47, v47
    v_add_f32 v32, 1.0, v32
    v_add_f32 v33, 1.0, v33
    v_add_f32 v34, 1.0, v34
    v_add_f32 v35, 1.0, v35
    v_add_f32 v36, 1.0, v36
    v_add_f32 v37, 1.0, v37
    v_add_f32 v38, 1.0, v38
    v_add_f32 v39, 1.0, v39
    v_add_f32 v40, 1.0, v40
    v_add_f32 v41, 1.0, v41
    v_add_f32 v42, 1.0, v42
    v_add_f32 v43, 1.0, v43
    v_add_f32 v44, 1.0, v44
    v_add_f32 v45, 1.0, v45
    v_add_f32 v46, 1.0, v46
    v_add_f32 v47, 1.0, v47
    v_rcp_f32 v32, v32
    v_rcp_f32 v33, v33
    v_rcp_f32 v34, v34
    v_rcp_f32 v35, v35
    v_rcp_f32 v36, v36
    v_rcp_f32 v37, v37
    v_rcp_f32 v38, v38
    v_rcp_f32 v39, v39
    v_rcp_f32 v40, v40
    v_rcp_f32 v41, v41
    v_rcp_f32 v42, v42
    v_rcp_f32 v43, v43
    v_rcp_f32 v44, v44
    v_rcp_f32 v45, v45
    v_rcp_f32 v46, v46
    v_rcp_f32 v47, v47
    v_mul_f32 v16, v16, v32
    v_mul_f32 v17, v17, v33
    v_mul_f32 v18, v18, v34
    v_mul_f32 v19, v19, v35
    v_mul_f32 v20, v20, v36
    v_mul_f32 v21, v21, v37
    v_mul_f32 v22, v22, v38
    v_mul_f32 v23, v23, v39
    v_mul_f32 v24, v24, v40
    v_mul_f32 v25, v25, v41
    v_mul_f32 v26, v26, v42
    v_mul_f32 v27, v27, v43
    v_mul_f32 v28, v28, v44
    v_mul_f32 v29, v29, v45
    v_mul_f32 v30, v30, v46
    v_mul_f32 v31, v31, v47
    v_accvgpr_read_b32 v32, a48
    v_accvgpr_read_b32 v33, a49
    v_accvgpr_read_b32 v34, a50
    v_accvgpr_read_b32 v35, a51
    v_accvgpr_read_b32 v36, a52
    v_accvgpr_read_b32 v37, a53
    v_accvgpr_read_b32 v38, a54
    v_accvgpr_read_b32 v39, a55
    v_accvgpr_read_b32 v40, a56
    v_accvgpr_read_b32 v41, a57
    v_accvgpr_read_b32 v42, a58
    v_accvgpr_read_b32 v43, a59
    v_accvgpr_read_b32 v44, a60
    v_accvgpr_read_b32 v45, a61
    v_accvgpr_read_b32 v46, a62
    v_accvgpr_read_b32 v47, a63
    v_mul_f32 v16, v16, v32
    v_mul_f32 v17, v17, v33
    v_mul_f32 v18, v18, v34
    v_mul_f32 v19, v19, v35
    v_mul_f32 v20, v20, v36
    v_mul_f32 v21, v21, v37
    v_mul_f32 v22, v22, v38
    v_mul_f32 v23, v23, v39
    v_mul_f32 v24, v24, v40
    v_mul_f32 v25, v25, v41
    v_mul_f32 v26, v26, v42
    v_mul_f32 v27, v27, v43
    v_mul_f32 v28, v28, v44
    v_mul_f32 v29, v29, v45
    v_mul_f32 v30, v30, v46
    v_mul_f32 v31, v31, v47
    v_cvt_pk_bf16_f32 v56, v16, v17
    v_cvt_pk_bf16_f32 v57, v18, v19
    v_cvt_pk_bf16_f32 v58, v20, v21
    v_cvt_pk_bf16_f32 v59, v22, v23
    v_cvt_pk_bf16_f32 v60, v24, v25
    v_cvt_pk_bf16_f32 v61, v26, v27
    v_cvt_pk_bf16_f32 v62, v28, v29
    v_cvt_pk_bf16_f32 v63, v30, v31
    s_nop 0
    v_permlane32_swap_b32 v56, v58
    v_permlane32_swap_b32 v57, v59
    v_permlane32_swap_b32 v60, v62
    v_permlane32_swap_b32 v61, v63
    buffer_store_dwordx4 v[56:59], v1, s[8:11], s24 offen offset:2048 sc1
    buffer_store_dwordx4 v[60:63], v1, s[8:11], s24 offen offset:3072 sc1
    v_accvgpr_read_b32 v16, a64
    v_accvgpr_read_b32 v17, a65
    v_accvgpr_read_b32 v18, a66
    v_accvgpr_read_b32 v19, a67
    v_accvgpr_read_b32 v20, a68
    v_accvgpr_read_b32 v21, a69
    v_accvgpr_read_b32 v22, a70
    v_accvgpr_read_b32 v23, a71
    v_accvgpr_read_b32 v24, a72
    v_accvgpr_read_b32 v25, a73
    v_accvgpr_read_b32 v26, a74
    v_accvgpr_read_b32 v27, a75
    v_accvgpr_read_b32 v28, a76
    v_accvgpr_read_b32 v29, a77
    v_accvgpr_read_b32 v30, a78
    v_accvgpr_read_b32 v31, a79
    v_mul_f32 v32, s26, v16
    v_mul_f32 v33, s26, v17
    v_mul_f32 v34, s26, v18
    v_mul_f32 v35, s26, v19
    v_mul_f32 v36, s26, v20
    v_mul_f32 v37, s26, v21
    v_mul_f32 v38, s26, v22
    v_mul_f32 v39, s26, v23
    v_mul_f32 v40, s26, v24
    v_mul_f32 v41, s26, v25
    v_mul_f32 v42, s26, v26
    v_mul_f32 v43, s26, v27
    v_mul_f32 v44, s26, v28
    v_mul_f32 v45, s26, v29
    v_mul_f32 v46, s26, v30
    v_mul_f32 v47, s26, v31
    v_exp_f32 v32, v32
    v_exp_f32 v33, v33
    v_exp_f32 v34, v34
    v_exp_f32 v35, v35
    v_exp_f32 v36, v36
    v_exp_f32 v37, v37
    v_exp_f32 v38, v38
    v_exp_f32 v39, v39
    v_exp_f32 v40, v40
    v_exp_f32 v41, v41
    v_exp_f32 v42, v42
    v_exp_f32 v43, v43
    v_exp_f32 v44, v44
    v_exp_f32 v45, v45
    v_exp_f32 v46, v46
    v_exp_f32 v47, v47
    v_add_f32 v32, 1.0, v32
    v_add_f32 v33, 1.0, v33
    v_add_f32 v34, 1.0, v34
    v_add_f32 v35, 1.0, v35
    v_add_f32 v36, 1.0, v36
    v_add_f32 v37, 1.0, v37
    v_add_f32 v38, 1.0, v38
    v_add_f32 v39, 1.0, v39
    v_add_f32 v40, 1.0, v40
    v_add_f32 v41, 1.0, v41
    v_add_f32 v42, 1.0, v42
    v_add_f32 v43, 1.0, v43
    v_add_f32 v44, 1.0, v44
    v_add_f32 v45, 1.0, v45
    v_add_f32 v46, 1.0, v46
    v_add_f32 v47, 1.0, v47
    v_rcp_f32 v32, v32
    v_rcp_f32 v33, v33
    v_rcp_f32 v34, v34
    v_rcp_f32 v35, v35
    v_rcp_f32 v36, v36
    v_rcp_f32 v37, v37
    v_rcp_f32 v38, v38
    v_rcp_f32 v39, v39
    v_rcp_f32 v40, v40
    v_rcp_f32 v41, v41
    v_rcp_f32 v42, v42
    v_rcp_f32 v43, v43
    v_rcp_f32 v44, v44
    v_rcp_f32 v45, v45
    v_rcp_f32 v46, v46
    v_rcp_f32 v47, v47
    v_mul_f32 v16, v16, v32
    v_mul_f32 v17, v17, v33
    v_mul_f32 v18, v18, v34
    v_mul_f32 v19, v19, v35
    v_mul_f32 v20, v20, v36
    v_mul_f32 v21, v21, v37
    v_mul_f32 v22, v22, v38
    v_mul_f32 v23, v23, v39
    v_mul_f32 v24, v24, v40
    v_mul_f32 v25, v25, v41
    v_mul_f32 v26, v26, v42
    v_mul_f32 v27, v27, v43
    v_mul_f32 v28, v28, v44
    v_mul_f32 v29, v29, v45
    v_mul_f32 v30, v30, v46
    v_mul_f32 v31, v31, v47
    v_accvgpr_read_b32 v32, a96
    v_accvgpr_read_b32 v33, a97
    v_accvgpr_read_b32 v34, a98
    v_accvgpr_read_b32 v35, a99
    v_accvgpr_read_b32 v36, a100
    v_accvgpr_read_b32 v37, a101
    v_accvgpr_read_b32 v38, a102
    v_accvgpr_read_b32 v39, a103
    v_accvgpr_read_b32 v40, a104
    v_accvgpr_read_b32 v41, a105
    v_accvgpr_read_b32 v42, a106
    v_accvgpr_read_b32 v43, a107
    v_accvgpr_read_b32 v44, a108
    v_accvgpr_read_b32 v45, a109
    v_accvgpr_read_b32 v46, a110
    v_accvgpr_read_b32 v47, a111
    v_mul_f32 v16, v16, v32
    v_mul_f32 v17, v17, v33
    v_mul_f32 v18, v18, v34
    v_mul_f32 v19, v19, v35
    v_mul_f32 v20, v20, v36
    v_mul_f32 v21, v21, v37
    v_mul_f32 v22, v22, v38
    v_mul_f32 v23, v23, v39
    v_mul_f32 v24, v24, v40
    v_mul_f32 v25, v25, v41
    v_mul_f32 v26, v26, v42
    v_mul_f32 v27, v27, v43
    v_mul_f32 v28, v28, v44
    v_mul_f32 v29, v29, v45
    v_mul_f32 v30, v30, v46
    v_mul_f32 v31, v31, v47
    v_cvt_pk_bf16_f32 v48, v16, v17
    v_cvt_pk_bf16_f32 v49, v18, v19
    v_cvt_pk_bf16_f32 v50, v20, v21
    v_cvt_pk_bf16_f32 v51, v22, v23
    v_cvt_pk_bf16_f32 v52, v24, v25
    v_cvt_pk_bf16_f32 v53, v26, v27
    v_cvt_pk_bf16_f32 v54, v28, v29
    v_cvt_pk_bf16_f32 v55, v30, v31
    s_add_u32 s24, s45, 491520
    s_nop 0
    v_permlane32_swap_b32 v48, v50
    v_permlane32_swap_b32 v49, v51
    v_permlane32_swap_b32 v52, v54
    v_permlane32_swap_b32 v53, v55
    buffer_store_dwordx4 v[48:51], v1, s[8:11], s24 offen offset:0 sc1
    buffer_store_dwordx4 v[52:55], v1, s[8:11], s24 offen offset:1024 sc1
    v_accvgpr_read_b32 v16, a80
    v_accvgpr_read_b32 v17, a81
    v_accvgpr_read_b32 v18, a82
    v_accvgpr_read_b32 v19, a83
    v_accvgpr_read_b32 v20, a84
    v_accvgpr_read_b32 v21, a85
    v_accvgpr_read_b32 v22, a86
    v_accvgpr_read_b32 v23, a87
    v_accvgpr_read_b32 v24, a88
    v_accvgpr_read_b32 v25, a89
    v_accvgpr_read_b32 v26, a90
    v_accvgpr_read_b32 v27, a91
    v_accvgpr_read_b32 v28, a92
    v_accvgpr_read_b32 v29, a93
    v_accvgpr_read_b32 v30, a94
    v_accvgpr_read_b32 v31, a95
    v_mul_f32 v32, s26, v16
    v_mul_f32 v33, s26, v17
    v_mul_f32 v34, s26, v18
    v_mul_f32 v35, s26, v19
    v_mul_f32 v36, s26, v20
    v_mul_f32 v37, s26, v21
    v_mul_f32 v38, s26, v22
    v_mul_f32 v39, s26, v23
    v_mul_f32 v40, s26, v24
    v_mul_f32 v41, s26, v25
    v_mul_f32 v42, s26, v26
    v_mul_f32 v43, s26, v27
    v_mul_f32 v44, s26, v28
    v_mul_f32 v45, s26, v29
    v_mul_f32 v46, s26, v30
    v_mul_f32 v47, s26, v31
    v_exp_f32 v32, v32
    v_exp_f32 v33, v33
    v_exp_f32 v34, v34
    v_exp_f32 v35, v35
    v_exp_f32 v36, v36
    v_exp_f32 v37, v37
    v_exp_f32 v38, v38
    v_exp_f32 v39, v39
    v_exp_f32 v40, v40
    v_exp_f32 v41, v41
    v_exp_f32 v42, v42
    v_exp_f32 v43, v43
    v_exp_f32 v44, v44
    v_exp_f32 v45, v45
    v_exp_f32 v46, v46
    v_exp_f32 v47, v47
    v_add_f32 v32, 1.0, v32
    v_add_f32 v33, 1.0, v33
    v_add_f32 v34, 1.0, v34
    v_add_f32 v35, 1.0, v35
    v_add_f32 v36, 1.0, v36
    v_add_f32 v37, 1.0, v37
    v_add_f32 v38, 1.0, v38
    v_add_f32 v39, 1.0, v39
    v_add_f32 v40, 1.0, v40
    v_add_f32 v41, 1.0, v41
    v_add_f32 v42, 1.0, v42
    v_add_f32 v43, 1.0, v43
    v_add_f32 v44, 1.0, v44
    v_add_f32 v45, 1.0, v45
    v_add_f32 v46, 1.0, v46
    v_add_f32 v47, 1.0, v47
    v_rcp_f32 v32, v32
    v_rcp_f32 v33, v33
    v_rcp_f32 v34, v34
    v_rcp_f32 v35, v35
    v_rcp_f32 v36, v36
    v_rcp_f32 v37, v37
    v_rcp_f32 v38, v38
    v_rcp_f32 v39, v39
    v_rcp_f32 v40, v40
    v_rcp_f32 v41, v41
    v_rcp_f32 v42, v42
    v_rcp_f32 v43, v43
    v_rcp_f32 v44, v44
    v_rcp_f32 v45, v45
    v_rcp_f32 v46, v46
    v_rcp_f32 v47, v47
    v_mul_f32 v16, v16, v32
    v_mul_f32 v17, v17, v33
    v_mul_f32 v18, v18, v34
    v_mul_f32 v19, v19, v35
    v_mul_f32 v20, v20, v36
    v_mul_f32 v21, v21, v37
    v_mul_f32 v22, v22, v38
    v_mul_f32 v23, v23, v39
    v_mul_f32 v24, v24, v40
    v_mul_f32 v25, v25, v41
    v_mul_f32 v26, v26, v42
    v_mul_f32 v27, v27, v43
    v_mul_f32 v28, v28, v44
    v_mul_f32 v29, v29, v45
    v_mul_f32 v30, v30, v46
    v_mul_f32 v31, v31, v47
    v_accvgpr_read_b32 v32, a112
    v_accvgpr_read_b32 v33, a113
    v_accvgpr_read_b32 v34, a114
    v_accvgpr_read_b32 v35, a115
    v_accvgpr_read_b32 v36, a116
    v_accvgpr_read_b32 v37, a117
    v_accvgpr_read_b32 v38, a118
    v_accvgpr_read_b32 v39, a119
    v_accvgpr_read_b32 v40, a120
    v_accvgpr_read_b32 v41, a121
    v_accvgpr_read_b32 v42, a122
    v_accvgpr_read_b32 v43, a123
    v_accvgpr_read_b32 v44, a124
    v_accvgpr_read_b32 v45, a125
    v_accvgpr_read_b32 v46, a126
    v_accvgpr_read_b32 v47, a127
    v_mul_f32 v16, v16, v32
    v_mul_f32 v17, v17, v33
    v_mul_f32 v18, v18, v34
    v_mul_f32 v19, v19, v35
    v_mul_f32 v20, v20, v36
    v_mul_f32 v21, v21, v37
    v_mul_f32 v22, v22, v38
    v_mul_f32 v23, v23, v39
    v_mul_f32 v24, v24, v40
    v_mul_f32 v25, v25, v41
    v_mul_f32 v26, v26, v42
    v_mul_f32 v27, v27, v43
    v_mul_f32 v28, v28, v44
    v_mul_f32 v29, v29, v45
    v_mul_f32 v30, v30, v46
    v_mul_f32 v31, v31, v47
    v_cvt_pk_bf16_f32 v56, v16, v17
    v_cvt_pk_bf16_f32 v57, v18, v19
    v_cvt_pk_bf16_f32 v58, v20, v21
    v_cvt_pk_bf16_f32 v59, v22, v23
    v_cvt_pk_bf16_f32 v60, v24, v25
    v_cvt_pk_bf16_f32 v61, v26, v27
    v_cvt_pk_bf16_f32 v62, v28, v29
    v_cvt_pk_bf16_f32 v63, v30, v31
    s_nop 0
    v_permlane32_swap_b32 v56, v58
    v_permlane32_swap_b32 v57, v59
    v_permlane32_swap_b32 v60, v62
    v_permlane32_swap_b32 v61, v63
    buffer_store_dwordx4 v[56:59], v1, s[8:11], s24 offen offset:2048 sc1
    buffer_store_dwordx4 v[60:63], v1, s[8:11], s24 offen offset:3072 sc1
    v_accvgpr_read_b32 v16, a128
    v_accvgpr_read_b32 v17, a129
    v_accvgpr_read_b32 v18, a130
    v_accvgpr_read_b32 v19, a131
    v_accvgpr_read_b32 v20, a132
    v_accvgpr_read_b32 v21, a133
    v_accvgpr_read_b32 v22, a134
    v_accvgpr_read_b32 v23, a135
    v_accvgpr_read_b32 v24, a136
    v_accvgpr_read_b32 v25, a137
    v_accvgpr_read_b32 v26, a138
    v_accvgpr_read_b32 v27, a139
    v_accvgpr_read_b32 v28, a140
    v_accvgpr_read_b32 v29, a141
    v_accvgpr_read_b32 v30, a142
    v_accvgpr_read_b32 v31, a143
    v_mul_f32 v32, s26, v16
    v_mul_f32 v33, s26, v17
    v_mul_f32 v34, s26, v18
    v_mul_f32 v35, s26, v19
    v_mul_f32 v36, s26, v20
    v_mul_f32 v37, s26, v21
    v_mul_f32 v38, s26, v22
    v_mul_f32 v39, s26, v23
    v_mul_f32 v40, s26, v24
    v_mul_f32 v41, s26, v25
    v_mul_f32 v42, s26, v26
    v_mul_f32 v43, s26, v27
    v_mul_f32 v44, s26, v28
    v_mul_f32 v45, s26, v29
    v_mul_f32 v46, s26, v30
    v_mul_f32 v47, s26, v31
    v_exp_f32 v32, v32
    v_exp_f32 v33, v33
    v_exp_f32 v34, v34
    v_exp_f32 v35, v35
    v_exp_f32 v36, v36
    v_exp_f32 v37, v37
    v_exp_f32 v38, v38
    v_exp_f32 v39, v39
    v_exp_f32 v40, v40
    v_exp_f32 v41, v41
    v_exp_f32 v42, v42
    v_exp_f32 v43, v43
    v_exp_f32 v44, v44
    v_exp_f32 v45, v45
    v_exp_f32 v46, v46
    v_exp_f32 v47, v47
    v_add_f32 v32, 1.0, v32
    v_add_f32 v33, 1.0, v33
    v_add_f32 v34, 1.0, v34
    v_add_f32 v35, 1.0, v35
    v_add_f32 v36, 1.0, v36
    v_add_f32 v37, 1.0, v37
    v_add_f32 v38, 1.0, v38
    v_add_f32 v39, 1.0, v39
    v_add_f32 v40, 1.0, v40
    v_add_f32 v41, 1.0, v41
    v_add_f32 v42, 1.0, v42
    v_add_f32 v43, 1.0, v43
    v_add_f32 v44, 1.0, v44
    v_add_f32 v45, 1.0, v45
    v_add_f32 v46, 1.0, v46
    v_add_f32 v47, 1.0, v47
    v_rcp_f32 v32, v32
    v_rcp_f32 v33, v33
    v_rcp_f32 v34, v34
    v_rcp_f32 v35, v35
    v_rcp_f32 v36, v36
    v_rcp_f32 v37, v37
    v_rcp_f32 v38, v38
    v_rcp_f32 v39, v39
    v_rcp_f32 v40, v40
    v_rcp_f32 v41, v41
    v_rcp_f32 v42, v42
    v_rcp_f32 v43, v43
    v_rcp_f32 v44, v44
    v_rcp_f32 v45, v45
    v_rcp_f32 v46, v46
    v_rcp_f32 v47, v47
    v_mul_f32 v16, v16, v32
    v_mul_f32 v17, v17, v33
    v_mul_f32 v18, v18, v34
    v_mul_f32 v19, v19, v35
    v_mul_f32 v20, v20, v36
    v_mul_f32 v21, v21, v37
    v_mul_f32 v22, v22, v38
    v_mul_f32 v23, v23, v39
    v_mul_f32 v24, v24, v40
    v_mul_f32 v25, v25, v41
    v_mul_f32 v26, v26, v42
    v_mul_f32 v27, v27, v43
    v_mul_f32 v28, v28, v44
    v_mul_f32 v29, v29, v45
    v_mul_f32 v30, v30, v46
    v_mul_f32 v31, v31, v47
    v_accvgpr_read_b32 v32, a160
    v_accvgpr_read_b32 v33, a161
    v_accvgpr_read_b32 v34, a162
    v_accvgpr_read_b32 v35, a163
    v_accvgpr_read_b32 v36, a164
    v_accvgpr_read_b32 v37, a165
    v_accvgpr_read_b32 v38, a166
    v_accvgpr_read_b32 v39, a167
    v_accvgpr_read_b32 v40, a168
    v_accvgpr_read_b32 v41, a169
    v_accvgpr_read_b32 v42, a170
    v_accvgpr_read_b32 v43, a171
    v_accvgpr_read_b32 v44, a172
    v_accvgpr_read_b32 v45, a173
    v_accvgpr_read_b32 v46, a174
    v_accvgpr_read_b32 v47, a175
    v_mul_f32 v16, v16, v32
    v_mul_f32 v17, v17, v33
    v_mul_f32 v18, v18, v34
    v_mul_f32 v19, v19, v35
    v_mul_f32 v20, v20, v36
    v_mul_f32 v21, v21, v37
    v_mul_f32 v22, v22, v38
    v_mul_f32 v23, v23, v39
    v_mul_f32 v24, v24, v40
    v_mul_f32 v25, v25, v41
    v_mul_f32 v26, v26, v42
    v_mul_f32 v27, v27, v43
    v_mul_f32 v28, v28, v44
    v_mul_f32 v29, v29, v45
    v_mul_f32 v30, v30, v46
    v_mul_f32 v31, v31, v47
    v_cvt_pk_bf16_f32 v48, v16, v17
    v_cvt_pk_bf16_f32 v49, v18, v19
    v_cvt_pk_bf16_f32 v50, v20, v21
    v_cvt_pk_bf16_f32 v51, v22, v23
    v_cvt_pk_bf16_f32 v52, v24, v25
    v_cvt_pk_bf16_f32 v53, v26, v27
    v_cvt_pk_bf16_f32 v54, v28, v29
    v_cvt_pk_bf16_f32 v55, v30, v31
    s_add_u32 s24, s45, 983040
    s_nop 0
    v_permlane32_swap_b32 v48, v50
    v_permlane32_swap_b32 v49, v51
    v_permlane32_swap_b32 v52, v54
    v_permlane32_swap_b32 v53, v55
    buffer_store_dwordx4 v[48:51], v1, s[8:11], s24 offen offset:0 sc1
    buffer_store_dwordx4 v[52:55], v1, s[8:11], s24 offen offset:1024 sc1
    v_accvgpr_read_b32 v16, a144
    v_accvgpr_read_b32 v17, a145
    v_accvgpr_read_b32 v18, a146
    v_accvgpr_read_b32 v19, a147
    v_accvgpr_read_b32 v20, a148
    v_accvgpr_read_b32 v21, a149
    v_accvgpr_read_b32 v22, a150
    v_accvgpr_read_b32 v23, a151
    v_accvgpr_read_b32 v24, a152
    v_accvgpr_read_b32 v25, a153
    v_accvgpr_read_b32 v26, a154
    v_accvgpr_read_b32 v27, a155
    v_accvgpr_read_b32 v28, a156
    v_accvgpr_read_b32 v29, a157
    v_accvgpr_read_b32 v30, a158
    v_accvgpr_read_b32 v31, a159
    v_mul_f32 v32, s26, v16
    v_mul_f32 v33, s26, v17
    v_mul_f32 v34, s26, v18
    v_mul_f32 v35, s26, v19
    v_mul_f32 v36, s26, v20
    v_mul_f32 v37, s26, v21
    v_mul_f32 v38, s26, v22
    v_mul_f32 v39, s26, v23
    v_mul_f32 v40, s26, v24
    v_mul_f32 v41, s26, v25
    v_mul_f32 v42, s26, v26
    v_mul_f32 v43, s26, v27
    v_mul_f32 v44, s26, v28
    v_mul_f32 v45, s26, v29
    v_mul_f32 v46, s26, v30
    v_mul_f32 v47, s26, v31
    v_exp_f32 v32, v32
    v_exp_f32 v33, v33
    v_exp_f32 v34, v34
    v_exp_f32 v35, v35
    v_exp_f32 v36, v36
    v_exp_f32 v37, v37
    v_exp_f32 v38, v38
    v_exp_f32 v39, v39
    v_exp_f32 v40, v40
    v_exp_f32 v41, v41
    v_exp_f32 v42, v42
    v_exp_f32 v43, v43
    v_exp_f32 v44, v44
    v_exp_f32 v45, v45
    v_exp_f32 v46, v46
    v_exp_f32 v47, v47
    v_add_f32 v32, 1.0, v32
    v_add_f32 v33, 1.0, v33
    v_add_f32 v34, 1.0, v34
    v_add_f32 v35, 1.0, v35
    v_add_f32 v36, 1.0, v36
    v_add_f32 v37, 1.0, v37
    v_add_f32 v38, 1.0, v38
    v_add_f32 v39, 1.0, v39
    v_add_f32 v40, 1.0, v40
    v_add_f32 v41, 1.0, v41
    v_add_f32 v42, 1.0, v42
    v_add_f32 v43, 1.0, v43
    v_add_f32 v44, 1.0, v44
    v_add_f32 v45, 1.0, v45
    v_add_f32 v46, 1.0, v46
    v_add_f32 v47, 1.0, v47
    v_rcp_f32 v32, v32
    v_rcp_f32 v33, v33
    v_rcp_f32 v34, v34
    v_rcp_f32 v35, v35
    v_rcp_f32 v36, v36
    v_rcp_f32 v37, v37
    v_rcp_f32 v38, v38
    v_rcp_f32 v39, v39
    v_rcp_f32 v40, v40
    v_rcp_f32 v41, v41
    v_rcp_f32 v42, v42
    v_rcp_f32 v43, v43
    v_rcp_f32 v44, v44
    v_rcp_f32 v45, v45
    v_rcp_f32 v46, v46
    v_rcp_f32 v47, v47
    v_mul_f32 v16, v16, v32
    v_mul_f32 v17, v17, v33
    v_mul_f32 v18, v18, v34
    v_mul_f32 v19, v19, v35
    v_mul_f32 v20, v20, v36
    v_mul_f32 v21, v21, v37
    v_mul_f32 v22, v22, v38
    v_mul_f32 v23, v23, v39
    v_mul_f32 v24, v24, v40
    v_mul_f32 v25, v25, v41
    v_mul_f32 v26, v26, v42
    v_mul_f32 v27, v27, v43
    v_mul_f32 v28, v28, v44
    v_mul_f32 v29, v29, v45
    v_mul_f32 v30, v30, v46
    v_mul_f32 v31, v31, v47
    v_accvgpr_read_b32 v32, a176
    v_accvgpr_read_b32 v33, a177
    v_accvgpr_read_b32 v34, a178
    v_accvgpr_read_b32 v35, a179
    v_accvgpr_read_b32 v36, a180
    v_accvgpr_read_b32 v37, a181
    v_accvgpr_read_b32 v38, a182
    v_accvgpr_read_b32 v39, a183
    v_accvgpr_read_b32 v40, a184
    v_accvgpr_read_b32 v41, a185
    v_accvgpr_read_b32 v42, a186
    v_accvgpr_read_b32 v43, a187
    v_accvgpr_read_b32 v44, a188
    v_accvgpr_read_b32 v45, a189
    v_accvgpr_read_b32 v46, a190
    v_accvgpr_read_b32 v47, a191
    v_mul_f32 v16, v16, v32
    v_mul_f32 v17, v17, v33
    v_mul_f32 v18, v18, v34
    v_mul_f32 v19, v19, v35
    v_mul_f32 v20, v20, v36
    v_mul_f32 v21, v21, v37
    v_mul_f32 v22, v22, v38
    v_mul_f32 v23, v23, v39
    v_mul_f32 v24, v24, v40
    v_mul_f32 v25, v25, v41
    v_mul_f32 v26, v26, v42
    v_mul_f32 v27, v27, v43
    v_mul_f32 v28, v28, v44
    v_mul_f32 v29, v29, v45
    v_mul_f32 v30, v30, v46
    v_mul_f32 v31, v31, v47
    v_cvt_pk_bf16_f32 v56, v16, v17
    v_cvt_pk_bf16_f32 v57, v18, v19
    v_cvt_pk_bf16_f32 v58, v20, v21
    v_cvt_pk_bf16_f32 v59, v22, v23
    v_cvt_pk_bf16_f32 v60, v24, v25
    v_cvt_pk_bf16_f32 v61, v26, v27
    v_cvt_pk_bf16_f32 v62, v28, v29
    v_cvt_pk_bf16_f32 v63, v30, v31
    s_nop 0
    v_permlane32_swap_b32 v56, v58
    v_permlane32_swap_b32 v57, v59
    v_permlane32_swap_b32 v60, v62
    v_permlane32_swap_b32 v61, v63
    buffer_store_dwordx4 v[56:59], v1, s[8:11], s24 offen offset:2048 sc1
    buffer_store_dwordx4 v[60:63], v1, s[8:11], s24 offen offset:3072 sc1
    v_accvgpr_read_b32 v16, a192
    v_accvgpr_read_b32 v17, a193
    v_accvgpr_read_b32 v18, a194
    v_accvgpr_read_b32 v19, a195
    v_accvgpr_read_b32 v20, a196
    v_accvgpr_read_b32 v21, a197
    v_accvgpr_read_b32 v22, a198
    v_accvgpr_read_b32 v23, a199
    v_accvgpr_read_b32 v24, a200
    v_accvgpr_read_b32 v25, a201
    v_accvgpr_read_b32 v26, a202
    v_accvgpr_read_b32 v27, a203
    v_accvgpr_read_b32 v28, a204
    v_accvgpr_read_b32 v29, a205
    v_accvgpr_read_b32 v30, a206
    v_accvgpr_read_b32 v31, a207
    v_mul_f32 v32, s26, v16
    v_mul_f32 v33, s26, v17
    v_mul_f32 v34, s26, v18
    v_mul_f32 v35, s26, v19
    v_mul_f32 v36, s26, v20
    v_mul_f32 v37, s26, v21
    v_mul_f32 v38, s26, v22
    v_mul_f32 v39, s26, v23
    v_mul_f32 v40, s26, v24
    v_mul_f32 v41, s26, v25
    v_mul_f32 v42, s26, v26
    v_mul_f32 v43, s26, v27
    v_mul_f32 v44, s26, v28
    v_mul_f32 v45, s26, v29
    v_mul_f32 v46, s26, v30
    v_mul_f32 v47, s26, v31
    v_exp_f32 v32, v32
    v_exp_f32 v33, v33
    v_exp_f32 v34, v34
    v_exp_f32 v35, v35
    v_exp_f32 v36, v36
    v_exp_f32 v37, v37
    v_exp_f32 v38, v38
    v_exp_f32 v39, v39
    v_exp_f32 v40, v40
    v_exp_f32 v41, v41
    v_exp_f32 v42, v42
    v_exp_f32 v43, v43
    v_exp_f32 v44, v44
    v_exp_f32 v45, v45
    v_exp_f32 v46, v46
    v_exp_f32 v47, v47
    v_add_f32 v32, 1.0, v32
    v_add_f32 v33, 1.0, v33
    v_add_f32 v34, 1.0, v34
    v_add_f32 v35, 1.0, v35
    v_add_f32 v36, 1.0, v36
    v_add_f32 v37, 1.0, v37
    v_add_f32 v38, 1.0, v38
    v_add_f32 v39, 1.0, v39
    v_add_f32 v40, 1.0, v40
    v_add_f32 v41, 1.0, v41
    v_add_f32 v42, 1.0, v42
    v_add_f32 v43, 1.0, v43
    v_add_f32 v44, 1.0, v44
    v_add_f32 v45, 1.0, v45
    v_add_f32 v46, 1.0, v46
    v_add_f32 v47, 1.0, v47
    v_rcp_f32 v32, v32
    v_rcp_f32 v33, v33
    v_rcp_f32 v34, v34
    v_rcp_f32 v35, v35
    v_rcp_f32 v36, v36
    v_rcp_f32 v37, v37
    v_rcp_f32 v38, v38
    v_rcp_f32 v39, v39
    v_rcp_f32 v40, v40
    v_rcp_f32 v41, v41
    v_rcp_f32 v42, v42
    v_rcp_f32 v43, v43
    v_rcp_f32 v44, v44
    v_rcp_f32 v45, v45
    v_rcp_f32 v46, v46
    v_rcp_f32 v47, v47
    v_mul_f32 v16, v16, v32
    v_mul_f32 v17, v17, v33
    v_mul_f32 v18, v18, v34
    v_mul_f32 v19, v19, v35
    v_mul_f32 v20, v20, v36
    v_mul_f32 v21, v21, v37
    v_mul_f32 v22, v22, v38
    v_mul_f32 v23, v23, v39
    v_mul_f32 v24, v24, v40
    v_mul_f32 v25, v25, v41
    v_mul_f32 v26, v26, v42
    v_mul_f32 v27, v27, v43
    v_mul_f32 v28, v28, v44
    v_mul_f32 v29, v29, v45
    v_mul_f32 v30, v30, v46
    v_mul_f32 v31, v31, v47
    v_accvgpr_read_b32 v32, a224
    v_accvgpr_read_b32 v33, a225
    v_accvgpr_read_b32 v34, a226
    v_accvgpr_read_b32 v35, a227
    v_accvgpr_read_b32 v36, a228
    v_accvgpr_read_b32 v37, a229
    v_accvgpr_read_b32 v38, a230
    v_accvgpr_read_b32 v39, a231
    v_accvgpr_read_b32 v40, a232
    v_accvgpr_read_b32 v41, a233
    v_accvgpr_read_b32 v42, a234
    v_accvgpr_read_b32 v43, a235
    v_accvgpr_read_b32 v44, a236
    v_accvgpr_read_b32 v45, a237
    v_accvgpr_read_b32 v46, a238
    v_accvgpr_read_b32 v47, a239
    v_mul_f32 v16, v16, v32
    v_mul_f32 v17, v17, v33
    v_mul_f32 v18, v18, v34
    v_mul_f32 v19, v19, v35
    v_mul_f32 v20, v20, v36
    v_mul_f32 v21, v21, v37
    v_mul_f32 v22, v22, v38
    v_mul_f32 v23, v23, v39
    v_mul_f32 v24, v24, v40
    v_mul_f32 v25, v25, v41
    v_mul_f32 v26, v26, v42
    v_mul_f32 v27, v27, v43
    v_mul_f32 v28, v28, v44
    v_mul_f32 v29, v29, v45
    v_mul_f32 v30, v30, v46
    v_mul_f32 v31, v31, v47
    v_cvt_pk_bf16_f32 v48, v16, v17
    v_cvt_pk_bf16_f32 v49, v18, v19
    v_cvt_pk_bf16_f32 v50, v20, v21
    v_cvt_pk_bf16_f32 v51, v22, v23
    v_cvt_pk_bf16_f32 v52, v24, v25
    v_cvt_pk_bf16_f32 v53, v26, v27
    v_cvt_pk_bf16_f32 v54, v28, v29
    v_cvt_pk_bf16_f32 v55, v30, v31
    s_add_u32 s24, s45, 1474560
    s_nop 0
    v_permlane32_swap_b32 v48, v50
    v_permlane32_swap_b32 v49, v51
    v_permlane32_swap_b32 v52, v54
    v_permlane32_swap_b32 v53, v55
    buffer_store_dwordx4 v[48:51], v1, s[8:11], s24 offen offset:0 sc1
    buffer_store_dwordx4 v[52:55], v1, s[8:11], s24 offen offset:1024 sc1
    v_accvgpr_read_b32 v16, a208
    v_accvgpr_read_b32 v17, a209
    v_accvgpr_read_b32 v18, a210
    v_accvgpr_read_b32 v19, a211
    v_accvgpr_read_b32 v20, a212
    v_accvgpr_read_b32 v21, a213
    v_accvgpr_read_b32 v22, a214
    v_accvgpr_read_b32 v23, a215
    v_accvgpr_read_b32 v24, a216
    v_accvgpr_read_b32 v25, a217
    v_accvgpr_read_b32 v26, a218
    v_accvgpr_read_b32 v27, a219
    v_accvgpr_read_b32 v28, a220
    v_accvgpr_read_b32 v29, a221
    v_accvgpr_read_b32 v30, a222
    v_accvgpr_read_b32 v31, a223
    v_mul_f32 v32, s26, v16
    v_mul_f32 v33, s26, v17
    v_mul_f32 v34, s26, v18
    v_mul_f32 v35, s26, v19
    v_mul_f32 v36, s26, v20
    v_mul_f32 v37, s26, v21
    v_mul_f32 v38, s26, v22
    v_mul_f32 v39, s26, v23
    v_mul_f32 v40, s26, v24
    v_mul_f32 v41, s26, v25
    v_mul_f32 v42, s26, v26
    v_mul_f32 v43, s26, v27
    v_mul_f32 v44, s26, v28
    v_mul_f32 v45, s26, v29
    v_mul_f32 v46, s26, v30
    v_mul_f32 v47, s26, v31
    v_exp_f32 v32, v32
    v_exp_f32 v33, v33
    v_exp_f32 v34, v34
    v_exp_f32 v35, v35
    v_exp_f32 v36, v36
    v_exp_f32 v37, v37
    v_exp_f32 v38, v38
    v_exp_f32 v39, v39
    v_exp_f32 v40, v40
    v_exp_f32 v41, v41
    v_exp_f32 v42, v42
    v_exp_f32 v43, v43
    v_exp_f32 v44, v44
    v_exp_f32 v45, v45
    v_exp_f32 v46, v46
    v_exp_f32 v47, v47
    v_add_f32 v32, 1.0, v32
    v_add_f32 v33, 1.0, v33
    v_add_f32 v34, 1.0, v34
    v_add_f32 v35, 1.0, v35
    v_add_f32 v36, 1.0, v36
    v_add_f32 v37, 1.0, v37
    v_add_f32 v38, 1.0, v38
    v_add_f32 v39, 1.0, v39
    v_add_f32 v40, 1.0, v40
    v_add_f32 v41, 1.0, v41
    v_add_f32 v42, 1.0, v42
    v_add_f32 v43, 1.0, v43
    v_add_f32 v44, 1.0, v44
    v_add_f32 v45, 1.0, v45
    v_add_f32 v46, 1.0, v46
    v_add_f32 v47, 1.0, v47
    v_rcp_f32 v32, v32
    v_rcp_f32 v33, v33
    v_rcp_f32 v34, v34
    v_rcp_f32 v35, v35
    v_rcp_f32 v36, v36
    v_rcp_f32 v37, v37
    v_rcp_f32 v38, v38
    v_rcp_f32 v39, v39
    v_rcp_f32 v40, v40
    v_rcp_f32 v41, v41
    v_rcp_f32 v42, v42
    v_rcp_f32 v43, v43
    v_rcp_f32 v44, v44
    v_rcp_f32 v45, v45
    v_rcp_f32 v46, v46
    v_rcp_f32 v47, v47
    v_mul_f32 v16, v16, v32
    v_mul_f32 v17, v17, v33
    v_mul_f32 v18, v18, v34
    v_mul_f32 v19, v19, v35
    v_mul_f32 v20, v20, v36
    v_mul_f32 v21, v21, v37
    v_mul_f32 v22, v22, v38
    v_mul_f32 v23, v23, v39
    v_mul_f32 v24, v24, v40
    v_mul_f32 v25, v25, v41
    v_mul_f32 v26, v26, v42
    v_mul_f32 v27, v27, v43
    v_mul_f32 v28, v28, v44
    v_mul_f32 v29, v29, v45
    v_mul_f32 v30, v30, v46
    v_mul_f32 v31, v31, v47
    v_accvgpr_read_b32 v32, a240
    v_accvgpr_read_b32 v33, a241
    v_accvgpr_read_b32 v34, a242
    v_accvgpr_read_b32 v35, a243
    v_accvgpr_read_b32 v36, a244
    v_accvgpr_read_b32 v37, a245
    v_accvgpr_read_b32 v38, a246
    v_accvgpr_read_b32 v39, a247
    v_accvgpr_read_b32 v40, a248
    v_accvgpr_read_b32 v41, a249
    v_accvgpr_read_b32 v42, a250
    v_accvgpr_read_b32 v43, a251
    v_accvgpr_read_b32 v44, a252
    v_accvgpr_read_b32 v45, a253
    v_accvgpr_read_b32 v46, a254
    v_accvgpr_read_b32 v47, a255
    v_mul_f32 v16, v16, v32
    v_mul_f32 v17, v17, v33
    v_mul_f32 v18, v18, v34
    v_mul_f32 v19, v19, v35
    v_mul_f32 v20, v20, v36
    v_mul_f32 v21, v21, v37
    v_mul_f32 v22, v22, v38
    v_mul_f32 v23, v23, v39
    v_mul_f32 v24, v24, v40
    v_mul_f32 v25, v25, v41
    v_mul_f32 v26, v26, v42
    v_mul_f32 v27, v27, v43
    v_mul_f32 v28, v28, v44
    v_mul_f32 v29, v29, v45
    v_mul_f32 v30, v30, v46
    v_mul_f32 v31, v31, v47
    v_cvt_pk_bf16_f32 v56, v16, v17
    v_cvt_pk_bf16_f32 v57, v18, v19
    v_cvt_pk_bf16_f32 v58, v20, v21
    v_cvt_pk_bf16_f32 v59, v22, v23
    v_cvt_pk_bf16_f32 v60, v24, v25
    v_cvt_pk_bf16_f32 v61, v26, v27
    v_cvt_pk_bf16_f32 v62, v28, v29
    v_cvt_pk_bf16_f32 v63, v30, v31
    s_nop 0
    v_permlane32_swap_b32 v56, v58
    v_permlane32_swap_b32 v57, v59
    v_permlane32_swap_b32 v60, v62
    v_permlane32_swap_b32 v61, v63
    buffer_store_dwordx4 v[56:59], v1, s[8:11], s24 offen offset:2048 sc1
    buffer_store_dwordx4 v[60:63], v1, s[8:11], s24 offen offset:3072 sc1
    s_waitcnt vmcnt(0)
    s_barrier
    s_cmp_lg_u32 s3, 0
    s_cbranch_scc1 ub_next
    v_mov_b32 v10, 1
    s_mov_b64 exec, 1
    buffer_atomic_add v10, off, s[8:11], s58
    s_mov_b64 exec, -1
    s_branch ub_next
ub_late:
    s_cmp_eq_u32 s50, 6
    s_cbranch_scc1 ub_at
    s_cmp_eq_u32 s50, 7
    s_cbranch_scc1 ub_eng
    s_cmp_eq_u32 s50, 5
    s_cbranch_scc1 ub_kvs
    s_and_b32 s24, s5, 3
    s_lshl2_add_u32 s46, s51, s24
    s_lshr_b32 s47, s5, 2
    s_cmp_eq_u32 s50, 4
    s_cselect_b32 s24, s46, 0
    s_cmp_ge_u32 s24, 12
    s_cbranch_scc1 ub_next
    s_lshl_b32 s16, s46, 2
    s_add_u32 s16, s16, s3
    s_mul_i32 s16, s16, 491520
    s_add_u32 s16, s16, 54525952
    s_lshl_b32 s58, s46, 7
    s_add_u32 s59, s58, 105912320
    s_add_u32 s58, s58, 105910272
    s_cmp_eq_u32 s50, 3
    s_cselect_b32 s12, s52, s34
    s_cselect_b32 s13, s53, s35
    s_mov_b32 s14, 0x800000
    s_cselect_b32 s14, 0x700000, s14
    s_cselect_b32 s24, 262144, 0
    s_cselect_b32 s48, 13, 15
    s_cselect_b32 s59, 105906432, s59
    s_cselect_b32 s49, 224, 32
    s_and_b32 s13, s13, 0xffff
    s_mov_b32 s15, 0x20000
    s_add_u32 s16, s16, s24
    s_mov_b32 s17, s16
    s_lshl_b32 s18, s3, 15
    s_lshl_b32 s24, s47, 8
    s_add_u32 s18, s18, s24
    s_mov_b32 s20, 131072
    s_mov_b32 s44, 2048
    v_and_b32 v9, 63, v0
    v_lshlrev_b32 v1, 4, v9
    v_lshrrev_b32 v10, 4, v9
    v_bfe_u32 v11, v9, 2, 2
    v_xor_b32 v11, v11, v10
    v_lshlrev_b32 v11, 6, v11
    v_and_b32 v12, 3, v9
    v_lshl_add_u32 v11, v12, 4, v11
    v_mul_lo_u32 v10, v10, s44
    v_add_u32 v2, v10, v11
    s_lshl_b32 s24, s44, 2
    s_sub_u32 s24, s24, 1024
    v_add_u32 v3, s24, v2
    v_add_u32 v4, s24, v3
    v_add_u32 v5, s24, v4
    s_lshr_b32 s24, s3, 1
    s_lshl_b32 s24, s24, 13
    v_add_u32 v6, s24, v1
    v_add_u32 v7, 0x10000, v6
    v_lshrrev_b32 v10, 5, v9
    v_lshlrev_b32 v10, 3, v10
    v_bfe_u32 v11, v9, 2, 2
    v_add_u32 v10, v10, v11
    v_lshlrev_b32 v10, 8, v10
    v_bfe_u32 v12, v9, 4, 1
    v_lshl_add_u32 v10, v12, 5, v10
    v_and_b32 v12, 3, v9
    v_lshl_add_u32 v10, v12, 3, v10
    v_add_u32 v10, 0x4000, v10
    s_and_b32 s24, s3, 1
    s_lshl_b32 s24, s24, 1
    v_xor_b32 v12, s24, v11
    v_lshl_add_u32 v48, v12, 6, v10
    v_add_u32 v50, 0x10000, v48
    v_xor_b32 v12, s24, v11
    v_xor_b32 v12, 1, v12
    v_lshl_add_u32 v49, v12, 6, v10
    v_add_u32 v51, 0x10000, v49
    s_lshl_b32 s22, s3, 12
    s_lshl_b32 s45, s46, 18
    s_lshr_b32 s24, s3, 1
    s_lshl_b32 s24, s24, 17
    s_add_u32 s45, s45, s24
    s_lshl_b32 s24, s47, 8
    s_add_u32 s45, s45, s24
    s_and_b32 s24, s3, 1
    s_lshl_b32 s24, s24, 7
    s_add_u32 s45, s45, s24
    s_lshl_b32 s43, s46, 3
    s_add_u32 s43, s43, s47
    s_lshl_b32 s43, s43, 2
    s_add_u32 s43, s43, s3
    s_lshl_b32 s43, s43, 13
    s_add_u32 s43, s43, 96468992
wait_17:
    buffer_load_dword v10, off, s[8:11], s59 sc1
    s_waitcnt vmcnt(0)
    v_readfirstlane_b32 s24, v10
    s_cmp_ge_u32 s24, s49
    s_cbranch_scc1 waitok_18
    s_sleep 16
    s_sub_u32 s95, s95, 1
    s_cbranch_scc0 wait_17
    s_mov_b32 s95, 0
waitok_18:
ub_wa2:
    s_add_u32 m0, s22, 0
    s_nop 0
    buffer_load_dwordx4 v1, s[8:11], s16 offen offset:0 sc1 lds
    buffer_load_dwordx4 v1, s[8:11], s16 offen offset:1024 sc1 lds
    buffer_load_dwordx4 v1, s[8:11], s17 offen offset:2048 sc1 lds
    buffer_load_dwordx4 v1, s[8:11], s17 offen offset:3072 sc1 lds
    s_add_u32 m0, s22, 16384
    s_add_u32 s16, s16, 4096
    buffer_load_dwordx4 v2, s[12:15], s18 offen offset:0 lds
    s_add_u32 s17, s17, 4096
    buffer_load_dwordx4 v3, s[12:15], s18 offen offset:1024 lds
    buffer_load_dwordx4 v4, s[12:15], s18 offen offset:2048 lds
    buffer_load_dwordx4 v5, s[12:15], s18 offen offset:3072 lds
    s_add_u32 s18, s18, s20
    s_add_u32 m0, s22, 32768
    s_nop 0
    buffer_load_dwordx4 v1, s[8:11], s16 offen offset:0 sc1 lds
    buffer_load_dwordx4 v1, s[8:11], s16 offen offset:1024 sc1 lds
    buffer_load_dwordx4 v1, s[8:11], s17 offen offset:2048 sc1 lds
    buffer_load_dwordx4 v1, s[8:11], s17 offen offset:3072 sc1 lds
    s_add_u32 m0, s22, 49152
    s_add_u32 s16, s16, 4096
    buffer_load_dwordx4 v2, s[12:15], s18 offen offset:0 lds
    s_add_u32 s17, s17, 4096
    buffer_load_dwordx4 v3, s[12:15], s18 offen offset:1024 lds
    buffer_load_dwordx4 v4, s[12:15], s18 offen offset:2048 lds
    buffer_load_dwordx4 v5, s[12:15], s18 offen offset:3072 lds
    s_add_u32 s18, s18, s20
    s_add_u32 m0, s22, 65536
    s_nop 0
    buffer_load_dwordx4 v1, s[8:11], s16 offen offset:0 sc1 lds
    buffer_load_dwordx4 v1, s[8:11], s16 offen offset:1024 sc1 lds
    buffer_load_dwordx4 v1, s[8:11], s17 offen offset:2048 sc1 lds
    buffer_load_dwordx4 v1, s[8:11], s17 offen offset:3072 sc1 lds
    s_add_u32 m0, s22, 81920
    s_add_u32 s16, s16, 4096
    buffer_load_dwordx4 v2, s[12:15], s18 offen offset:0 lds
    s_add_u32 s17, s17, 4096
    buffer_load_dwordx4 v3, s[12:15], s18 offen offset:1024 lds
    buffer_load_dwordx4 v4, s[12:15], s18 offen offset:2048 lds
    buffer_load_dwordx4 v5, s[12:15], s18 offen offset:3072 lds
    s_add_u32 s18, s18, s20
    s_add_u32 m0, s22, 98304
    s_nop 0
    buffer_load_dwordx4 v1, s[8:11], s16 offen offset:0 sc1 lds
    buffer_load_dwordx4 v1, s[8:11], s16 offen offset:1024 sc1 lds
    buffer_load_dwordx4 v1, s[8:11], s17 offen offset:2048 sc1 lds
    buffer_load_dwordx4 v1, s[8:11], s17 offen offset:3072 sc1 lds
    s_add_u32 m0, s22, 114688
    s_add_u32 s16, s16, 4096
    buffer_load_dwordx4 v2, s[12:15], s18 offen offset:0 lds
    s_add_u32 s17, s17, 4096
    buffer_load_dwordx4 v3, s[12:15], s18 offen offset:1024 lds
    buffer_load_dwordx4 v4, s[12:15], s18 offen offset:2048 lds
    buffer_load_dwordx4 v5, s[12:15], s18 offen offset:3072 lds
    s_add_u32 s18, s18, s20
    v_accvgpr_write_b32 a0, 0
    v_accvgpr_write_b32 a1, 0
    v_accvgpr_write_b32 a2, 0
    v_accvgpr_write_b32 a3, 0
    v_accvgpr_write_b32 a4, 0
    v_accvgpr_write_b32 a5, 0
    v_accvgpr_write_b32 a6, 0
    v_accvgpr_write_b32 a7, 0
    v_accvgpr_write_b32 a8, 0
    v_accvgpr_write_b32 a9, 0
    v_accvgpr_write_b32 a10, 0
    v_accvgpr_write_b32 a11, 0
    v_accvgpr_write_b32 a12, 0
    v_accvgpr_write_b32 a13, 0
    v_accvgpr_write_b32 a14, 0
    v_accvgpr_write_b32 a15, 0
    v_accvgpr_write_b32 a16, 0
    v_accvgpr_write_b32 a17, 0
    v_accvgpr_write_b32 a18, 0
    v_accvgpr_write_b32 a19, 0
    v_accvgpr_write_b32 a20, 0
    v_accvgpr_write_b32 a21, 0
    v_accvgpr_write_b32 a22, 0
    v_accvgpr_write_b32 a23, 0
    v_accvgpr_write_b32 a24, 0
    v_accvgpr_write_b32 a25, 0
    v_accvgpr_write_b32 a26, 0
    v_accvgpr_write_b32 a27, 0
    v_accvgpr_write_b32 a28, 0
    v_accvgpr_write_b32 a29, 0
    v_accvgpr_write_b32 a30, 0
    v_accvgpr_write_b32 a31, 0
    v_accvgpr_write_b32 a32, 0
    v_accvgpr_write_b32 a33, 0
    v_accvgpr_write_b32 a34, 0
    v_accvgpr_write_b32 a35, 0
    v_accvgpr_write_b32 a36, 0
    v_accvgpr_write_b32 a37, 0
    v_accvgpr_write_b32 a38, 0
    v_accvgpr_write_b32 a39, 0
    v_accvgpr_write_b32 a40, 0
    v_accvgpr_write_b32 a41, 0
    v_accvgpr_write_b32 a42, 0
    v_accvgpr_write_b32 a43, 0
    v_accvgpr_write_b32 a44, 0
    v_accvgpr_write_b32 a45, 0
    v_accvgpr_write_b32 a46, 0
    v_accvgpr_write_b32 a47, 0
    v_accvgpr_write_b32 a48, 0
    v_accvgpr_write_b32 a49, 0
    v_accvgpr_write_b32 a50, 0
    v_accvgpr_write_b32 a51, 0
    v_accvgpr_write_b32 a52, 0
    v_accvgpr_write_b32 a53, 0
    v_accvgpr_write_b32 a54, 0
    v_accvgpr_write_b32 a55, 0
    v_accvgpr_write_b32 a56, 0
    v_accvgpr_write_b32 a57, 0
    v_accvgpr_write_b32 a58, 0
    v_accvgpr_write_b32 a59, 0
    v_accvgpr_write_b32 a60, 0
    v_accvgpr_write_b32 a61, 0
    v_accvgpr_write_b32 a62, 0
    v_accvgpr_write_b32 a63, 0
    s_waitcnt vmcnt(24)
    s_barrier
    ds_read_b128 v[64:67], v6 offset:0
    ds_read_b64_tr_b16 v[80:81], v48 offset:0
    ds_read_b64_tr_b16 v[82:83], v48 offset:1024
    ds_read_b64_tr_b16 v[88:89], v49 offset:0
    ds_read_b64_tr_b16 v[90:91], v49 offset:1024
    ds_read_b128 v[72:75], v6 offset:4096
    ds_read_b128 v[68:71], v6 offset:1024
    ds_read_b64_tr_b16 v[84:85], v48 offset:4096
    ds_read_b64_tr_b16 v[86:87], v48 offset:5120
    ds_read_b64_tr_b16 v[92:93], v49 offset:4096
    ds_read_b64_tr_b16 v[94:95], v49 offset:5120
    ds_read_b128 v[76:79], v6 offset:5120
    s_waitcnt lgkmcnt(0)
    s_mov_b32 s21, s48
.p2align 6
u2_loop_19:
    v_mfma_f32_32x32x16_bf16 a[0:15], v[80:83], v[64:67], a[0:15]
    ds_read_b128 v[96:99], v6 offset:2048
    ds_read_b64_tr_b16 v[112:113], v48 offset:8192
    v_mfma_f32_32x32x16_bf16 a[16:31], v[88:91], v[64:67], a[16:31]
    ds_read_b64_tr_b16 v[114:115], v48 offset:9216
    ds_read_b64_tr_b16 v[120:121], v49 offset:8192
    v_mfma_f32_32x32x16_bf16 a[32:47], v[80:83], v[72:75], a[32:47]
    ds_read_b64_tr_b16 v[122:123], v49 offset:9216
    ds_read_b128 v[104:107], v6 offset:6144
    v_mfma_f32_32x32x16_bf16 a[48:63], v[88:91], v[72:75], a[48:63]
    ds_read_b128 v[100:103], v6 offset:3072
    ds_read_b64_tr_b16 v[116:117], v48 offset:12288
    v_mfma_f32_32x32x16_bf16 a[0:15], v[84:87], v[68:71], a[0:15]
    ds_read_b64_tr_b16 v[118:119], v48 offset:13312
    ds_read_b64_tr_b16 v[124:125], v49 offset:12288
    v_mfma_f32_32x32x16_bf16 a[16:31], v[92:95], v[68:71], a[16:31]
    ds_read_b64_tr_b16 v[126:127], v49 offset:13312
    ds_read_b128 v[108:111], v6 offset:7168
    v_mfma_f32_32x32x16_bf16 a[32:47], v[84:87], v[76:79], a[32:47]
    v_mfma_f32_32x32x16_bf16 a[48:63], v[92:95], v[76:79], a[48:63]
    s_waitcnt vmcnt(16) lgkmcnt(0)
    s_barrier
    v_mfma_f32_32x32x16_bf16 a[0:15], v[112:115], v[96:99], a[0:15]
    ds_read_b128 v[64:67], v6 offset:32768
    ds_read_b64_tr_b16 v[80:81], v48 offset:32768
    s_add_u32 m0, s22, 0
    s_nop 0
    buffer_load_dwordx4 v1, s[8:11], s16 offen offset:0 sc1 lds
    v_mfma_f32_32x32x16_bf16 a[16:31], v[120:123], v[96:99], a[16:31]
    ds_read_b64_tr_b16 v[82:83], v48 offset:33792
    ds_read_b64_tr_b16 v[88:89], v49 offset:32768
    buffer_load_dwordx4 v1, s[8:11], s16 offen offset:1024 sc1 lds
    v_mfma_f32_32x32x16_bf16 a[32:47], v[112:115], v[104:107], a[32:47]
    ds_read_b64_tr_b16 v[90:91], v49 offset:33792
    ds_read_b128 v[72:75], v6 offset:36864
    buffer_load_dwordx4 v1, s[8:11], s17 offen offset:2048 sc1 lds
    v_mfma_f32_32x32x16_bf16 a[48:63], v[120:123], v[104:107], a[48:63]
    ds_read_b128 v[68:71], v6 offset:33792
    ds_read_b64_tr_b16 v[84:85], v48 offset:36864
    buffer_load_dwordx4 v1, s[8:11], s17 offen offset:3072 sc1 lds
    s_add_u32 m0, s22, 16384
    s_add_u32 s16, s16, 4096
    v_mfma_f32_32x32x16_bf16 a[0:15], v[116:119], v[100:103], a[0:15]
    ds_read_b64_tr_b16 v[86:87], v48 offset:37888
    ds_read_b64_tr_b16 v[92:93], v49 offset:36864
    buffer_load_dwordx4 v2, s[12:15], s18 offen offset:0 lds
    s_add_u32 s17, s17, 4096
    v_mfma_f32_32x32x16_bf16 a[16:31], v[124:127], v[100:103], a[16:31]
    ds_read_b64_tr_b16 v[94:95], v49 offset:37888
    ds_read_b128 v[76:79], v6 offset:37888
    buffer_load_dwordx4 v3, s[12:15], s18 offen offset:1024 lds
    v_mfma_f32_32x32x16_bf16 a[32:47], v[116:119], v[108:111], a[32:47]
    buffer_load_dwordx4 v4, s[12:15], s18 offen offset:2048 lds
    v_mfma_f32_32x32x16_bf16 a[48:63], v[124:127], v[108:111], a[48:63]
    buffer_load_dwordx4 v5, s[12:15], s18 offen offset:3072 lds
    s_add_u32 s18, s18, s20
    s_waitcnt lgkmcnt(0)
    v_mfma_f32_32x32x16_bf16 a[0:15], v[80:83], v[64:67], a[0:15]
    ds_read_b128 v[96:99], v6 offset:34816
    ds_read_b64_tr_b16 v[112:113], v48 offset:40960
    v_mfma_f32_32x32x16_bf16 a[16:31], v[88:91], v[64:67], a[16:31]
    ds_read_b64_tr_b16 v[114:115], v48 offset:41984
    ds_read_b64_tr_b16 v[120:121], v49 offset:40960
    v_mfma_f32_32x32x16_bf16 a[32:47], v[80:83], v[72:75], a[32:47]
    ds_read_b64_tr_b16 v[122:123], v49 offset:41984
    ds_read_b128 v[104:107], v6 offset:38912
    v_mfma_f32_32x32x16_bf16 a[48:63], v[88:91], v[72:75], a[48:63]
    ds_read_b128 v[100:103], v6 offset:35840
    ds_read_b64_tr_b16 v[116:117], v48 offset:45056
    v_mfma_f32_32x32x16_bf16 a[0:15], v[84:87], v[68:71], a[0:15]
    ds_read_b64_tr_b16 v[118:119], v48 offset:46080
    ds_read_b64_tr_b16 v[124:125], v49 offset:45056
    v_mfma_f32_32x32x16_bf16 a[16:31], v[92:95], v[68:71], a[16:31]
    ds_read_b64_tr_b16 v[126:127], v49 offset:46080
    ds_read_b128 v[108:111], v6 offset:39936
    v_mfma_f32_32x32x16_bf16 a[32:47], v[84:87], v[76:79], a[32:47]
    v_mfma_f32_32x32x16_bf16 a[48:63], v[92:95], v[76:79], a[48:63]
    s_waitcnt vmcnt(16) lgkmcnt(0)
    s_barrier
    v_mfma_f32_32x32x16_bf16 a[0:15], v[112:115], v[96:99], a[0:15]
    ds_read_b128 v[64:67], v7 offset:0
    ds_read_b64_tr_b16 v[80:81], v50 offset:0
    s_add_u32 m0, s22, 32768
    s_nop 0
    buffer_load_dwordx4 v1, s[8:11], s16 offen offset:0 sc1 lds
    v_mfma_f32_32x32x16_bf16 a[16:31], v[120:123], v[96:99], a[16:31]
    ds_read_b64_tr_b16 v[82:83], v50 offset:1024
    ds_read_b64_tr_b16 v[88:89], v51 offset:0
    buffer_load_dwordx4 v1, s[8:11], s16 offen offset:1024 sc1 lds
    v_mfma_f32_32x32x16_bf16 a[32:47], v[112:115], v[104:107], a[32:47]
    ds_read_b64_tr_b16 v[90:91], v51 offset:1024
    ds_read_b128 v[72:75], v7 offset:4096
    buffer_load_dwordx4 v1, s[8:11], s17 offen offset:2048 sc1 lds
    v_mfma_f32_32x32x16_bf16 a[48:63], v[120:123], v[104:107], a[48:63]
    ds_read_b128 v[68:71], v7 offset:1024
    ds_read_b64_tr_b16 v[84:85], v50 offset:4096
    buffer_load_dwordx4 v1, s[8:11], s17 offen offset:3072 sc1 lds
    s_add_u32 m0, s22, 49152
    s_add_u32 s16, s16, 4096
    v_mfma_f32_32x32x16_bf16 a[0:15], v[116:119], v[100:103], a[0:15]
    ds_read_b64_tr_b16 v[86:87], v50 offset:5120
    ds_read_b64_tr_b16 v[92:93], v51 offset:4096
    buffer_load_dwordx4 v2, s[12:15], s18 offen offset:0 lds
    s_add_u32 s17, s17, 4096
    v_mfma_f32_32x32x16_bf16 a[16:31], v[124:127], v[100:103], a[16:31]
    ds_read_b64_tr_b16 v[94:95], v51 offset:5120
    ds_read_b128 v[76:79], v7 offset:5120
    buffer_load_dwordx4 v3, s[12:15], s18 offen offset:1024 lds
    v_mfma_f32_32x32x16_bf16 a[32:47], v[116:119], v[108:111], a[32:47]
    buffer_load_dwordx4 v4, s[12:15], s18 offen offset:2048 lds
    v_mfma_f32_32x32x16_bf16 a[48:63], v[124:127], v[108:111], a[48:63]
    buffer_load_dwordx4 v5, s[12:15], s18 offen offset:3072 lds
    s_add_u32 s18, s18, s20
    s_waitcnt lgkmcnt(0)
    v_mfma_f32_32x32x16_bf16 a[0:15], v[80:83], v[64:67], a[0:15]
    ds_read_b128 v[96:99], v7 offset:2048
    ds_read_b64_tr_b16 v[112:113], v50 offset:8192
    v_mfma_f32_32x32x16_bf16 a[16:31], v[88:91], v[64:67], a[16:31]
    ds_read_b64_tr_b16 v[114:115], v50 offset:9216
    ds_read_b64_tr_b16 v[120:121], v51 offset:8192
    v_mfma_f32_32x32x16_bf16 a[32:47], v[80:83], v[72:75], a[32:47]
    ds_read_b64_tr_b16 v[122:123], v51 offset:9216
    ds_read_b128 v[104:107], v7 offset:6144
    v_mfma_f32_32x32x16_bf16 a[48:63], v[88:91], v[72:75], a[48:63]
    ds_read_b128 v[100:103], v7 offset:3072
    ds_read_b64_tr_b16 v[116:117], v50 offset:12288
    v_mfma_f32_32x32x16_bf16 a[0:15], v[84:87], v[68:71], a[0:15]
    ds_read_b64_tr_b16 v[118:119], v50 offset:13312
    ds_read_b64_tr_b16 v[124:125], v51 offset:12288
    v_mfma_f32_32x32x16_bf16 a[16:31], v[92:95], v[68:71], a[16:31]
    ds_read_b64_tr_b16 v[126:127], v51 offset:13312
    ds_read_b128 v[108:111], v7 offset:7168
    v_mfma_f32_32x32x16_bf16 a[32:47], v[84:87], v[76:79], a[32:47]
    v_mfma_f32_32x32x16_bf16 a[48:63], v[92:95], v[76:79], a[48:63]
    s_waitcnt vmcnt(16) lgkmcnt(0)
    s_barrier
    v_mfma_f32_32x32x16_bf16 a[0:15], v[112:115], v[96:99], a[0:15]
    ds_read_b128 v[64:67], v7 offset:32768
    ds_read_b64_tr_b16 v[80:81], v50 offset:32768
    s_add_u32 m0, s22, 65536
    s_nop 0
    buffer_load_dwordx4 v1, s[8:11], s16 offen offset:0 sc1 lds
    v_mfma_f32_32x32x16_bf16 a[16:31], v[120:123], v[96:99], a[16:31]
    ds_read_b64_tr_b16 v[82:83], v50 offset:33792
    ds_read_b64_tr_b16 v[88:89], v51 offset:32768
    buffer_load_dwordx4 v1, s[8:11], s16 offen offset:1024 sc1 lds
    v_mfma_f32_32x32x16_bf16 a[32:47], v[112:115], v[104:107], a[32:47]
    ds_read_b64_tr_b16 v[90:91], v51 offset:33792
    ds_read_b128 v[72:75], v7 offset:36864
    buffer_load_dwordx4 v1, s[8:11], s17 offen offset:2048 sc1 lds
    v_mfma_f32_32x32x16_bf16 a[48:63], v[120:123], v[104:107], a[48:63]
    ds_read_b128 v[68:71], v7 offset:33792
    ds_read_b64_tr_b16 v[84:85], v50 offset:36864
    buffer_load_dwordx4 v1, s[8:11], s17 offen offset:3072 sc1 lds
    s_add_u32 m0, s22, 81920
    s_add_u32 s16, s16, 4096
    v_mfma_f32_32x32x16_bf16 a[0:15], v[116:119], v[100:103], a[0:15]
    ds_read_b64_tr_b16 v[86:87], v50 offset:37888
    ds_read_b64_tr_b16 v[92:93], v51 offset:36864
    buffer_load_dwordx4 v2, s[12:15], s18 offen offset:0 lds
    s_add_u32 s17, s17, 4096
    v_mfma_f32_32x32x16_bf16 a[16:31], v[124:127], v[100:103], a[16:31]
    ds_read_b64_tr_b16 v[94:95], v51 offset:37888
    ds_read_b128 v[76:79], v7 offset:37888
    buffer_load_dwordx4 v3, s[12:15], s18 offen offset:1024 lds
    v_mfma_f32_32x32x16_bf16 a[32:47], v[116:119], v[108:111], a[32:47]
    buffer_load_dwordx4 v4, s[12:15], s18 offen offset:2048 lds
    v_mfma_f32_32x32x16_bf16 a[48:63], v[124:127], v[108:111], a[48:63]
    buffer_load_dwordx4 v5, s[12:15], s18 offen offset:3072 lds
    s_add_u32 s18, s18, s20
    s_waitcnt lgkmcnt(0)
    v_mfma_f32_32x32x16_bf16 a[0:15], v[80:83], v[64:67], a[0:15]
    ds_read_b128 v[96:99], v7 offset:34816
    ds_read_b64_tr_b16 v[112:113], v50 offset:40960
    v_mfma_f32_32x32x16_bf16 a[16:31], v[88:91], v[64:67], a[16:31]
    ds_read_b64_tr_b16 v[114:115], v50 offset:41984
    ds_read_b64_tr_b16 v[120:121], v51 offset:40960
    v_mfma_f32_32x32x16_bf16 a[32:47], v[80:83], v[72:75], a[32:47]
    ds_read_b64_tr_b16 v[122:123], v51 offset:41984
    ds_read_b128 v[104:107], v7 offset:38912
    v_mfma_f32_32x32x16_bf16 a[48:63], v[88:91], v[72:75], a[48:63]
    ds_read_b128 v[100:103], v7 offset:35840
    ds_read_b64_tr_b16 v[116:117], v50 offset:45056
    v_mfma_f32_32x32x16_bf16 a[0:15], v[84:87], v[68:71], a[0:15]
    ds_read_b64_tr_b16 v[118:119], v50 offset:46080
    ds_read_b64_tr_b16 v[124:125], v51 offset:45056
    v_mfma_f32_32x32x16_bf16 a[16:31], v[92:95], v[68:71], a[16:31]
    ds_read_b64_tr_b16 v[126:127], v51 offset:46080
    ds_read_b128 v[108:111], v7 offset:39936
    v_mfma_f32_32x32x16_bf16 a[32:47], v[84:87], v[76:79], a[32:47]
    v_mfma_f32_32x32x16_bf16 a[48:63], v[92:95], v[76:79], a[48:63]
    s_waitcnt vmcnt(16) lgkmcnt(0)
    s_barrier
    v_mfma_f32_32x32x16_bf16 a[0:15], v[112:115], v[96:99], a[0:15]
    ds_read_b128 v[64:67], v6 offset:0
    ds_read_b64_tr_b16 v[80:81], v48 offset:0
    s_add_u32 m0, s22, 98304
    s_nop 0
    buffer_load_dwordx4 v1, s[8:11], s16 offen offset:0 sc1 lds
    v_mfma_f32_32x32x16_bf16 a[16:31], v[120:123], v[96:99], a[16:31]
    ds_read_b64_tr_b16 v[82:83], v48 offset:1024
    ds_read_b64_tr_b16 v[88:89], v49 offset:0
    buffer_load_dwordx4 v1, s[8:11], s16 offen offset:1024 sc1 lds
    v_mfma_f32_32x32x16_bf16 a[32:47], v[112:115], v[104:107], a[32:47]
    ds_read_b64_tr_b16 v[90:91], v49 offset:1024
    ds_read_b128 v[72:75], v6 offset:4096
    buffer_load_dwordx4 v1, s[8:11], s17 offen offset:2048 sc1 lds
    v_mfma_f32_32x32x16_bf16 a[48:63], v[120:123], v[104:107], a[48:63]
    ds_read_b128 v[68:71], v6 offset:1024
    ds_read_b64_tr_b16 v[84:85], v48 offset:4096
    buffer_load_dwordx4 v1, s[8:11], s17 offen offset:3072 sc1 lds
    s_add_u32 m0, s22, 114688
    s_add_u32 s16, s16, 4096
    v_mfma_f32_32x32x16_bf16 a[0:15], v[116:119], v[100:103], a[0:15]
    ds_read_b64_tr_b16 v[86:87], v48 offset:5120
    ds_read_b64_tr_b16 v[92:93], v49 offset:4096
    buffer_load_dwordx4 v2, s[12:15], s18 offen offset:0 lds
    s_add_u32 s17, s17, 4096
    v_mfma_f32_32x32x16_bf16 a[16:31], v[124:127], v[100:103], a[16:31]
    ds_read_b64_tr_b16 v[94:95], v49 offset:5120
    ds_read_b128 v[76:79], v6 offset:5120
    buffer_load_dwordx4 v3, s[12:15], s18 offen offset:1024 lds
    v_mfma_f32_32x32x16_bf16 a[32:47], v[116:119], v[108:111], a[32:47]
    buffer_load_dwordx4 v4, s[12:15], s18 offen offset:2048 lds
    v_mfma_f32_32x32x16_bf16 a[48:63], v[124:127], v[108:111], a[48:63]
    buffer_load_dwordx4 v5, s[12:15], s18 offen offset:3072 lds
    s_add_u32 s18, s18, s20
    s_waitcnt lgkmcnt(0)
    s_sub_u32 s21, s21, 1
    s_cmp_lg_u32 s21, 0
    s_cbranch_scc1 u2_loop_19
    v_mfma_f32_32x32x16_bf16 a[0:15], v[80:83], v[64:67], a[0:15]
    ds_read_b128 v[96:99], v6 offset:2048
    ds_read_b64_tr_b16 v[112:113], v48 offset:8192
    v_mfma_f32_32x32x16_bf16 a[16:31], v[88:91], v[64:67], a[16:31]
    ds_read_b64_tr_b16 v[114:115], v48 offset:9216
    ds_read_b64_tr_b16 v[120:121], v49 offset:8192
    v_mfma_f32_32x32x16_bf16 a[32:47], v[80:83], v[72:75], a[32:47]
    ds_read_b64_tr_b16 v[122:123], v49 offset:9216
    ds_read_b128 v[104:107], v6 offset:6144
    v_mfma_f32_32x32x16_bf16 a[48:63], v[88:91], v[72:75], a[48:63]
    ds_read_b128 v[100:103], v6 offset:3072
    ds_read_b64_tr_b16 v[116:117], v48 offset:12288
    v_mfma_f32_32x32x16_bf16 a[0:15], v[84:87], v[68:71], a[0:15]
    ds_read_b64_tr_b16 v[118:119], v48 offset:13312
    ds_read_b64_tr_b16 v[124:125], v49 offset:12288
    v_mfma_f32_32x32x16_bf16 a[16:31], v[92:95], v[68:71], a[16:31]
    ds_read_b64_tr_b16 v[126:127], v49 offset:13312
    ds_read_b128 v[108:111], v6 offset:7168
    v_mfma_f32_32x32x16_bf16 a[32:47], v[84:87], v[76:79], a[32:47]
    v_mfma_f32_32x32x16_bf16 a[48:63], v[92:95], v[76:79], a[48:63]
    s_waitcnt vmcnt(16) lgkmcnt(0)
    s_barrier
    v_mfma_f32_32x32x16_bf16 a[0:15], v[112:115], v[96:99], a[0:15]
    ds_read_b128 v[64:67], v6 offset:32768
    ds_read_b64_tr_b16 v[80:81], v48 offset:32768
    v_mfma_f32_32x32x16_bf16 a[16:31], v[120:123], v[96:99], a[16:31]
    ds_read_b64_tr_b16 v[82:83], v48 offset:33792
    ds_read_b64_tr_b16 v[88:89], v49 offset:32768
    v_mfma_f32_32x32x16_bf16 a[32:47], v[112:115], v[104:107], a[32:47]
    ds_read_b64_tr_b16 v[90:91], v49 offset:33792
    ds_read_b128 v[72:75], v6 offset:36864
    v_mfma_f32_32x32x16_bf16 a[48:63], v[120:123], v[104:107], a[48:63]
    ds_read_b128 v[68:71], v6 offset:33792
    ds_read_b64_tr_b16 v[84:85], v48 offset:36864
    v_mfma_f32_32x32x16_bf16 a[0:15], v[116:119], v[100:103], a[0:15]
    ds_read_b64_tr_b16 v[86:87], v48 offset:37888
    ds_read_b64_tr_b16 v[92:93], v49 offset:36864
    v_mfma_f32_32x32x16_bf16 a[16:31], v[124:127], v[100:103], a[16:31]
    ds_read_b64_tr_b16 v[94:95], v49 offset:37888
    ds_read_b128 v[76:79], v6 offset:37888
    v_mfma_f32_32x32x16_bf16 a[32:47], v[116:119], v[108:111], a[32:47]
    v_mfma_f32_32x32x16_bf16 a[48:63], v[124:127], v[108:111], a[48:63]
    s_waitcnt lgkmcnt(0)
    v_mfma_f32_32x32x16_bf16 a[0:15], v[80:83], v[64:67], a[0:15]
    ds_read_b128 v[96:99], v6 offset:34816
    ds_read_b64_tr_b16 v[112:113], v48 offset:40960
    v_mfma_f32_32x32x16_bf16 a[16:31], v[88:91], v[64:67], a[16:31]
    ds_read_b64_tr_b16 v[114:115], v48 offset:41984
    ds_read_b64_tr_b16 v[120:121], v49 offset:40960
    v_mfma_f32_32x32x16_bf16 a[32:47], v[80:83], v[72:75], a[32:47]
    ds_read_b64_tr_b16 v[122:123], v49 offset:41984
    ds_read_b128 v[104:107], v6 offset:38912
    v_mfma_f32_32x32x16_bf16 a[48:63], v[88:91], v[72:75], a[48:63]
    ds_read_b128 v[100:103], v6 offset:35840
    ds_read_b64_tr_b16 v[116:117], v48 offset:45056
    v_mfma_f32_32x32x16_bf16 a[0:15], v[84:87], v[68:71], a[0:15]
    ds_read_b64_tr_b16 v[118:119], v48 offset:46080
    ds_read_b64_tr_b16 v[124:125], v49 offset:45056
    v_mfma_f32_32x32x16_bf16 a[16:31], v[92:95], v[68:71], a[16:31]
    ds_read_b64_tr_b16 v[126:127], v49 offset:46080
    ds_read_b128 v[108:111], v6 offset:39936
    v_mfma_f32_32x32x16_bf16 a[32:47], v[84:87], v[76:79], a[32:47]
    v_mfma_f32_32x32x16_bf16 a[48:63], v[92:95], v[76:79], a[48:63]
    s_waitcnt vmcnt(8) lgkmcnt(0)
    s_barrier
    v_mfma_f32_32x32x16_bf16 a[0:15], v[112:115], v[96:99], a[0:15]
    ds_read_b128 v[64:67], v7 offset:0
    ds_read_b64_tr_b16 v[80:81], v50 offset:0
    v_mfma_f32_32x32x16_bf16 a[16:31], v[120:123], v[96:99], a[16:31]
    ds_read_b64_tr_b16 v[82:83], v50 offset:1024
    ds_read_b64_tr_b16 v[88:89], v51 offset:0
    v_mfma_f32_32x32x16_bf16 a[32:47], v[112:115], v[104:107], a[32:47]
    ds_read_b64_tr_b16 v[90:91], v51 offset:1024
    ds_read_b128 v[72:75], v7 offset:4096
    v_mfma_f32_32x32x16_bf16 a[48:63], v[120:123], v[104:107], a[48:63]
    ds_read_b128 v[68:71], v7 offset:1024
    ds_read_b64_tr_b16 v[84:85], v50 offset:4096
    v_mfma_f32_32x32x16_bf16 a[0:15], v[116:119], v[100:103], a[0:15]
    ds_read_b64_tr_b16 v[86:87], v50 offset:5120
    ds_read_b64_tr_b16 v[92:93], v51 offset:4096
    v_mfma_f32_32x32x16_bf16 a[16:31], v[124:127], v[100:103], a[16:31]
    ds_read_b64_tr_b16 v[94:95], v51 offset:5120
    ds_read_b128 v[76:79], v7 offset:5120
    v_mfma_f32_32x32x16_bf16 a[32:47], v[116:119], v[108:111], a[32:47]
    v_mfma_f32_32x32x16_bf16 a[48:63], v[124:127], v[108:111], a[48:63]
    s_waitcnt lgkmcnt(0)
    v_mfma_f32_32x32x16_bf16 a[0:15], v[80:83], v[64:67], a[0:15]
    ds_read_b128 v[96:99], v7 offset:2048
    ds_read_b64_tr_b16 v[112:113], v50 offset:8192
    v_mfma_f32_32x32x16_bf16 a[16:31], v[88:91], v[64:67], a[16:31]
    ds_read_b64_tr_b16 v[114:115], v50 offset:9216
    ds_read_b64_tr_b16 v[120:121], v51 offset:8192
    v_mfma_f32_32x32x16_bf16 a[32:47], v[80:83], v[72:75], a[32:47]
    ds_read_b64_tr_b16 v[122:123], v51 offset:9216
    ds_read_b128 v[104:107], v7 offset:6144
    v_mfma_f32_32x32x16_bf16 a[48:63], v[88:91], v[72:75], a[48:63]
    ds_read_b128 v[100:103], v7 offset:3072
    ds_read_b64_tr_b16 v[116:117], v50 offset:12288
    v_mfma_f32_32x32x16_bf16 a[0:15], v[84:87], v[68:71], a[0:15]
    ds_read_b64_tr_b16 v[118:119], v50 offset:13312
    ds_read_b64_tr_b16 v[124:125], v51 offset:12288
    v_mfma_f32_32x32x16_bf16 a[16:31], v[92:95], v[68:71], a[16:31]
    ds_read_b64_tr_b16 v[126:127], v51 offset:13312
    ds_read_b128 v[108:111], v7 offset:7168
    v_mfma_f32_32x32x16_bf16 a[32:47], v[84:87], v[76:79], a[32:47]
    v_mfma_f32_32x32x16_bf16 a[48:63], v[92:95], v[76:79], a[48:63]
    s_waitcnt vmcnt(0) lgkmcnt(0)
    s_barrier
    v_mfma_f32_32x32x16_bf16 a[0:15], v[112:115], v[96:99], a[0:15]
    ds_read_b128 v[64:67], v7 offset:32768
    ds_read_b64_tr_b16 v[80:81], v50 offset:32768
    v_mfma_f32_32x32x16_bf16 a[16:31], v[120:123], v[96:99], a[16:31]
    ds_read_b64_tr_b16 v[82:83], v50 offset:33792
    ds_read_b64_tr_b16 v[88:89], v51 offset:32768
    v_mfma_f32_32x32x16_bf16 a[32:47], v[112:115], v[104:107], a[32:47]
    ds_read_b64_tr_b16 v[90:91], v51 offset:33792
    ds_read_b128 v[72:75], v7 offset:36864
    v_mfma_f32_32x32x16_bf16 a[48:63], v[120:123], v[104:107], a[48:63]
    ds_read_b128 v[68:71], v7 offset:33792
    ds_read_b64_tr_b16 v[84:85], v50 offset:36864
    v_mfma_f32_32x32x16_bf16 a[0:15], v[116:119], v[100:103], a[0:15]
    ds_read_b64_tr_b16 v[86:87], v50 offset:37888
    ds_read_b64_tr_b16 v[92:93], v51 offset:36864
    v_mfma_f32_32x32x16_bf16 a[16:31], v[124:127], v[100:103], a[16:31]
    ds_read_b64_tr_b16 v[94:95], v51 offset:37888
    ds_read_b128 v[76:79], v7 offset:37888
    v_mfma_f32_32x32x16_bf16 a[32:47], v[116:119], v[108:111], a[32:47]
    v_mfma_f32_32x32x16_bf16 a[48:63], v[124:127], v[108:111], a[48:63]
    s_waitcnt lgkmcnt(0)
    v_mfma_f32_32x32x16_bf16 a[0:15], v[80:83], v[64:67], a[0:15]
    ds_read_b128 v[96:99], v7 offset:34816
    ds_read_b64_tr_b16 v[112:113], v50 offset:40960
    v_mfma_f32_32x32x16_bf16 a[16:31], v[88:91], v[64:67], a[16:31]
    ds_read_b64_tr_b16 v[114:115], v50 offset:41984
    ds_read_b64_tr_b16 v[120:121], v51 offset:40960
    v_mfma_f32_32x32x16_bf16 a[32:47], v[80:83], v[72:75], a[32:47]
    ds_read_b64_tr_b16 v[122:123], v51 offset:41984
    ds_read_b128 v[104:107], v7 offset:38912
    v_mfma_f32_32x32x16_bf16 a[48:63], v[88:91], v[72:75], a[48:63]
    ds_read_b128 v[100:103], v7 offset:35840
    ds_read_b64_tr_b16 v[116:117], v50 offset:45056
    v_mfma_f32_32x32x16_bf16 a[0:15], v[84:87], v[68:71], a[0:15]
    ds_read_b64_tr_b16 v[118:119], v50 offset:46080
    ds_read_b64_tr_b16 v[124:125], v51 offset:45056
    v_mfma_f32_32x32x16_bf16 a[16:31], v[92:95], v[68:71], a[16:31]
    ds_read_b64_tr_b16 v[126:127], v51 offset:46080
    ds_read_b128 v[108:111], v7 offset:39936
    v_mfma_f32_32x32x16_bf16 a[32:47], v[84:87], v[76:79], a[32:47]
    v_mfma_f32_32x32x16_bf16 a[48:63], v[92:95], v[76:79], a[48:63]
    s_waitcnt vmcnt(0) lgkmcnt(0)
    s_barrier
    v_mfma_f32_32x32x16_bf16 a[0:15], v[112:115], v[96:99], a[0:15]
    v_mfma_f32_32x32x16_bf16 a[16:31], v[120:123], v[96:99], a[16:31]
    v_mfma_f32_32x32x16_bf16 a[32:47], v[112:115], v[104:107], a[32:47]
    v_mfma_f32_32x32x16_bf16 a[48:63], v[120:123], v[104:107], a[48:63]
    v_mfma_f32_32x32x16_bf16 a[0:15], v[116:119], v[100:103], a[0:15]
    v_mfma_f32_32x32x16_bf16 a[16:31], v[124:127], v[100:103], a[16:31]
    v_mfma_f32_32x32x16_bf16 a[32:47], v[116:119], v[108:111], a[32:47]
    v_mfma_f32_32x32x16_bf16 a[48:63], v[124:127], v[108:111], a[48:63]
    s_nop 15
    s_cmp_eq_u32 s50, 5
    s_cbranch_scc1 ub_kvs_epi
    s_cmp_eq_u32 s50, 3
    s_cbranch_scc0 ub_w_epi
    v_accvgpr_read_b32 v16, a0
    v_accvgpr_read_b32 v17, a1
    v_accvgpr_read_b32 v18, a2
    v_accvgpr_read_b32 v19, a3
    v_accvgpr_read_b32 v20, a4
    v_accvgpr_read_b32 v21, a5
    v_accvgpr_read_b32 v22, a6
    v_accvgpr_read_b32 v23, a7
    v_accvgpr_read_b32 v24, a8
    v_accvgpr_read_b32 v25, a9
    v_accvgpr_read_b32 v26, a10
    v_accvgpr_read_b32 v27, a11
    v_accvgpr_read_b32 v28, a12
    v_accvgpr_read_b32 v29, a13
    v_accvgpr_read_b32 v30, a14
    v_accvgpr_read_b32 v31, a15
    v_cvt_pk_bf16_f32 v32, v16, v17
    v_cvt_pk_bf16_f32 v33, v18, v19
    v_cvt_pk_bf16_f32 v34, v20, v21
    v_cvt_pk_bf16_f32 v35, v22, v23
    v_cvt_pk_bf16_f32 v36, v24, v25
    v_cvt_pk_bf16_f32 v37, v26, v27
    v_cvt_pk_bf16_f32 v38, v28, v29
    v_cvt_pk_bf16_f32 v39, v30, v31
    s_add_u32 s24, s43, 0
    s_nop 0
    v_permlane32_swap_b32 v32, v34
    v_permlane32_swap_b32 v33, v35
    v_permlane32_swap_b32 v36, v38
    v_permlane32_swap_b32 v37, v39
    buffer_store_dwordx4 v[32:35], v1, s[8:11], s24 offen offset:0 sc1
    buffer_store_dwordx4 v[36:39], v1, s[8:11], s24 offen offset:1024 sc1
    v_accvgpr_read_b32 v40, a16
    v_accvgpr_read_b32 v41, a17
    v_accvgpr_read_b32 v42, a18
    v_accvgpr_read_b32 v43, a19
    v_accvgpr_read_b32 v44, a20
    v_accvgpr_read_b32 v45, a21
    v_accvgpr_read_b32 v46, a22
    v_accvgpr_read_b32 v47, a23
    v_accvgpr_read_b32 v48, a24
    v_accvgpr_read_b32 v49, a25
    v_accvgpr_read_b32 v50, a26
    v_accvgpr_read_b32 v51, a27
    v_accvgpr_read_b32 v52, a28
    v_accvgpr_read_b32 v53, a29
    v_accvgpr_read_b32 v54, a30
    v_accvgpr_read_b32 v55, a31
    v_cvt_pk_bf16_f32 v56, v40, v41
    v_cvt_pk_bf16_f32 v57, v42, v43
    v_cvt_pk_bf16_f32 v58, v44, v45
    v_cvt_pk_bf16_f32 v59, v46, v47
    v_cvt_pk_bf16_f32 v60, v48, v49
    v_cvt_pk_bf16_f32 v61, v50, v51
    v_cvt_pk_bf16_f32 v62, v52, v53
    v_cvt_pk_bf16_f32 v63, v54, v55
    s_nop 0
    v_permlane32_swap_b32 v56, v58
    v_permlane32_swap_b32 v57, v59
    v_permlane32_swap_b32 v60, v62
    v_permlane32_swap_b32 v61, v63
    buffer_store_dwordx4 v[56:59], v1, s[8:11], s24 offen offset:2048 sc1
    buffer_store_dwordx4 v[60:63], v1, s[8:11], s24 offen offset:3072 sc1
    v_accvgpr_read_b32 v16, a32
    v_accvgpr_read_b32 v17, a33
    v_accvgpr_read_b32 v18, a34
    v_accvgpr_read_b32 v19, a35
    v_accvgpr_read_b32 v20, a36
    v_accvgpr_read_b32 v21, a37
    v_accvgpr_read_b32 v22, a38
    v_accvgpr_read_b32 v23, a39
    v_accvgpr_read_b32 v24, a40
    v_accvgpr_read_b32 v25, a41
    v_accvgpr_read_b32 v26, a42
    v_accvgpr_read_b32 v27, a43
    v_accvgpr_read_b32 v28, a44
    v_accvgpr_read_b32 v29, a45
    v_accvgpr_read_b32 v30, a46
    v_accvgpr_read_b32 v31, a47
    v_cvt_pk_bf16_f32 v32, v16, v17
    v_cvt_pk_bf16_f32 v33, v18, v19
    v_cvt_pk_bf16_f32 v34, v20, v21
    v_cvt_pk_bf16_f32 v35, v22, v23
    v_cvt_pk_bf16_f32 v36, v24, v25
    v_cvt_pk_bf16_f32 v37, v26, v27
    v_cvt_pk_bf16_f32 v38, v28, v29
    v_cvt_pk_bf16_f32 v39, v30, v31
    s_add_u32 s24, s43, 4096
    s_nop 0
    v_permlane32_swap_b32 v32, v34
    v_permlane32_swap_b32 v33, v35
    v_permlane32_swap_b32 v36, v38
    v_permlane32_swap_b32 v37, v39
    buffer_store_dwordx4 v[32:35], v1, s[8:11], s24 offen offset:0 sc1
    buffer_store_dwordx4 v[36:39], v1, s[8:11], s24 offen offset:1024 sc1
    v_accvgpr_read_b32 v40, a48
    v_accvgpr_read_b32 v41, a49
    v_accvgpr_read_b32 v42, a50
    v_accvgpr_read_b32 v43, a51
    v_accvgpr_read_b32 v44, a52
    v_accvgpr_read_b32 v45, a53
    v_accvgpr_read_b32 v46, a54
    v_accvgpr_read_b32 v47, a55
    v_accvgpr_read_b32 v48, a56
    v_accvgpr_read_b32 v49, a57
    v_accvgpr_read_b32 v50, a58
    v_accvgpr_read_b32 v51, a59
    v_accvgpr_read_b32 v52, a60
    v_accvgpr_read_b32 v53, a61
    v_accvgpr_read_b32 v54, a62
    v_accvgpr_read_b32 v55, a63
    v_cvt_pk_bf16_f32 v56, v40, v41
    v_cvt_pk_bf16_f32 v57, v42, v43
    v_cvt_pk_bf16_f32 v58, v44, v45
    v_cvt_pk_bf16_f32 v59, v46, v47
    v_cvt_pk_bf16_f32 v60, v48, v49
    v_cvt_pk_bf16_f32 v61, v50, v51
    v_cvt_pk_bf16_f32 v62, v52, v53
    v_cvt_pk_bf16_f32 v63, v54, v55
    s_nop 0
    v_permlane32_swap_b32 v56, v58
    v_permlane32_swap_b32 v57, v59
    v_permlane32_swap_b32 v60, v62
    v_permlane32_swap_b32 v61, v63
    buffer_store_dwordx4 v[56:59], v1, s[8:11], s24 offen offset:2048 sc1
    buffer_store_dwordx4 v[60:63], v1, s[8:11], s24 offen offset:3072 sc1
    s_waitcnt vmcnt(0)
    s_barrier
    s_cmp_lg_u32 s3, 0
    s_cbranch_scc1 ub_next
    v_mov_b32 v10, 1
    s_mov_b64 exec, 1
    buffer_atomic_add v10, off, s[8:11], s58
    s_mov_b64 exec, -1
    s_branch ub_next
ub_w_epi:
    s_mov_b32 s28, s56
    s_and_b32 s29, s57, 0xffff
    s_mov_b32 s30, 0x400000
    s_mov_b32 s31, 0x20000
    s_mov_b32 s32, s54
    s_and_b32 s33, s55, 0xffff
    s_mov_b32 s34, 0x400000
    s_mov_b32 s35, 0x20000
wait_20:
    buffer_load_dword v10, off, s[8:11], s58 sc1
    s_waitcnt vmcnt(0)
    v_readfirstlane_b32 s24, v10
    s_cmp_ge_u32 s24, 8
    s_cbranch_scc1 waitok_21
    s_sleep 16
    s_sub_u32 s95, s95, 1
    s_cbranch_scc0 wait_20
    s_mov_b32 s95, 0
waitok_21:
    v_and_b32 v9, 31, v0
    v_lshlrev_b32 v9, 11, v9
    v_bfe_u32 v10, v0, 5, 1
    v_lshl_add_u32 v9, v10, 4, v9
    s_add_u32 s24, s45, 0
    s_add_u32 s25, s43, 0
    buffer_load_dwordx4 v[64:67], v9, s[28:31], s24 offen offset:0
    buffer_load_dwordx4 v[96:99], v1, s[8:11], s25 offen offset:0 sc1
    buffer_load_dwordx4 v[68:71], v9, s[28:31], s24 offen offset:32
    buffer_load_dwordx4 v[100:103], v1, s[8:11], s25 offen offset:1024 sc1
    buffer_load_dwordx4 v[72:75], v9, s[28:31], s24 offen offset:64
    buffer_load_dwordx4 v[104:107], v1, s[8:11], s25 offen offset:2048 sc1
    buffer_load_dwordx4 v[76:79], v9, s[28:31], s24 offen offset:96
    buffer_load_dwordx4 v[108:111], v1, s[8:11], s25 offen offset:3072 sc1
    s_add_u32 s24, s45, 65536
    s_add_u32 s25, s43, 4096
    buffer_load_dwordx4 v[80:83], v9, s[28:31], s24 offen offset:0
    buffer_load_dwordx4 v[112:115], v1, s[8:11], s25 offen offset:0 sc1
    buffer_load_dwordx4 v[84:87], v9, s[28:31], s24 offen offset:32
    buffer_load_dwordx4 v[116:119], v1, s[8:11], s25 offen offset:1024 sc1
    buffer_load_dwordx4 v[88:91], v9, s[28:31], s24 offen offset:64
    buffer_load_dwordx4 v[120:123], v1, s[8:11], s25 offen offset:2048 sc1
    buffer_load_dwordx4 v[92:95], v9, s[28:31], s24 offen offset:96
    buffer_load_dwordx4 v[124:127], v1, s[8:11], s25 offen offset:3072 sc1
    s_add_u32 s24, s45, 0
    v_accvgpr_read_b32 v16, a0
    v_accvgpr_read_b32 v17, a1
    v_accvgpr_read_b32 v18, a2
    v_accvgpr_read_b32 v19, a3
    v_accvgpr_read_b32 v20, a4
    v_accvgpr_read_b32 v21, a5
    v_accvgpr_read_b32 v22, a6
    v_accvgpr_read_b32 v23, a7
    v_accvgpr_read_b32 v24, a8
    v_accvgpr_read_b32 v25, a9
    v_accvgpr_read_b32 v26, a10
    v_accvgpr_read_b32 v27, a11
    v_accvgpr_read_b32 v28, a12
    v_accvgpr_read_b32 v29, a13
    v_accvgpr_read_b32 v30, a14
    v_accvgpr_read_b32 v31, a15
    v_cvt_pk_bf16_f32 v32, v16, v17
    v_cvt_pk_bf16_f32 v33, v18, v19
    v_cvt_pk_bf16_f32 v34, v20, v21
    v_cvt_pk_bf16_f32 v35, v22, v23
    v_cvt_pk_bf16_f32 v36, v24, v25
    v_cvt_pk_bf16_f32 v37, v26, v27
    v_cvt_pk_bf16_f32 v38, v28, v29
    v_cvt_pk_bf16_f32 v39, v30, v31
    s_nop 0
    v_permlane32_swap_b32 v32, v34
    v_permlane32_swap_b32 v33, v35
    v_permlane32_swap_b32 v36, v38
    v_permlane32_swap_b32 v37, v39
    s_waitcnt vmcnt(12)
    v_lshlrev_b32 v10, 16, v64
    v_and_b32 v11, 0xffff0000, v64
    v_lshlrev_b32 v12, 16, v32
    v_and_b32 v13, 0xffff0000, v32
    v_add_f32 v10, v10, v12
    v_add_f32 v11, v11, v13
    v_cvt_pk_bf16_f32 v32, v10, v11
    v_lshlrev_b32 v10, 16, v96
    v_and_b32 v11, 0xffff0000, v96
    v_lshlrev_b32 v12, 16, v32
    v_and_b32 v13, 0xffff0000, v32
    v_add_f32 v10, v10, v12
    v_add_f32 v11, v11, v13
    v_cvt_pk_bf16_f32 v32, v10, v11
    v_lshlrev_b32 v10, 16, v65
    v_and_b32 v11, 0xffff0000, v65
    v_lshlrev_b32 v12, 16, v33
    v_and_b32 v13, 0xffff0000, v33
    v_add_f32 v10, v10, v12
    v_add_f32 v11, v11, v13
    v_cvt_pk_bf16_f32 v33, v10, v11
    v_lshlrev_b32 v10, 16, v97
    v_and_b32 v11, 0xffff0000, v97
    v_lshlrev_b32 v12, 16, v33
    v_and_b32 v13, 0xffff0000, v33
    v_add_f32 v10, v10, v12
    v_add_f32 v11, v11, v13
    v_cvt_pk_bf16_f32 v33, v10, v11
    v_lshlrev_b32 v10, 16, v66
    v_and_b32 v11, 0xffff0000, v66
    v_lshlrev_b32 v12, 16, v34
    v_and_b32 v13, 0xffff0000, v34
    v_add_f32 v10, v10, v12
    v_add_f32 v11, v11, v13
    v_cvt_pk_bf16_f32 v34, v10, v11
    v_lshlrev_b32 v10, 16, v98
    v_and_b32 v11, 0xffff0000, v98
    v_lshlrev_b32 v12, 16, v34
    v_and_b32 v13, 0xffff0000, v34
    v_add_f32 v10, v10, v12
    v_add_f32 v11, v11, v13
    v_cvt_pk_bf16_f32 v34, v10, v11
    v_lshlrev_b32 v10, 16, v67
    v_and_b32 v11, 0xffff0000, v67
    v_lshlrev_b32 v12, 16, v35
    v_and_b32 v13, 0xffff0000, v35
    v_add_f32 v10, v10, v12
    v_add_f32 v11, v11, v13
    v_cvt_pk_bf16_f32 v35, v10, v11
    v_lshlrev_b32 v10, 16, v99
    v_and_b32 v11, 0xffff0000, v99
    v_lshlrev_b32 v12, 16, v35
    v_and_b32 v13, 0xffff0000, v35
    v_add_f32 v10, v10, v12
    v_add_f32 v11, v11, v13
    v_cvt_pk_bf16_f32 v35, v10, v11
    buffer_store_dwordx4 v[32:35], v9, s[32:35], s24 offen offset:0
    v_lshlrev_b32 v10, 16, v68
    v_and_b32 v11, 0xffff0000, v68
    v_lshlrev_b32 v12, 16, v36
    v_and_b32 v13, 0xffff0000, v36
    v_add_f32 v10, v10, v12
    v_add_f32 v11, v11, v13
    v_cvt_pk_bf16_f32 v36, v10, v11
    v_lshlrev_b32 v10, 16, v100
    v_and_b32 v11, 0xffff0000, v100
    v_lshlrev_b32 v12, 16, v36
    v_and_b32 v13, 0xffff0000, v36
    v_add_f32 v10, v10, v12
    v_add_f32 v11, v11, v13
    v_cvt_pk_bf16_f32 v36, v10, v11
    v_lshlrev_b32 v10, 16, v69
    v_and_b32 v11, 0xffff0000, v69
    v_lshlrev_b32 v12, 16, v37
    v_and_b32 v13, 0xffff0000, v37
    v_add_f32 v10, v10, v12
    v_add_f32 v11, v11, v13
    v_cvt_pk_bf16_f32 v37, v10, v11
    v_lshlrev_b32 v10, 16, v101
    v_and_b32 v11, 0xffff0000, v101
    v_lshlrev_b32 v12, 16, v37
    v_and_b32 v13, 0xffff0000, v37
    v_add_f32 v10, v10, v12
    v_add_f32 v11, v11, v13
    v_cvt_pk_bf16_f32 v37, v10, v11
    v_lshlrev_b32 v10, 16, v70
    v_and_b32 v11, 0xffff0000, v70
    v_lshlrev_b32 v12, 16, v38
    v_and_b32 v13, 0xffff0000, v38
    v_add_f32 v10, v10, v12
    v_add_f32 v11, v11, v13
    v_cvt_pk_bf16_f32 v38, v10, v11
    v_lshlrev_b32 v10, 16, v102
    v_and_b32 v11, 0xffff0000, v102
    v_lshlrev_b32 v12, 16, v38
    v_and_b32 v13, 0xffff0000, v38
    v_add_f32 v10, v10, v12
    v_add_f32 v11, v11, v13
    v_cvt_pk_bf16_f32 v38, v10, v11
    v_lshlrev_b32 v10, 16, v71
    v_and_b32 v11, 0xffff0000, v71
    v_lshlrev_b32 v12, 16, v39
    v_and_b32 v13, 0xffff0000, v39
    v_add_f32 v10, v10, v12
    v_add_f32 v11, v11, v13
    v_cvt_pk_bf16_f32 v39, v10, v11
    v_lshlrev_b32 v10, 16, v103
    v_and_b32 v11, 0xffff0000, v103
    v_lshlrev_b32 v12, 16, v39
    v_and_b32 v13, 0xffff0000, v39
    v_add_f32 v10, v10, v12
    v_add_f32 v11, v11, v13
    v_cvt_pk_bf16_f32 v39, v10, v11
    buffer_store_dwordx4 v[36:39], v9, s[32:35], s24 offen offset:32
    v_accvgpr_read_b32 v40, a16
    v_accvgpr_read_b32 v41, a17
    v_accvgpr_read_b32 v42, a18
    v_accvgpr_read_b32 v43, a19
    v_accvgpr_read_b32 v44, a20
    v_accvgpr_read_b32 v45, a21
    v_accvgpr_read_b32 v46, a22
    v_accvgpr_read_b32 v47, a23
    v_accvgpr_read_b32 v48, a24
    v_accvgpr_read_b32 v49, a25
    v_accvgpr_read_b32 v50, a26
    v_accvgpr_read_b32 v51, a27
    v_accvgpr_read_b32 v52, a28
    v_accvgpr_read_b32 v53, a29
    v_accvgpr_read_b32 v54, a30
    v_accvgpr_read_b32 v55, a31
    v_cvt_pk_bf16_f32 v56, v40, v41
    v_cvt_pk_bf16_f32 v57, v42, v43
    v_cvt_pk_bf16_f32 v58, v44, v45
    v_cvt_pk_bf16_f32 v59, v46, v47
    v_cvt_pk_bf16_f32 v60, v48, v49
    v_cvt_pk_bf16_f32 v61, v50, v51
    v_cvt_pk_bf16_f32 v62, v52, v53
    v_cvt_pk_bf16_f32 v63, v54, v55
    s_nop 0
    v_permlane32_swap_b32 v56, v58
    v_permlane32_swap_b32 v57, v59
    v_permlane32_swap_b32 v60, v62
    v_permlane32_swap_b32 v61, v63
    s_waitcnt vmcnt(10)
    v_lshlrev_b32 v10, 16, v72
    v_and_b32 v11, 0xffff0000, v72
    v_lshlrev_b32 v12, 16, v56
    v_and_b32 v13, 0xffff0000, v56
    v_add_f32 v10, v10, v12
    v_add_f32 v11, v11, v13
    v_cvt_pk_bf16_f32 v56, v10, v11
    v_lshlrev_b32 v10, 16, v104
    v_and_b32 v11, 0xffff0000, v104
    v_lshlrev_b32 v12, 16, v56
    v_and_b32 v13, 0xffff0000, v56
    v_add_f32 v10, v10, v12
    v_add_f32 v11, v11, v13
    v_cvt_pk_bf16_f32 v56, v10, v11
    v_lshlrev_b32 v10, 16, v73
    v_and_b32 v11, 0xffff0000, v73
    v_lshlrev_b32 v12, 16, v57
    v_and_b32 v13, 0xffff0000, v57
    v_add_f32 v10, v10, v12
    v_add_f32 v11, v11, v13
    v_cvt_pk_bf16_f32 v57, v10, v11
    v_lshlrev_b32 v10, 16, v105
    v_and_b32 v11, 0xffff0000, v105
    v_lshlrev_b32 v12, 16, v57
    v_and_b32 v13, 0xffff0000, v57
    v_add_f32 v10, v10, v12
    v_add_f32 v11, v11, v13
    v_cvt_pk_bf16_f32 v57, v10, v11
    v_lshlrev_b32 v10, 16, v74
    v_and_b32 v11, 0xffff0000, v74
    v_lshlrev_b32 v12, 16, v58
    v_and_b32 v13, 0xffff0000, v58
    v_add_f32 v10, v10, v12
    v_add_f32 v11, v11, v13
    v_cvt_pk_bf16_f32 v58, v10, v11
    v_lshlrev_b32 v10, 16, v106
    v_and_b32 v11, 0xffff0000, v106
    v_lshlrev_b32 v12, 16, v58
    v_and_b32 v13, 0xffff0000, v58
    v_add_f32 v10, v10, v12
    v_add_f32 v11, v11, v13
    v_cvt_pk_bf16_f32 v58, v10, v11
    v_lshlrev_b32 v10, 16, v75
    v_and_b32 v11, 0xffff0000, v75
    v_lshlrev_b32 v12, 16, v59
    v_and_b32 v13, 0xffff0000, v59
    v_add_f32 v10, v10, v12
    v_add_f32 v11, v11, v13
    v_cvt_pk_bf16_f32 v59, v10, v11
    v_lshlrev_b32 v10, 16, v107
    v_and_b32 v11, 0xffff0000, v107
    v_lshlrev_b32 v12, 16, v59
    v_and_b32 v13, 0xffff0000, v59
    v_add_f32 v10, v10, v12
    v_add_f32 v11, v11, v13
    v_cvt_pk_bf16_f32 v59, v10, v11
    buffer_store_dwordx4 v[56:59], v9, s[32:35], s24 offen offset:64
    v_lshlrev_b32 v10, 16, v76
    v_and_b32 v11, 0xffff0000, v76
    v_lshlrev_b32 v12, 16, v60
    v_and_b32 v13, 0xffff0000, v60
    v_add_f32 v10, v10, v12
    v_add_f32 v11, v11, v13
    v_cvt_pk_bf16_f32 v60, v10, v11
    v_lshlrev_b32 v10, 16, v108
    v_and_b32 v11, 0xffff0000, v108
    v_lshlrev_b32 v12, 16, v60
    v_and_b32 v13, 0xffff0000, v60
    v_add_f32 v10, v10, v12
    v_add_f32 v11, v11, v13
    v_cvt_pk_bf16_f32 v60, v10, v11
    v_lshlrev_b32 v10, 16, v77
    v_and_b32 v11, 0xffff0000, v77
    v_lshlrev_b32 v12, 16, v61
    v_and_b32 v13, 0xffff0000, v61
    v_add_f32 v10, v10, v12
    v_add_f32 v11, v11, v13
    v_cvt_pk_bf16_f32 v61, v10, v11
    v_lshlrev_b32 v10, 16, v109
    v_and_b32 v11, 0xffff0000, v109
    v_lshlrev_b32 v12, 16, v61
    v_and_b32 v13, 0xffff0000, v61
    v_add_f32 v10, v10, v12
    v_add_f32 v11, v11, v13
    v_cvt_pk_bf16_f32 v61, v10, v11
    v_lshlrev_b32 v10, 16, v78
    v_and_b32 v11, 0xffff0000, v78
    v_lshlrev_b32 v12, 16, v62
    v_and_b32 v13, 0xffff0000, v62
    v_add_f32 v10, v10, v12
    v_add_f32 v11, v11, v13
    v_cvt_pk_bf16_f32 v62, v10, v11
    v_lshlrev_b32 v10, 16, v110
    v_and_b32 v11, 0xffff0000, v110
    v_lshlrev_b32 v12, 16, v62
    v_and_b32 v13, 0xffff0000, v62
    v_add_f32 v10, v10, v12
    v_add_f32 v11, v11, v13
    v_cvt_pk_bf16_f32 v62, v10, v11
    v_lshlrev_b32 v10, 16, v79
    v_and_b32 v11, 0xffff0000, v79
    v_lshlrev_b32 v12, 16, v63
    v_and_b32 v13, 0xffff0000, v63
    v_add_f32 v10, v10, v12
    v_add_f32 v11, v11, v13
    v_cvt_pk_bf16_f32 v63, v10, v11
    v_lshlrev_b32 v10, 16, v111
    v_and_b32 v11, 0xffff0000, v111
    v_lshlrev_b32 v12, 16, v63
    v_and_b32 v13, 0xffff0000, v63
    v_add_f32 v10, v10, v12
    v_add_f32 v11, v11, v13
    v_cvt_pk_bf16_f32 v63, v10, v11
    buffer_store_dwordx4 v[60:63], v9, s[32:35], s24 offen offset:96
    s_add_u32 s24, s45, 65536
    v_accvgpr_read_b32 v16, a32
    v_accvgpr_read_b32 v17, a33
    v_accvgpr_read_b32 v18, a34
    v_accvgpr_read_b32 v19, a35
    v_accvgpr_read_b32 v20, a36
    v_accvgpr_read_b32 v21, a37
    v_accvgpr_read_b32 v22, a38
    v_accvgpr_read_b32 v23, a39
    v_accvgpr_read_b32 v24, a40
    v_accvgpr_read_b32 v25, a41
    v_accvgpr_read_b32 v26, a42
    v_accvgpr_read_b32 v27, a43
    v_accvgpr_read_b32 v28, a44
    v_accvgpr_read_b32 v29, a45
    v_accvgpr_read_b32 v30, a46
    v_accvgpr_read_b32 v31, a47
    v_cvt_pk_bf16_f32 v32, v16, v17
    v_cvt_pk_bf16_f32 v33, v18, v19
    v_cvt_pk_bf16_f32 v34, v20, v21
    v_cvt_pk_bf16_f32 v35, v22, v23
    v_cvt_pk_bf16_f32 v36, v24, v25
    v_cvt_pk_bf16_f32 v37, v26, v27
    v_cvt_pk_bf16_f32 v38, v28, v29
    v_cvt_pk_bf16_f32 v39, v30, v31
    s_nop 0
    v_permlane32_swap_b32 v32, v34
    v_permlane32_swap_b32 v33, v35
    v_permlane32_swap_b32 v36, v38
    v_permlane32_swap_b32 v37, v39
    s_waitcnt vmcnt(8)
    v_lshlrev_b32 v10, 16, v80
    v_and_b32 v11, 0xffff0000, v80
    v_lshlrev_b32 v12, 16, v32
    v_and_b32 v13, 0xffff0000, v32
    v_add_f32 v10, v10, v12
    v_add_f32 v11, v11, v13
    v_cvt_pk_bf16_f32 v32, v10, v11
    v_lshlrev_b32 v10, 16, v112
    v_and_b32 v11, 0xffff0000, v112
    v_lshlrev_b32 v12, 16, v32
    v_and_b32 v13, 0xffff0000, v32
    v_add_f32 v10, v10, v12
    v_add_f32 v11, v11, v13
    v_cvt_pk_bf16_f32 v32, v10, v11
    v_lshlrev_b32 v10, 16, v81
    v_and_b32 v11, 0xffff0000, v81
    v_lshlrev_b32 v12, 16, v33
    v_and_b32 v13, 0xffff0000, v33
    v_add_f32 v10, v10, v12
    v_add_f32 v11, v11, v13
    v_cvt_pk_bf16_f32 v33, v10, v11
    v_lshlrev_b32 v10, 16, v113
    v_and_b32 v11, 0xffff0000, v113
    v_lshlrev_b32 v12, 16, v33
    v_and_b32 v13, 0xffff0000, v33
    v_add_f32 v10, v10, v12
    v_add_f32 v11, v11, v13
    v_cvt_pk_bf16_f32 v33, v10, v11
    v_lshlrev_b32 v10, 16, v82
    v_and_b32 v11, 0xffff0000, v82
    v_lshlrev_b32 v12, 16, v34
    v_and_b32 v13, 0xffff0000, v34
    v_add_f32 v10, v10, v12
    v_add_f32 v11, v11, v13
    v_cvt_pk_bf16_f32 v34, v10, v11
    v_lshlrev_b32 v10, 16, v114
    v_and_b32 v11, 0xffff0000, v114
    v_lshlrev_b32 v12, 16, v34
    v_and_b32 v13, 0xffff0000, v34
    v_add_f32 v10, v10, v12
    v_add_f32 v11, v11, v13
    v_cvt_pk_bf16_f32 v34, v10, v11
    v_lshlrev_b32 v10, 16, v83
    v_and_b32 v11, 0xffff0000, v83
    v_lshlrev_b32 v12, 16, v35
    v_and_b32 v13, 0xffff0000, v35
    v_add_f32 v10, v10, v12
    v_add_f32 v11, v11, v13
    v_cvt_pk_bf16_f32 v35, v10, v11
    v_lshlrev_b32 v10, 16, v115
    v_and_b32 v11, 0xffff0000, v115
    v_lshlrev_b32 v12, 16, v35
    v_and_b32 v13, 0xffff0000, v35
    v_add_f32 v10, v10, v12
    v_add_f32 v11, v11, v13
    v_cvt_pk_bf16_f32 v35, v10, v11
    buffer_store_dwordx4 v[32:35], v9, s[32:35], s24 offen offset:0
    v_lshlrev_b32 v10, 16, v84
    v_and_b32 v11, 0xffff0000, v84
    v_lshlrev_b32 v12, 16, v36
    v_and_b32 v13, 0xffff0000, v36
    v_add_f32 v10, v10, v12
    v_add_f32 v11, v11, v13
    v_cvt_pk_bf16_f32 v36, v10, v11
    v_lshlrev_b32 v10, 16, v116
    v_and_b32 v11, 0xffff0000, v116
    v_lshlrev_b32 v12, 16, v36
    v_and_b32 v13, 0xffff0000, v36
    v_add_f32 v10, v10, v12
    v_add_f32 v11, v11, v13
    v_cvt_pk_bf16_f32 v36, v10, v11
    v_lshlrev_b32 v10, 16, v85
    v_and_b32 v11, 0xffff0000, v85
    v_lshlrev_b32 v12, 16, v37
    v_and_b32 v13, 0xffff0000, v37
    v_add_f32 v10, v10, v12
    v_add_f32 v11, v11, v13
    v_cvt_pk_bf16_f32 v37, v10, v11
    v_lshlrev_b32 v10, 16, v117
    v_and_b32 v11, 0xffff0000, v117
    v_lshlrev_b32 v12, 16, v37
    v_and_b32 v13, 0xffff0000, v37
    v_add_f32 v10, v10, v12
    v_add_f32 v11, v11, v13
    v_cvt_pk_bf16_f32 v37, v10, v11
    v_lshlrev_b32 v10, 16, v86
    v_and_b32 v11, 0xffff0000, v86
    v_lshlrev_b32 v12, 16, v38
    v_and_b32 v13, 0xffff0000, v38
    v_add_f32 v10, v10, v12
    v_add_f32 v11, v11, v13
    v_cvt_pk_bf16_f32 v38, v10, v11
    v_lshlrev_b32 v10, 16, v118
    v_and_b32 v11, 0xffff0000, v118
    v_lshlrev_b32 v12, 16, v38
    v_and_b32 v13, 0xffff0000, v38
    v_add_f32 v10, v10, v12
    v_add_f32 v11, v11, v13
    v_cvt_pk_bf16_f32 v38, v10, v11
    v_lshlrev_b32 v10, 16, v87
    v_and_b32 v11, 0xffff0000, v87
    v_lshlrev_b32 v12, 16, v39
    v_and_b32 v13, 0xffff0000, v39
    v_add_f32 v10, v10, v12
    v_add_f32 v11, v11, v13
    v_cvt_pk_bf16_f32 v39, v10, v11
    v_lshlrev_b32 v10, 16, v119
    v_and_b32 v11, 0xffff0000, v119
    v_lshlrev_b32 v12, 16, v39
    v_and_b32 v13, 0xffff0000, v39
    v_add_f32 v10, v10, v12
    v_add_f32 v11, v11, v13
    v_cvt_pk_bf16_f32 v39, v10, v11
    buffer_store_dwordx4 v[36:39], v9, s[32:35], s24 offen offset:32
    v_accvgpr_read_b32 v40, a48
    v_accvgpr_read_b32 v41, a49
    v_accvgpr_read_b32 v42, a50
    v_accvgpr_read_b32 v43, a51
    v_accvgpr_read_b32 v44, a52
    v_accvgpr_read_b32 v45, a53
    v_accvgpr_read_b32 v46, a54
    v_accvgpr_read_b32 v47, a55
    v_accvgpr_read_b32 v48, a56
    v_accvgpr_read_b32 v49, a57
    v_accvgpr_read_b32 v50, a58
    v_accvgpr_read_b32 v51, a59
    v_accvgpr_read_b32 v52, a60
    v_accvgpr_read_b32 v53, a61
    v_accvgpr_read_b32 v54, a62
    v_accvgpr_read_b32 v55, a63
    v_cvt_pk_bf16_f32 v56, v40, v41
    v_cvt_pk_bf16_f32 v57, v42, v43
    v_cvt_pk_bf16_f32 v58, v44, v45
    v_cvt_pk_bf16_f32 v59, v46, v47
    v_cvt_pk_bf16_f32 v60, v48, v49
    v_cvt_pk_bf16_f32 v61, v50, v51
    v_cvt_pk_bf16_f32 v62, v52, v53
    v_cvt_pk_bf16_f32 v63, v54, v55
    s_nop 0
    v_permlane32_swap_b32 v56, v58
    v_permlane32_swap_b32 v57, v59
    v_permlane32_swap_b32 v60, v62
    v_permlane32_swap_b32 v61, v63
    s_waitcnt vmcnt(6)
    v_lshlrev_b32 v10, 16, v88
    v_and_b32 v11, 0xffff0000, v88
    v_lshlrev_b32 v12, 16, v56
    v_and_b32 v13, 0xffff0000, v56
    v_add_f32 v10, v10, v12
    v_add_f32 v11, v11, v13
    v_cvt_pk_bf16_f32 v56, v10, v11
    v_lshlrev_b32 v10, 16, v120
    v_and_b32 v11, 0xffff0000, v120
    v_lshlrev_b32 v12, 16, v56
    v_and_b32 v13, 0xffff0000, v56
    v_add_f32 v10, v10, v12
    v_add_f32 v11, v11, v13
    v_cvt_pk_bf16_f32 v56, v10, v11
    v_lshlrev_b32 v10, 16, v89
    v_and_b32 v11, 0xffff0000, v89
    v_lshlrev_b32 v12, 16, v57
    v_and_b32 v13, 0xffff0000, v57
    v_add_f32 v10, v10, v12
    v_add_f32 v11, v11, v13
    v_cvt_pk_bf16_f32 v57, v10, v11
    v_lshlrev_b32 v10, 16, v121
    v_and_b32 v11, 0xffff0000, v121
    v_lshlrev_b32 v12, 16, v57
    v_and_b32 v13, 0xffff0000, v57
    v_add_f32 v10, v10, v12
    v_add_f32 v11, v11, v13
    v_cvt_pk_bf16_f32 v57, v10, v11
    v_lshlrev_b32 v10, 16, v90
    v_and_b32 v11, 0xffff0000, v90
    v_lshlrev_b32 v12, 16, v58
    v_and_b32 v13, 0xffff0000, v58
    v_add_f32 v10, v10, v12
    v_add_f32 v11, v11, v13
    v_cvt_pk_bf16_f32 v58, v10, v11
    v_lshlrev_b32 v10, 16, v122
    v_and_b32 v11, 0xffff0000, v122
    v_lshlrev_b32 v12, 16, v58
    v_and_b32 v13, 0xffff0000, v58
    v_add_f32 v10, v10, v12
    v_add_f32 v11, v11, v13
    v_cvt_pk_bf16_f32 v58, v10, v11
    v_lshlrev_b32 v10, 16, v91
    v_and_b32 v11, 0xffff0000, v91
    v_lshlrev_b32 v12, 16, v59
    v_and_b32 v13, 0xffff0000, v59
    v_add_f32 v10, v10, v12
    v_add_f32 v11, v11, v13
    v_cvt_pk_bf16_f32 v59, v10, v11
    v_lshlrev_b32 v10, 16, v123
    v_and_b32 v11, 0xffff0000, v123
    v_lshlrev_b32 v12, 16, v59
    v_and_b32 v13, 0xffff0000, v59
    v_add_f32 v10, v10, v12
    v_add_f32 v11, v11, v13
    v_cvt_pk_bf16_f32 v59, v10, v11
    buffer_store_dwordx4 v[56:59], v9, s[32:35], s24 offen offset:64
    v_lshlrev_b32 v10, 16, v92
    v_and_b32 v11, 0xffff0000, v92
    v_lshlrev_b32 v12, 16, v60
    v_and_b32 v13, 0xffff0000, v60
    v_add_f32 v10, v10, v12
    v_add_f32 v11, v11, v13
    v_cvt_pk_bf16_f32 v60, v10, v11
    v_lshlrev_b32 v10, 16, v124
    v_and_b32 v11, 0xffff0000, v124
    v_lshlrev_b32 v12, 16, v60
    v_and_b32 v13, 0xffff0000, v60
    v_add_f32 v10, v10, v12
    v_add_f32 v11, v11, v13
    v_cvt_pk_bf16_f32 v60, v10, v11
    v_lshlrev_b32 v10, 16, v93
    v_and_b32 v11, 0xffff0000, v93
    v_lshlrev_b32 v12, 16, v61
    v_and_b32 v13, 0xffff0000, v61
    v_add_f32 v10, v10, v12
    v_add_f32 v11, v11, v13
    v_cvt_pk_bf16_f32 v61, v10, v11
    v_lshlrev_b32 v10, 16, v125
    v_and_b32 v11, 0xffff0000, v125
    v_lshlrev_b32 v12, 16, v61
    v_and_b32 v13, 0xffff0000, v61
    v_add_f32 v10, v10, v12
    v_add_f32 v11, v11, v13
    v_cvt_pk_bf16_f32 v61, v10, v11
    v_lshlrev_b32 v10, 16, v94
    v_and_b32 v11, 0xffff0000, v94
    v_lshlrev_b32 v12, 16, v62
    v_and_b32 v13, 0xffff0000, v62
    v_add_f32 v10, v10, v12
    v_add_f32 v11, v11, v13
    v_cvt_pk_bf16_f32 v62, v10, v11
    v_lshlrev_b32 v10, 16, v126
    v_and_b32 v11, 0xffff0000, v126
    v_lshlrev_b32 v12, 16, v62
    v_and_b32 v13, 0xffff0000, v62
    v_add_f32 v10, v10, v12
    v_add_f32 v11, v11, v13
    v_cvt_pk_bf16_f32 v62, v10, v11
    v_lshlrev_b32 v10, 16, v95
    v_and_b32 v11, 0xffff0000, v95
    v_lshlrev_b32 v12, 16, v63
    v_and_b32 v13, 0xffff0000, v63
    v_add_f32 v10, v10, v12
    v_add_f32 v11, v11, v13
    v_cvt_pk_bf16_f32 v63, v10, v11
    v_lshlrev_b32 v10, 16, v127
    v_and_b32 v11, 0xffff0000, v127
    v_lshlrev_b32 v12, 16, v63
    v_and_b32 v13, 0xffff0000, v63
    v_add_f32 v10, v10, v12
    v_add_f32 v11, v11, v13
    v_cvt_pk_bf16_f32 v63, v10, v11
    buffer_store_dwordx4 v[60:63], v9, s[32:35], s24 offen offset:96
    s_barrier
    s_branch ub_next
ub_kvs:
    s_lshr_b32 s46, s51, 1
    s_and_b32 s42, s51, 1
    s_cmp_eq_u32 s42, 0
    s_cselect_b32 s12, s30, s32
    s_cselect_b32 s13, s31, s33
    s_and_b32 s13, s13, 0xffff
    s_mov_b32 s14, 0x800000
    s_mov_b32 s15, 0x20000
    s_lshl_b32 s16, s46, 2
    s_add_u32 s16, s16, s3
    s_lshl_b32 s16, s16, 16
    s_add_u32 s16, s16, 0
    s_mov_b32 s17, s16
    s_lshl_b32 s18, s3, 17
    s_lshl_b32 s24, s5, 8
    s_add_u32 s18, s18, s24
    s_mov_b32 s20, 524288
    s_mov_b32 s44, 8192
    s_mov_b32 s48, 3
    v_and_b32 v9, 63, v0
    v_lshlrev_b32 v1, 4, v9
    v_lshrrev_b32 v10, 4, v9
    v_bfe_u32 v11, v9, 2, 2
    v_xor_b32 v11, v11, v10
    v_lshlrev_b32 v11, 6, v11
    v_and_b32 v12, 3, v9
    v_lshl_add_u32 v11, v12, 4, v11
    v_mul_lo_u32 v10, v10, s44
    v_add_u32 v2, v10, v11
    s_lshl_b32 s24, s44, 2
    s_sub_u32 s24, s24, 1024
    v_add_u32 v3, s24, v2
    v_add_u32 v4, s24, v3
    v_add_u32 v5, s24, v4
    s_lshr_b32 s24, s3, 1
    s_lshl_b32 s24, s24, 13
    v_add_u32 v6, s24, v1
    v_add_u32 v7, 0x10000, v6
    v_lshrrev_b32 v10, 5, v9
    v_lshlrev_b32 v10, 3, v10
    v_bfe_u32 v11, v9, 2, 2
    v_add_u32 v10, v10, v11
    v_lshlrev_b32 v10, 8, v10
    v_bfe_u32 v12, v9, 4, 1
    v_lshl_add_u32 v10, v12, 5, v10
    v_and_b32 v12, 3, v9
    v_lshl_add_u32 v10, v12, 3, v10
    v_add_u32 v10, 0x4000, v10
    s_and_b32 s24, s3, 1
    s_lshl_b32 s24, s24, 1
    v_xor_b32 v12, s24, v11
    v_lshl_add_u32 v48, v12, 6, v10
    v_add_u32 v50, 0x10000, v48
    v_xor_b32 v12, s24, v11
    v_xor_b32 v12, 1, v12
    v_lshl_add_u32 v49, v12, 6, v10
    v_add_u32 v51, 0x10000, v49
    s_lshl_b32 s22, s3, 12
    s_lshl_b32 s45, s42, 24
    s_add_u32 s45, s45, 20971520
    s_lshl_b32 s24, s46, 20
    s_add_u32 s45, s45, s24
    s_lshr_b32 s24, s3, 1
    s_lshl_b32 s24, s24, 19
    s_add_u32 s45, s45, s24
    s_lshl_b32 s24, s5, 13
    s_add_u32 s45, s45, s24
    s_and_b32 s24, s3, 1
    s_lshl_b32 s24, s24, 12
    s_add_u32 s45, s45, s24
    s_mov_b32 s58, 105907200
    s_cmp_eq_u32 s42, 0
    s_cbranch_scc1 ub_wa2
    s_add_u32 m0, s22, 0
    s_nop 0
    buffer_load_dwordx4 v1, s[8:11], s16 offen offset:0 sc1 lds
    buffer_load_dwordx4 v1, s[8:11], s16 offen offset:1024 sc1 lds
    buffer_load_dwordx4 v1, s[8:11], s17 offen offset:2048 sc1 lds
    buffer_load_dwordx4 v1, s[8:11], s17 offen offset:3072 sc1 lds
    s_add_u32 m0, s22, 16384
    s_add_u32 s16, s16, 4096
    buffer_load_dwordx4 v2, s[12:15], s18 offen offset:0 lds
    s_add_u32 s17, s17, 4096
    buffer_load_dwordx4 v3, s[12:15], s18 offen offset:1024 lds
    buffer_load_dwordx4 v4, s[12:15], s18 offen offset:2048 lds
    buffer_load_dwordx4 v5, s[12:15], s18 offen offset:3072 lds
    s_add_u32 s18, s18, s20
    s_add_u32 m0, s22, 32768
    s_nop 0
    buffer_load_dwordx4 v1, s[8:11], s16 offen offset:0 sc1 lds
    buffer_load_dwordx4 v1, s[8:11], s16 offen offset:1024 sc1 lds
    buffer_load_dwordx4 v1, s[8:11], s17 offen offset:2048 sc1 lds
    buffer_load_dwordx4 v1, s[8:11], s17 offen offset:3072 sc1 lds
    s_add_u32 m0, s22, 49152
    s_add_u32 s16, s16, 4096
    buffer_load_dwordx4 v2, s[12:15], s18 offen offset:0 lds
    s_add_u32 s17, s17, 4096
    buffer_load_dwordx4 v3, s[12:15], s18 offen offset:1024 lds
    buffer_load_dwordx4 v4, s[12:15], s18 offen offset:2048 lds
    buffer_load_dwordx4 v5, s[12:15], s18 offen offset:3072 lds
    s_add_u32 s18, s18, s20
    s_add_u32 m0, s22, 65536
    s_nop 0
    buffer_load_dwordx4 v1, s[8:11], s16 offen offset:0 sc1 lds
    buffer_load_dwordx4 v1, s[8:11], s16 offen offset:1024 sc1 lds
    buffer_load_dwordx4 v1, s[8:11], s17 offen offset:2048 sc1 lds
    buffer_load_dwordx4 v1, s[8:11], s17 offen offset:3072 sc1 lds
    s_add_u32 m0, s22, 81920
    s_add_u32 s16, s16, 4096
    buffer_load_dwordx4 v2, s[12:15], s18 offen offset:0 lds
    s_add_u32 s17, s17, 4096
    buffer_load_dwordx4 v3, s[12:15], s18 offen offset:1024 lds
    buffer_load_dwordx4 v4, s[12:15], s18 offen offset:2048 lds
    buffer_load_dwordx4 v5, s[12:15], s18 offen offset:3072 lds
    s_add_u32 s18, s18, s20
    s_add_u32 m0, s22, 98304
    s_nop 0
    buffer_load_dwordx4 v1, s[8:11], s16 offen offset:0 sc1 lds
    buffer_load_dwordx4 v1, s[8:11], s16 offen offset:1024 sc1 lds
    buffer_load_dwordx4 v1, s[8:11], s17 offen offset:2048 sc1 lds
    buffer_load_dwordx4 v1, s[8:11], s17 offen offset:3072 sc1 lds
    s_add_u32 m0, s22, 114688
    s_add_u32 s16, s16, 4096
    buffer_load_dwordx4 v2, s[12:15], s18 offen offset:0 lds
    s_add_u32 s17, s17, 4096
    buffer_load_dwordx4 v3, s[12:15], s18 offen offset:1024 lds
    buffer_load_dwordx4 v4, s[12:15], s18 offen offset:2048 lds
    buffer_load_dwordx4 v5, s[12:15], s18 offen offset:3072 lds
    s_add_u32 s18, s18, s20
    v_accvgpr_write_b32 a0, 0
    v_accvgpr_write_b32 a1, 0
    v_accvgpr_write_b32 a2, 0
    v_accvgpr_write_b32 a3, 0
    v_accvgpr_write_b32 a4, 0
    v_accvgpr_write_b32 a5, 0
    v_accvgpr_write_b32 a6, 0
    v_accvgpr_write_b32 a7, 0
    v_accvgpr_write_b32 a8, 0
    v_accvgpr_write_b32 a9, 0
    v_accvgpr_write_b32 a10, 0
    v_accvgpr_write_b32 a11, 0
    v_accvgpr_write_b32 a12, 0
    v_accvgpr_write_b32 a13, 0
    v_accvgpr_write_b32 a14, 0
    v_accvgpr_write_b32 a15, 0
    v_accvgpr_write_b32 a16, 0
    v_accvgpr_write_b32 a17, 0
    v_accvgpr_write_b32 a18, 0
    v_accvgpr_write_b32 a19, 0
    v_accvgpr_write_b32 a20, 0
    v_accvgpr_write_b32 a21, 0
    v_accvgpr_write_b32 a22, 0
    v_accvgpr_write_b32 a23, 0
    v_accvgpr_write_b32 a24, 0
    v_accvgpr_write_b32 a25, 0
    v_accvgpr_write_b32 a26, 0
    v_accvgpr_write_b32 a27, 0
    v_accvgpr_write_b32 a28, 0
    v_accvgpr_write_b32 a29, 0
    v_accvgpr_write_b32 a30, 0
    v_accvgpr_write_b32 a31, 0
    v_accvgpr_write_b32 a32, 0
    v_accvgpr_write_b32 a33, 0
    v_accvgpr_write_b32 a34, 0
    v_accvgpr_write_b32 a35, 0
    v_accvgpr_write_b32 a36, 0
    v_accvgpr_write_b32 a37, 0
    v_accvgpr_write_b32 a38, 0
    v_accvgpr_write_b32 a39, 0
    v_accvgpr_write_b32 a40, 0
    v_accvgpr_write_b32 a41, 0
    v_accvgpr_write_b32 a42, 0
    v_accvgpr_write_b32 a43, 0
    v_accvgpr_write_b32 a44, 0
    v_accvgpr_write_b32 a45, 0
    v_accvgpr_write_b32 a46, 0
    v_accvgpr_write_b32 a47, 0
    v_accvgpr_write_b32 a48, 0
    v_accvgpr_write_b32 a49, 0
    v_accvgpr_write_b32 a50, 0
    v_accvgpr_write_b32 a51, 0
    v_accvgpr_write_b32 a52, 0
    v_accvgpr_write_b32 a53, 0
    v_accvgpr_write_b32 a54, 0
    v_accvgpr_write_b32 a55, 0
    v_accvgpr_write_b32 a56, 0
    v_accvgpr_write_b32 a57, 0
    v_accvgpr_write_b32 a58, 0
    v_accvgpr_write_b32 a59, 0
    v_accvgpr_write_b32 a60, 0
    v_accvgpr_write_b32 a61, 0
    v_accvgpr_write_b32 a62, 0
    v_accvgpr_write_b32 a63, 0
    s_waitcnt vmcnt(24)
    s_barrier
    ds_read_b128 v[64:67], v6 offset:0
    ds_read_b64_tr_b16 v[80:81], v48 offset:0
    ds_read_b64_tr_b16 v[82:83], v48 offset:1024
    ds_read_b64_tr_b16 v[88:89], v49 offset:0
    ds_read_b64_tr_b16 v[90:91], v49 offset:1024
    ds_read_b128 v[72:75], v6 offset:4096
    ds_read_b128 v[68:71], v6 offset:1024
    ds_read_b64_tr_b16 v[84:85], v48 offset:4096
    ds_read_b64_tr_b16 v[86:87], v48 offset:5120
    ds_read_b64_tr_b16 v[92:93], v49 offset:4096
    ds_read_b64_tr_b16 v[94:95], v49 offset:5120
    ds_read_b128 v[76:79], v6 offset:5120
    s_waitcnt lgkmcnt(0)
    s_mov_b32 s21, s48
.p2align 6
u2v_loop_22:
    v_mfma_f32_32x32x16_bf16 a[0:15], v[64:67], v[80:83], a[0:15]
    ds_read_b128 v[96:99], v6 offset:2048
    ds_read_b64_tr_b16 v[112:113], v48 offset:8192
    v_mfma_f32_32x32x16_bf16 a[16:31], v[64:67], v[88:91], a[16:31]
    ds_read_b64_tr_b16 v[114:115], v48 offset:9216
    ds_read_b64_tr_b16 v[120:121], v49 offset:8192
    v_mfma_f32_32x32x16_bf16 a[32:47], v[72:75], v[80:83], a[32:47]
    ds_read_b64_tr_b16 v[122:123], v49 offset:9216
    ds_read_b128 v[104:107], v6 offset:6144
    v_mfma_f32_32x32x16_bf16 a[48:63], v[72:75], v[88:91], a[48:63]
    ds_read_b128 v[100:103], v6 offset:3072
    ds_read_b64_tr_b16 v[116:117], v48 offset:12288
    v_mfma_f32_32x32x16_bf16 a[0:15], v[68:71], v[84:87], a[0:15]
    ds_read_b64_tr_b16 v[118:119], v48 offset:13312
    ds_read_b64_tr_b16 v[124:125], v49 offset:12288
    v_mfma_f32_32x32x16_bf16 a[16:31], v[68:71], v[92:95], a[16:31]
    ds_read_b64_tr_b16 v[126:127], v49 offset:13312
    ds_read_b128 v[108:111], v6 offset:7168
    v_mfma_f32_32x32x16_bf16 a[32:47], v[76:79], v[84:87], a[32:47]
    v_mfma_f32_32x32x16_bf16 a[48:63], v[76:79], v[92:95], a[48:63]
    s_waitcnt vmcnt(16) lgkmcnt(0)
    s_barrier
    v_mfma_f32_32x32x16_bf16 a[0:15], v[96:99], v[112:115], a[0:15]
    ds_read_b128 v[64:67], v6 offset:32768
    ds_read_b64_tr_b16 v[80:81], v48 offset:32768
    s_add_u32 m0, s22, 0
    s_nop 0
    buffer_load_dwordx4 v1, s[8:11], s16 offen offset:0 sc1 lds
    v_mfma_f32_32x32x16_bf16 a[16:31], v[96:99], v[120:123], a[16:31]
    ds_read_b64_tr_b16 v[82:83], v48 offset:33792
    ds_read_b64_tr_b16 v[88:89], v49 offset:32768
    buffer_load_dwordx4 v1, s[8:11], s16 offen offset:1024 sc1 lds
    v_mfma_f32_32x32x16_bf16 a[32:47], v[104:107], v[112:115], a[32:47]
    ds_read_b64_tr_b16 v[90:91], v49 offset:33792
    ds_read_b128 v[72:75], v6 offset:36864
    buffer_load_dwordx4 v1, s[8:11], s17 offen offset:2048 sc1 lds
    v_mfma_f32_32x32x16_bf16 a[48:63], v[104:107], v[120:123], a[48:63]
    ds_read_b128 v[68:71], v6 offset:33792
    ds_read_b64_tr_b16 v[84:85], v48 offset:36864
    buffer_load_dwordx4 v1, s[8:11], s17 offen offset:3072 sc1 lds
    s_add_u32 m0, s22, 16384
    s_add_u32 s16, s16, 4096
    v_mfma_f32_32x32x16_bf16 a[0:15], v[100:103], v[116:119], a[0:15]
    ds_read_b64_tr_b16 v[86:87], v48 offset:37888
    ds_read_b64_tr_b16 v[92:93], v49 offset:36864
    buffer_load_dwordx4 v2, s[12:15], s18 offen offset:0 lds
    s_add_u32 s17, s17, 4096
    v_mfma_f32_32x32x16_bf16 a[16:31], v[100:103], v[124:127], a[16:31]
    ds_read_b64_tr_b16 v[94:95], v49 offset:37888
    ds_read_b128 v[76:79], v6 offset:37888
    buffer_load_dwordx4 v3, s[12:15], s18 offen offset:1024 lds
    v_mfma_f32_32x32x16_bf16 a[32:47], v[108:111], v[116:119], a[32:47]
    buffer_load_dwordx4 v4, s[12:15], s18 offen offset:2048 lds
    v_mfma_f32_32x32x16_bf16 a[48:63], v[108:111], v[124:127], a[48:63]
    buffer_load_dwordx4 v5, s[12:15], s18 offen offset:3072 lds
    s_add_u32 s18, s18, s20
    s_waitcnt lgkmcnt(0)
    v_mfma_f32_32x32x16_bf16 a[0:15], v[64:67], v[80:83], a[0:15]
    ds_read_b128 v[96:99], v6 offset:34816
    ds_read_b64_tr_b16 v[112:113], v48 offset:40960
    v_mfma_f32_32x32x16_bf16 a[16:31], v[64:67], v[88:91], a[16:31]
    ds_read_b64_tr_b16 v[114:115], v48 offset:41984
    ds_read_b64_tr_b16 v[120:121], v49 offset:40960
    v_mfma_f32_32x32x16_bf16 a[32:47], v[72:75], v[80:83], a[32:47]
    ds_read_b64_tr_b16 v[122:123], v49 offset:41984
    ds_read_b128 v[104:107], v6 offset:38912
    v_mfma_f32_32x32x16_bf16 a[48:63], v[72:75], v[88:91], a[48:63]
    ds_read_b128 v[100:103], v6 offset:35840
    ds_read_b64_tr_b16 v[116:117], v48 offset:45056
    v_mfma_f32_32x32x16_bf16 a[0:15], v[68:71], v[84:87], a[0:15]
    ds_read_b64_tr_b16 v[118:119], v48 offset:46080
    ds_read_b64_tr_b16 v[124:125], v49 offset:45056
    v_mfma_f32_32x32x16_bf16 a[16:31], v[68:71], v[92:95], a[16:31]
    ds_read_b64_tr_b16 v[126:127], v49 offset:46080
    ds_read_b128 v[108:111], v6 offset:39936
    v_mfma_f32_32x32x16_bf16 a[32:47], v[76:79], v[84:87], a[32:47]
    v_mfma_f32_32x32x16_bf16 a[48:63], v[76:79], v[92:95], a[48:63]
    s_waitcnt vmcnt(16) lgkmcnt(0)
    s_barrier
    v_mfma_f32_32x32x16_bf16 a[0:15], v[96:99], v[112:115], a[0:15]
    ds_read_b128 v[64:67], v7 offset:0
    ds_read_b64_tr_b16 v[80:81], v50 offset:0
    s_add_u32 m0, s22, 32768
    s_nop 0
    buffer_load_dwordx4 v1, s[8:11], s16 offen offset:0 sc1 lds
    v_mfma_f32_32x32x16_bf16 a[16:31], v[96:99], v[120:123], a[16:31]
    ds_read_b64_tr_b16 v[82:83], v50 offset:1024
    ds_read_b64_tr_b16 v[88:89], v51 offset:0
    buffer_load_dwordx4 v1, s[8:11], s16 offen offset:1024 sc1 lds
    v_mfma_f32_32x32x16_bf16 a[32:47], v[104:107], v[112:115], a[32:47]
    ds_read_b64_tr_b16 v[90:91], v51 offset:1024
    ds_read_b128 v[72:75], v7 offset:4096
    buffer_load_dwordx4 v1, s[8:11], s17 offen offset:2048 sc1 lds
    v_mfma_f32_32x32x16_bf16 a[48:63], v[104:107], v[120:123], a[48:63]
    ds_read_b128 v[68:71], v7 offset:1024
    ds_read_b64_tr_b16 v[84:85], v50 offset:4096
    buffer_load_dwordx4 v1, s[8:11], s17 offen offset:3072 sc1 lds
    s_add_u32 m0, s22, 49152
    s_add_u32 s16, s16, 4096
    v_mfma_f32_32x32x16_bf16 a[0:15], v[100:103], v[116:119], a[0:15]
    ds_read_b64_tr_b16 v[86:87], v50 offset:5120
    ds_read_b64_tr_b16 v[92:93], v51 offset:4096
    buffer_load_dwordx4 v2, s[12:15], s18 offen offset:0 lds
    s_add_u32 s17, s17, 4096
    v_mfma_f32_32x32x16_bf16 a[16:31], v[100:103], v[124:127], a[16:31]
    ds_read_b64_tr_b16 v[94:95], v51 offset:5120
    ds_read_b128 v[76:79], v7 offset:5120
    buffer_load_dwordx4 v3, s[12:15], s18 offen offset:1024 lds
    v_mfma_f32_32x32x16_bf16 a[32:47], v[108:111], v[116:119], a[32:47]
    buffer_load_dwordx4 v4, s[12:15], s18 offen offset:2048 lds
    v_mfma_f32_32x32x16_bf16 a[48:63], v[108:111], v[124:127], a[48:63]
    buffer_load_dwordx4 v5, s[12:15], s18 offen offset:3072 lds
    s_add_u32 s18, s18, s20
    s_waitcnt lgkmcnt(0)
    v_mfma_f32_32x32x16_bf16 a[0:15], v[64:67], v[80:83], a[0:15]
    ds_read_b128 v[96:99], v7 offset:2048
    ds_read_b64_tr_b16 v[112:113], v50 offset:8192
    v_mfma_f32_32x32x16_bf16 a[16:31], v[64:67], v[88:91], a[16:31]
    ds_read_b64_tr_b16 v[114:115], v50 offset:9216
    ds_read_b64_tr_b16 v[120:121], v51 offset:8192
    v_mfma_f32_32x32x16_bf16 a[32:47], v[72:75], v[80:83], a[32:47]
    ds_read_b64_tr_b16 v[122:123], v51 offset:9216
    ds_read_b128 v[104:107], v7 offset:6144
    v_mfma_f32_32x32x16_bf16 a[48:63], v[72:75], v[88:91], a[48:63]
    ds_read_b128 v[100:103], v7 offset:3072
    ds_read_b64_tr_b16 v[116:117], v50 offset:12288
    v_mfma_f32_32x32x16_bf16 a[0:15], v[68:71], v[84:87], a[0:15]
    ds_read_b64_tr_b16 v[118:119], v50 offset:13312
    ds_read_b64_tr_b16 v[124:125], v51 offset:12288
    v_mfma_f32_32x32x16_bf16 a[16:31], v[68:71], v[92:95], a[16:31]
    ds_read_b64_tr_b16 v[126:127], v51 offset:13312
    ds_read_b128 v[108:111], v7 offset:7168
    v_mfma_f32_32x32x16_bf16 a[32:47], v[76:79], v[84:87], a[32:47]
    v_mfma_f32_32x32x16_bf16 a[48:63], v[76:79], v[92:95], a[48:63]
    s_waitcnt vmcnt(16) lgkmcnt(0)
    s_barrier
    v_mfma_f32_32x32x16_bf16 a[0:15], v[96:99], v[112:115], a[0:15]
    ds_read_b128 v[64:67], v7 offset:32768
    ds_read_b64_tr_b16 v[80:81], v50 offset:32768
    s_add_u32 m0, s22, 65536
    s_nop 0
    buffer_load_dwordx4 v1, s[8:11], s16 offen offset:0 sc1 lds
    v_mfma_f32_32x32x16_bf16 a[16:31], v[96:99], v[120:123], a[16:31]
    ds_read_b64_tr_b16 v[82:83], v50 offset:33792
    ds_read_b64_tr_b16 v[88:89], v51 offset:32768
    buffer_load_dwordx4 v1, s[8:11], s16 offen offset:1024 sc1 lds
    v_mfma_f32_32x32x16_bf16 a[32:47], v[104:107], v[112:115], a[32:47]
    ds_read_b64_tr_b16 v[90:91], v51 offset:33792
    ds_read_b128 v[72:75], v7 offset:36864
    buffer_load_dwordx4 v1, s[8:11], s17 offen offset:2048 sc1 lds
    v_mfma_f32_32x32x16_bf16 a[48:63], v[104:107], v[120:123], a[48:63]
    ds_read_b128 v[68:71], v7 offset:33792
    ds_read_b64_tr_b16 v[84:85], v50 offset:36864
    buffer_load_dwordx4 v1, s[8:11], s17 offen offset:3072 sc1 lds
    s_add_u32 m0, s22, 81920
    s_add_u32 s16, s16, 4096
    v_mfma_f32_32x32x16_bf16 a[0:15], v[100:103], v[116:119], a[0:15]
    ds_read_b64_tr_b16 v[86:87], v50 offset:37888
    ds_read_b64_tr_b16 v[92:93], v51 offset:36864
    buffer_load_dwordx4 v2, s[12:15], s18 offen offset:0 lds
    s_add_u32 s17, s17, 4096
    v_mfma_f32_32x32x16_bf16 a[16:31], v[100:103], v[124:127], a[16:31]
    ds_read_b64_tr_b16 v[94:95], v51 offset:37888
    ds_read_b128 v[76:79], v7 offset:37888
    buffer_load_dwordx4 v3, s[12:15], s18 offen offset:1024 lds
    v_mfma_f32_32x32x16_bf16 a[32:47], v[108:111], v[116:119], a[32:47]
    buffer_load_dwordx4 v4, s[12:15], s18 offen offset:2048 lds
    v_mfma_f32_32x32x16_bf16 a[48:63], v[108:111], v[124:127], a[48:63]
    buffer_load_dwordx4 v5, s[12:15], s18 offen offset:3072 lds
    s_add_u32 s18, s18, s20
    s_waitcnt lgkmcnt(0)
    v_mfma_f32_32x32x16_bf16 a[0:15], v[64:67], v[80:83], a[0:15]
    ds_read_b128 v[96:99], v7 offset:34816
    ds_read_b64_tr_b16 v[112:113], v50 offset:40960
    v_mfma_f32_32x32x16_bf16 a[16:31], v[64:67], v[88:91], a[16:31]
    ds_read_b64_tr_b16 v[114:115], v50 offset:41984
    ds_read_b64_tr_b16 v[120:121], v51 offset:40960
    v_mfma_f32_32x32x16_bf16 a[32:47], v[72:75], v[80:83], a[32:47]
    ds_read_b64_tr_b16 v[122:123], v51 offset:41984
    ds_read_b128 v[104:107], v7 offset:38912
    v_mfma_f32_32x32x16_bf16 a[48:63], v[72:75], v[88:91], a[48:63]
    ds_read_b128 v[100:103], v7 offset:35840
    ds_read_b64_tr_b16 v[116:117], v50 offset:45056
    v_mfma_f32_32x32x16_bf16 a[0:15], v[68:71], v[84:87], a[0:15]
    ds_read_b64_tr_b16 v[118:119], v50 offset:46080
    ds_read_b64_tr_b16 v[124:125], v51 offset:45056
    v_mfma_f32_32x32x16_bf16 a[16:31], v[68:71], v[92:95], a[16:31]
    ds_read_b64_tr_b16 v[126:127], v51 offset:46080
    ds_read_b128 v[108:111], v7 offset:39936
    v_mfma_f32_32x32x16_bf16 a[32:47], v[76:79], v[84:87], a[32:47]
    v_mfma_f32_32x32x16_bf16 a[48:63], v[76:79], v[92:95], a[48:63]
    s_waitcnt vmcnt(16) lgkmcnt(0)
    s_barrier
    v_mfma_f32_32x32x16_bf16 a[0:15], v[96:99], v[112:115], a[0:15]
    ds_read_b128 v[64:67], v6 offset:0
    ds_read_b64_tr_b16 v[80:81], v48 offset:0
    s_add_u32 m0, s22, 98304
    s_nop 0
    buffer_load_dwordx4 v1, s[8:11], s16 offen offset:0 sc1 lds
    v_mfma_f32_32x32x16_bf16 a[16:31], v[96:99], v[120:123], a[16:31]
    ds_read_b64_tr_b16 v[82:83], v48 offset:1024
    ds_read_b64_tr_b16 v[88:89], v49 offset:0
    buffer_load_dwordx4 v1, s[8:11], s16 offen offset:1024 sc1 lds
    v_mfma_f32_32x32x16_bf16 a[32:47], v[104:107], v[112:115], a[32:47]
    ds_read_b64_tr_b16 v[90:91], v49 offset:1024
    ds_read_b128 v[72:75], v6 offset:4096
    buffer_load_dwordx4 v1, s[8:11], s17 offen offset:2048 sc1 lds
    v_mfma_f32_32x32x16_bf16 a[48:63], v[104:107], v[120:123], a[48:63]
    ds_read_b128 v[68:71], v6 offset:1024
    ds_read_b64_tr_b16 v[84:85], v48 offset:4096
    buffer_load_dwordx4 v1, s[8:11], s17 offen offset:3072 sc1 lds
    s_add_u32 m0, s22, 114688
    s_add_u32 s16, s16, 4096
    v_mfma_f32_32x32x16_bf16 a[0:15], v[100:103], v[116:119], a[0:15]
    ds_read_b64_tr_b16 v[86:87], v48 offset:5120
    ds_read_b64_tr_b16 v[92:93], v49 offset:4096
    buffer_load_dwordx4 v2, s[12:15], s18 offen offset:0 lds
    s_add_u32 s17, s17, 4096
    v_mfma_f32_32x32x16_bf16 a[16:31], v[100:103], v[124:127], a[16:31]
    ds_read_b64_tr_b16 v[94:95], v49 offset:5120
    ds_read_b128 v[76:79], v6 offset:5120
    buffer_load_dwordx4 v3, s[12:15], s18 offen offset:1024 lds
    v_mfma_f32_32x32x16_bf16 a[32:47], v[108:111], v[116:119], a[32:47]
    buffer_load_dwordx4 v4, s[12:15], s18 offen offset:2048 lds
    v_mfma_f32_32x32x16_bf16 a[48:63], v[108:111], v[124:127], a[48:63]
    buffer_load_dwordx4 v5, s[12:15], s18 offen offset:3072 lds
    s_add_u32 s18, s18, s20
    s_waitcnt lgkmcnt(0)
    s_sub_u32 s21, s21, 1
    s_cmp_lg_u32 s21, 0
    s_cbranch_scc1 u2v_loop_22
    v_mfma_f32_32x32x16_bf16 a[0:15], v[64:67], v[80:83], a[0:15]
    ds_read_b128 v[96:99], v6 offset:2048
    ds_read_b64_tr_b16 v[112:113], v48 offset:8192
    v_mfma_f32_32x32x16_bf16 a[16:31], v[64:67], v[88:91], a[16:31]
    ds_read_b64_tr_b16 v[114:115], v48 offset:9216
    ds_read_b64_tr_b16 v[120:121], v49 offset:8192
    v_mfma_f32_32x32x16_bf16 a[32:47], v[72:75], v[80:83], a[32:47]
    ds_read_b64_tr_b16 v[122:123], v49 offset:9216
    ds_read_b128 v[104:107], v6 offset:6144
    v_mfma_f32_32x32x16_bf16 a[48:63], v[72:75], v[88:91], a[48:63]
    ds_read_b128 v[100:103], v6 offset:3072
    ds_read_b64_tr_b16 v[116:117], v48 offset:12288
    v_mfma_f32_32x32x16_bf16 a[0:15], v[68:71], v[84:87], a[0:15]
    ds_read_b64_tr_b16 v[118:119], v48 offset:13312
    ds_read_b64_tr_b16 v[124:125], v49 offset:12288
    v_mfma_f32_32x32x16_bf16 a[16:31], v[68:71], v[92:95], a[16:31]
    ds_read_b64_tr_b16 v[126:127], v49 offset:13312
    ds_read_b128 v[108:111], v6 offset:7168
    v_mfma_f32_32x32x16_bf16 a[32:47], v[76:79], v[84:87], a[32:47]
    v_mfma_f32_32x32x16_bf16 a[48:63], v[76:79], v[92:95], a[48:63]
    s_waitcnt vmcnt(16) lgkmcnt(0)
    s_barrier
    v_mfma_f32_32x32x16_bf16 a[0:15], v[96:99], v[112:115], a[0:15]
    ds_read_b128 v[64:67], v6 offset:32768
    ds_read_b64_tr_b16 v[80:81], v48 offset:32768
    v_mfma_f32_32x32x16_bf16 a[16:31], v[96:99], v[120:123], a[16:31]
    ds_read_b64_tr_b16 v[82:83], v48 offset:33792
    ds_read_b64_tr_b16 v[88:89], v49 offset:32768
    v_mfma_f32_32x32x16_bf16 a[32:47], v[104:107], v[112:115], a[32:47]
    ds_read_b64_tr_b16 v[90:91], v49 offset:33792
    ds_read_b128 v[72:75], v6 offset:36864
    v_mfma_f32_32x32x16_bf16 a[48:63], v[104:107], v[120:123], a[48:63]
    ds_read_b128 v[68:71], v6 offset:33792
    ds_read_b64_tr_b16 v[84:85], v48 offset:36864
    v_mfma_f32_32x32x16_bf16 a[0:15], v[100:103], v[116:119], a[0:15]
    ds_read_b64_tr_b16 v[86:87], v48 offset:37888
    ds_read_b64_tr_b16 v[92:93], v49 offset:36864
    v_mfma_f32_32x32x16_bf16 a[16:31], v[100:103], v[124:127], a[16:31]
    ds_read_b64_tr_b16 v[94:95], v49 offset:37888
    ds_read_b128 v[76:79], v6 offset:37888
    v_mfma_f32_32x32x16_bf16 a[32:47], v[108:111], v[116:119], a[32:47]
    v_mfma_f32_32x32x16_bf16 a[48:63], v[108:111], v[124:127], a[48:63]
    s_waitcnt lgkmcnt(0)
    v_mfma_f32_32x32x16_bf16 a[0:15], v[64:67], v[80:83], a[0:15]
    ds_read_b128 v[96:99], v6 offset:34816
    ds_read_b64_tr_b16 v[112:113], v48 offset:40960
    v_mfma_f32_32x32x16_bf16 a[16:31], v[64:67], v[88:91], a[16:31]
    ds_read_b64_tr_b16 v[114:115], v48 offset:41984
    ds_read_b64_tr_b16 v[120:121], v49 offset:40960
    v_mfma_f32_32x32x16_bf16 a[32:47], v[72:75], v[80:83], a[32:47]
    ds_read_b64_tr_b16 v[122:123], v49 offset:41984
    ds_read_b128 v[104:107], v6 offset:38912
    v_mfma_f32_32x32x16_bf16 a[48:63], v[72:75], v[88:91], a[48:63]
    ds_read_b128 v[100:103], v6 offset:35840
    ds_read_b64_tr_b16 v[116:117], v48 offset:45056
    v_mfma_f32_32x32x16_bf16 a[0:15], v[68:71], v[84:87], a[0:15]
    ds_read_b64_tr_b16 v[118:119], v48 offset:46080
    ds_read_b64_tr_b16 v[124:125], v49 offset:45056
    v_mfma_f32_32x32x16_bf16 a[16:31], v[68:71], v[92:95], a[16:31]
    ds_read_b64_tr_b16 v[126:127], v49 offset:46080
    ds_read_b128 v[108:111], v6 offset:39936
    v_mfma_f32_32x32x16_bf16 a[32:47], v[76:79], v[84:87], a[32:47]
    v_mfma_f32_32x32x16_bf16 a[48:63], v[76:79], v[92:95], a[48:63]
    s_waitcnt vmcnt(8) lgkmcnt(0)
    s_barrier
    v_mfma_f32_32x32x16_bf16 a[0:15], v[96:99], v[112:115], a[0:15]
    ds_read_b128 v[64:67], v7 offset:0
    ds_read_b64_tr_b16 v[80:81], v50 offset:0
    v_mfma_f32_32x32x16_bf16 a[16:31], v[96:99], v[120:123], a[16:31]
    ds_read_b64_tr_b16 v[82:83], v50 offset:1024
    ds_read_b64_tr_b16 v[88:89], v51 offset:0
    v_mfma_f32_32x32x16_bf16 a[32:47], v[104:107], v[112:115], a[32:47]
    ds_read_b64_tr_b16 v[90:91], v51 offset:1024
    ds_read_b128 v[72:75], v7 offset:4096
    v_mfma_f32_32x32x16_bf16 a[48:63], v[104:107], v[120:123], a[48:63]
    ds_read_b128 v[68:71], v7 offset:1024
    ds_read_b64_tr_b16 v[84:85], v50 offset:4096
    v_mfma_f32_32x32x16_bf16 a[0:15], v[100:103], v[116:119], a[0:15]
    ds_read_b64_tr_b16 v[86:87], v50 offset:5120
    ds_read_b64_tr_b16 v[92:93], v51 offset:4096
    v_mfma_f32_32x32x16_bf16 a[16:31], v[100:103], v[124:127], a[16:31]
    ds_read_b64_tr_b16 v[94:95], v51 offset:5120
    ds_read_b128 v[76:79], v7 offset:5120
    v_mfma_f32_32x32x16_bf16 a[32:47], v[108:111], v[116:119], a[32:47]
    v_mfma_f32_32x32x16_bf16 a[48:63], v[108:111], v[124:127], a[48:63]
    s_waitcnt lgkmcnt(0)
    v_mfma_f32_32x32x16_bf16 a[0:15], v[64:67], v[80:83], a[0:15]
    ds_read_b128 v[96:99], v7 offset:2048
    ds_read_b64_tr_b16 v[112:113], v50 offset:8192
    v_mfma_f32_32x32x16_bf16 a[16:31], v[64:67], v[88:91], a[16:31]
    ds_read_b64_tr_b16 v[114:115], v50 offset:9216
    ds_read_b64_tr_b16 v[120:121], v51 offset:8192
    v_mfma_f32_32x32x16_bf16 a[32:47], v[72:75], v[80:83], a[32:47]
    ds_read_b64_tr_b16 v[122:123], v51 offset:9216
    ds_read_b128 v[104:107], v7 offset:6144
    v_mfma_f32_32x32x16_bf16 a[48:63], v[72:75], v[88:91], a[48:63]
    ds_read_b128 v[100:103], v7 offset:3072
    ds_read_b64_tr_b16 v[116:117], v50 offset:12288
    v_mfma_f32_32x32x16_bf16 a[0:15], v[68:71], v[84:87], a[0:15]
    ds_read_b64_tr_b16 v[118:119], v50 offset:13312
    ds_read_b64_tr_b16 v[124:125], v51 offset:12288
    v_mfma_f32_32x32x16_bf16 a[16:31], v[68:71], v[92:95], a[16:31]
    ds_read_b64_tr_b16 v[126:127], v51 offset:13312
    ds_read_b128 v[108:111], v7 offset:7168
    v_mfma_f32_32x32x16_bf16 a[32:47], v[76:79], v[84:87], a[32:47]
    v_mfma_f32_32x32x16_bf16 a[48:63], v[76:79], v[92:95], a[48:63]
    s_waitcnt vmcnt(0) lgkmcnt(0)
    s_barrier
    v_mfma_f32_32x32x16_bf16 a[0:15], v[96:99], v[112:115], a[0:15]
    ds_read_b128 v[64:67], v7 offset:32768
    ds_read_b64_tr_b16 v[80:81], v50 offset:32768
    v_mfma_f32_32x32x16_bf16 a[16:31], v[96:99], v[120:123], a[16:31]
    ds_read_b64_tr_b16 v[82:83], v50 offset:33792
    ds_read_b64_tr_b16 v[88:89], v51 offset:32768
    v_mfma_f32_32x32x16_bf16 a[32:47], v[104:107], v[112:115], a[32:47]
    ds_read_b64_tr_b16 v[90:91], v51 offset:33792
    ds_read_b128 v[72:75], v7 offset:36864
    v_mfma_f32_32x32x16_bf16 a[48:63], v[104:107], v[120:123], a[48:63]
    ds_read_b128 v[68:71], v7 offset:33792
    ds_read_b64_tr_b16 v[84:85], v50 offset:36864
    v_mfma_f32_32x32x16_bf16 a[0:15], v[100:103], v[116:119], a[0:15]
    ds_read_b64_tr_b16 v[86:87], v50 offset:37888
    ds_read_b64_tr_b16 v[92:93], v51 offset:36864
    v_mfma_f32_32x32x16_bf16 a[16:31], v[100:103], v[124:127], a[16:31]
    ds_read_b64_tr_b16 v[94:95], v51 offset:37888
    ds_read_b128 v[76:79], v7 offset:37888
    v_mfma_f32_32x32x16_bf16 a[32:47], v[108:111], v[116:119], a[32:47]
    v_mfma_f32_32x32x16_bf16 a[48:63], v[108:111], v[124:127], a[48:63]
    s_waitcnt lgkmcnt(0)
    v_mfma_f32_32x32x16_bf16 a[0:15], v[64:67], v[80:83], a[0:15]
    ds_read_b128 v[96:99], v7 offset:34816
    ds_read_b64_tr_b16 v[112:113], v50 offset:40960
    v_mfma_f32_32x32x16_bf16 a[16:31], v[64:67], v[88:91], a[16:31]
    ds_read_b64_tr_b16 v[114:115], v50 offset:41984
    ds_read_b64_tr_b16 v[120:121], v51 offset:40960
    v_mfma_f32_32x32x16_bf16 a[32:47], v[72:75], v[80:83], a[32:47]
    ds_read_b64_tr_b16 v[122:123], v51 offset:41984
    ds_read_b128 v[104:107], v7 offset:38912
    v_mfma_f32_32x32x16_bf16 a[48:63], v[72:75], v[88:91], a[48:63]
    ds_read_b128 v[100:103], v7 offset:35840
    ds_read_b64_tr_b16 v[116:117], v50 offset:45056
    v_mfma_f32_32x32x16_bf16 a[0:15], v[68:71], v[84:87], a[0:15]
    ds_read_b64_tr_b16 v[118:119], v50 offset:46080
    ds_read_b64_tr_b16 v[124:125], v51 offset:45056
    v_mfma_f32_32x32x16_bf16 a[16:31], v[68:71], v[92:95], a[16:31]
    ds_read_b64_tr_b16 v[126:127], v51 offset:46080
    ds_read_b128 v[108:111], v7 offset:39936
    v_mfma_f32_32x32x16_bf16 a[32:47], v[76:79], v[84:87], a[32:47]
    v_mfma_f32_32x32x16_bf16 a[48:63], v[76:79], v[92:95], a[48:63]
    s_waitcnt vmcnt(0) lgkmcnt(0)
    s_barrier
    v_mfma_f32_32x32x16_bf16 a[0:15], v[96:99], v[112:115], a[0:15]
    v_mfma_f32_32x32x16_bf16 a[16:31], v[96:99], v[120:123], a[16:31]
    v_mfma_f32_32x32x16_bf16 a[32:47], v[104:107], v[112:115], a[32:47]
    v_mfma_f32_32x32x16_bf16 a[48:63], v[104:107], v[120:123], a[48:63]
    v_mfma_f32_32x32x16_bf16 a[0:15], v[100:103], v[116:119], a[0:15]
    v_mfma_f32_32x32x16_bf16 a[16:31], v[100:103], v[124:127], a[16:31]
    v_mfma_f32_32x32x16_bf16 a[32:47], v[108:111], v[116:119], a[32:47]
    v_mfma_f32_32x32x16_bf16 a[48:63], v[108:111], v[124:127], a[48:63]
    s_nop 15
ub_kvs_epi:
    v_accvgpr_read_b32 v16, a0
    v_accvgpr_read_b32 v17, a1
    v_accvgpr_read_b32 v18, a2
    v_accvgpr_read_b32 v19, a3
    v_accvgpr_read_b32 v20, a4
    v_accvgpr_read_b32 v21, a5
    v_accvgpr_read_b32 v22, a6
    v_accvgpr_read_b32 v23, a7
    v_accvgpr_read_b32 v24, a8
    v_accvgpr_read_b32 v25, a9
    v_accvgpr_read_b32 v26, a10
    v_accvgpr_read_b32 v27, a11
    v_accvgpr_read_b32 v28, a12
    v_accvgpr_read_b32 v29, a13
    v_accvgpr_read_b32 v30, a14
    v_accvgpr_read_b32 v31, a15
    v_cvt_pk_bf16_f32 v32, v16, v17
    v_cvt_pk_bf16_f32 v33, v18, v19
    v_cvt_pk_bf16_f32 v34, v20, v21
    v_cvt_pk_bf16_f32 v35, v22, v23
    v_cvt_pk_bf16_f32 v36, v24, v25
    v_cvt_pk_bf16_f32 v37, v26, v27
    v_cvt_pk_bf16_f32 v38, v28, v29
    v_cvt_pk_bf16_f32 v39, v30, v31
    s_add_u32 s24, s45, 0
    s_nop 0
    v_permlane32_swap_b32 v32, v34
    v_permlane32_swap_b32 v33, v35
    v_permlane32_swap_b32 v36, v38
    v_permlane32_swap_b32 v37, v39
    buffer_store_dwordx4 v[32:35], v1, s[8:11], s24 offen offset:0 sc1
    buffer_store_dwordx4 v[36:39], v1, s[8:11], s24 offen offset:1024 sc1
    v_accvgpr_read_b32 v40, a16
    v_accvgpr_read_b32 v41, a17
    v_accvgpr_read_b32 v42, a18
    v_accvgpr_read_b32 v43, a19
    v_accvgpr_read_b32 v44, a20
    v_accvgpr_read_b32 v45, a21
    v_accvgpr_read_b32 v46, a22
    v_accvgpr_read_b32 v47, a23
    v_accvgpr_read_b32 v48, a24
    v_accvgpr_read_b32 v49, a25
    v_accvgpr_read_b32 v50, a26
    v_accvgpr_read_b32 v51, a27
    v_accvgpr_read_b32 v52, a28
    v_accvgpr_read_b32 v53, a29
    v_accvgpr_read_b32 v54, a30
    v_accvgpr_read_b32 v55, a31
    v_cvt_pk_bf16_f32 v56, v40, v41
    v_cvt_pk_bf16_f32 v57, v42, v43
    v_cvt_pk_bf16_f32 v58, v44, v45
    v_cvt_pk_bf16_f32 v59, v46, v47
    v_cvt_pk_bf16_f32 v60, v48, v49
    v_cvt_pk_bf16_f32 v61, v50, v51
    v_cvt_pk_bf16_f32 v62, v52, v53
    v_cvt_pk_bf16_f32 v63, v54, v55
    s_nop 0
    v_permlane32_swap_b32 v56, v58
    v_permlane32_swap_b32 v57, v59
    v_permlane32_swap_b32 v60, v62
    v_permlane32_swap_b32 v61, v63
    buffer_store_dwordx4 v[56:59], v1, s[8:11], s24 offen offset:2048 sc1
    buffer_store_dwordx4 v[60:63], v1, s[8:11], s24 offen offset:3072 sc1
    v_accvgpr_read_b32 v16, a32
    v_accvgpr_read_b32 v17, a33
    v_accvgpr_read_b32 v18, a34
    v_accvgpr_read_b32 v19, a35
    v_accvgpr_read_b32 v20, a36
    v_accvgpr_read_b32 v21, a37
    v_accvgpr_read_b32 v22, a38
    v_accvgpr_read_b32 v23, a39
    v_accvgpr_read_b32 v24, a40
    v_accvgpr_read_b32 v25, a41
    v_accvgpr_read_b32 v26, a42
    v_accvgpr_read_b32 v27, a43
    v_accvgpr_read_b32 v28, a44
    v_accvgpr_read_b32 v29, a45
    v_accvgpr_read_b32 v30, a46
    v_accvgpr_read_b32 v31, a47
    v_cvt_pk_bf16_f32 v32, v16, v17
    v_cvt_pk_bf16_f32 v33, v18, v19
    v_cvt_pk_bf16_f32 v34, v20, v21
    v_cvt_pk_bf16_f32 v35, v22, v23
    v_cvt_pk_bf16_f32 v36, v24, v25
    v_cvt_pk_bf16_f32 v37, v26, v27
    v_cvt_pk_bf16_f32 v38, v28, v29
    v_cvt_pk_bf16_f32 v39, v30, v31
    s_add_u32 s24, s45, 262144
    s_nop 0
    v_permlane32_swap_b32 v32, v34
    v_permlane32_swap_b32 v33, v35
    v_permlane32_swap_b32 v36, v38
    v_permlane32_swap_b32 v37, v39
    buffer_store_dwordx4 v[32:35], v1, s[8:11], s24 offen offset:0 sc1
    buffer_store_dwordx4 v[36:39], v1, s[8:11], s24 offen offset:1024 sc1
    v_accvgpr_read_b32 v40, a48
    v_accvgpr_read_b32 v41, a49
    v_accvgpr_read_b32 v42, a50
    v_accvgpr_read_b32 v43, a51
    v_accvgpr_read_b32 v44, a52
    v_accvgpr_read_b32 v45, a53
    v_accvgpr_read_b32 v46, a54
    v_accvgpr_read_b32 v47, a55
    v_accvgpr_read_b32 v48, a56
    v_accvgpr_read_b32 v49, a57
    v_accvgpr_read_b32 v50, a58
    v_accvgpr_read_b32 v51, a59
    v_accvgpr_read_b32 v52, a60
    v_accvgpr_read_b32 v53, a61
    v_accvgpr_read_b32 v54, a62
    v_accvgpr_read_b32 v55, a63
    v_cvt_pk_bf16_f32 v56, v40, v41
    v_cvt_pk_bf16_f32 v57, v42, v43
    v_cvt_pk_bf16_f32 v58, v44, v45
    v_cvt_pk_bf16_f32 v59, v46, v47
    v_cvt_pk_bf16_f32 v60, v48, v49
    v_cvt_pk_bf16_f32 v61, v50, v51
    v_cvt_pk_bf16_f32 v62, v52, v53
    v_cvt_pk_bf16_f32 v63, v54, v55
    s_nop 0
    v_permlane32_swap_b32 v56, v58
    v_permlane32_swap_b32 v57, v59
    v_permlane32_swap_b32 v60, v62
    v_permlane32_swap_b32 v61, v63
    buffer_store_dwordx4 v[56:59], v1, s[8:11], s24 offen offset:2048 sc1
    buffer_store_dwordx4 v[60:63], v1, s[8:11], s24 offen offset:3072 sc1
    s_waitcnt vmcnt(0)
    s_barrier
    s_cmp_lg_u32 s3, 0
    s_cbranch_scc1 ub_pfw
    v_mov_b32 v10, 1
    s_mov_b64 exec, 1
    buffer_atomic_add v10, off, s[8:11], s58
    s_mov_b64 exec, -1
    s_branch ub_pfw
ub_pfw:
    s_lshl_b32 s24, s51, 5
    s_add_u32 s24, s24, s5
    s_lshl_b32 s24, s24, 16
    s_add_u32 s25, s24, 0x8000
    v_lshlrev_b32 v12, 7, v0
    s_mov_b32 s12, s36
    s_and_b32 s13, s37, 0xffff
    s_mov_b32 s14, 0x700000
    s_mov_b32 s15, 0x20000
    buffer_load_dword v13, v12, s[12:15], s24 offen
    buffer_load_dword v14, v12, s[12:15], s25 offen
    s_mov_b32 s12, s38
    s_and_b32 s13, s39, 0xffff
    s_mov_b32 s14, 0x700000
    s_mov_b32 s15, 0x20000
    buffer_load_dword v13, v12, s[12:15], s24 offen
    buffer_load_dword v14, v12, s[12:15], s25 offen
    s_waitcnt vmcnt(0)
    s_branch ub_next
    s_waitcnt vmcnt(0)
    s_barrier
    s_cmp_lg_u32 s3, 0
    s_cbranch_scc1 ub_next
    v_mov_b32 v10, 1
    s_mov_b64 exec, 1
    buffer_atomic_add v10, off, s[8:11], s58
    s_mov_b64 exec, -1
    s_branch ub_next
ub_eng:
    s_mov_b32 s12, s34
    s_and_b32 s13, s35, 0xffff
    s_mov_b32 s14, 0x800000
    s_mov_b32 s15, 0x20000
    s_mov_b32 s28, s56
    s_and_b32 s29, s57, 0xffff
    s_mov_b32 s30, 0x400000
    s_mov_b32 s31, 0x20000
    s_mov_b32 s32, s54
    s_and_b32 s33, s55, 0xffff
    s_mov_b32 s34, 0x400000
    s_mov_b32 s35, 0x20000
    v_and_b32 v9, 63, v0
    v_lshlrev_b32 v1, 4, v9
    v_lshrrev_b32 v2, 2, v9
    v_lshlrev_b32 v2, 11, v2
    v_and_b32 v10, 3, v9
    v_lshl_add_u32 v2, v10, 4, v2
    v_lshrrev_b32 v3, 5, v9
    v_lshlrev_b32 v3, 3, v3
    v_bfe_u32 v11, v9, 2, 2
    v_add_u32 v3, v3, v11
    v_lshlrev_b32 v3, 6, v3
    v_bfe_u32 v11, v9, 4, 1
    v_lshl_add_u32 v3, v11, 5, v3
    v_lshl_add_u32 v3, v10, 3, v3
    s_lshl_b32 s22, s3, 15
    v_add_u32 v3, s22, v3
    s_lshl_b32 s18, s3, 21
    s_lshl_b32 s24, s5, 6
    s_add_u32 s18, s18, s24
    s_mov_b32 m0, s22
    s_mov_b32 s21, 32
el_23:
    buffer_load_dwordx4 v2, s[12:15], s18 offen lds
    s_add_u32 s18, s18, 32768
    s_add_u32 m0, m0, 1024
    s_sub_u32 s21, s21, 1
    s_cmp_lg_u32 s21, 0
    s_cbranch_scc1 el_23
    s_waitcnt vmcnt(0)
    ds_read_b64_tr_b16 a[0:1], v3 offset:0
    ds_read_b64_tr_b16 a[2:3], v3 offset:256
    ds_read_b64_tr_b16 a[4:5], v3 offset:1024
    ds_read_b64_tr_b16 a[6:7], v3 offset:1280
    ds_read_b64_tr_b16 a[8:9], v3 offset:2048
    ds_read_b64_tr_b16 a[10:11], v3 offset:2304
    ds_read_b64_tr_b16 a[12:13], v3 offset:3072
    ds_read_b64_tr_b16 a[14:15], v3 offset:3328
    s_waitcnt lgkmcnt(0)
    ds_read_b64_tr_b16 a[16:17], v3 offset:4096
    ds_read_b64_tr_b16 a[18:19], v3 offset:4352
    ds_read_b64_tr_b16 a[20:21], v3 offset:5120
    ds_read_b64_tr_b16 a[22:23], v3 offset:5376
    ds_read_b64_tr_b16 a[24:25], v3 offset:6144
    ds_read_b64_tr_b16 a[26:27], v3 offset:6400
    ds_read_b64_tr_b16 a[28:29], v3 offset:7168
    ds_read_b64_tr_b16 a[30:31], v3 offset:7424
    s_waitcnt lgkmcnt(0)
    ds_read_b64_tr_b16 a[32:33], v3 offset:8192
    ds_read_b64_tr_b16 a[34:35], v3 offset:8448
    ds_read_b64_tr_b16 a[36:37], v3 offset:9216
    ds_read_b64_tr_b16 a[38:39], v3 offset:9472
    ds_read_b64_tr_b16 a[40:41], v3 offset:10240
    ds_read_b64_tr_b16 a[42:43], v3 offset:10496
    ds_read_b64_tr_b16 a[44:45], v3 offset:11264
    ds_read_b64_tr_b16 a[46:47], v3 offset:11520
    s_waitcnt lgkmcnt(0)
    ds_read_b64_tr_b16 a[48:49], v3 offset:12288
    ds_read_b64_tr_b16 a[50:51], v3 offset:12544
    ds_read_b64_tr_b16 a[52:53], v3 offset:13312
    ds_read_b64_tr_b16 a[54:55], v3 offset:13568
    ds_read_b64_tr_b16 a[56:57], v3 offset:14336
    ds_read_b64_tr_b16 a[58:59], v3 offset:14592
    ds_read_b64_tr_b16 a[60:61], v3 offset:15360
    ds_read_b64_tr_b16 a[62:63], v3 offset:15616
    s_waitcnt lgkmcnt(0)
    ds_read_b64_tr_b16 a[64:65], v3 offset:16384
    ds_read_b64_tr_b16 a[66:67], v3 offset:16640
    ds_read_b64_tr_b16 a[68:69], v3 offset:17408
    ds_read_b64_tr_b16 a[70:71], v3 offset:17664
    ds_read_b64_tr_b16 a[72:73], v3 offset:18432
    ds_read_b64_tr_b16 a[74:75], v3 offset:18688
    ds_read_b64_tr_b16 a[76:77], v3 offset:19456
    ds_read_b64_tr_b16 a[78:79], v3 offset:19712
    s_waitcnt lgkmcnt(0)
    ds_read_b64_tr_b16 a[80:81], v3 offset:20480
    ds_read_b64_tr_b16 a[82:83], v3 offset:20736
    ds_read_b64_tr_b16 a[84:85], v3 offset:21504
    ds_read_b64_tr_b16 a[86:87], v3 offset:21760
    ds_read_b64_tr_b16 a[88:89], v3 offset:22528
    ds_read_b64_tr_b16 a[90:91], v3 offset:22784
    ds_read_b64_tr_b16 a[92:93], v3 offset:23552
    ds_read_b64_tr_b16 a[94:95], v3 offset:23808
    s_waitcnt lgkmcnt(0)
    ds_read_b64_tr_b16 a[96:97], v3 offset:24576
    ds_read_b64_tr_b16 a[98:99], v3 offset:24832
    ds_read_b64_tr_b16 a[100:101], v3 offset:25600
    ds_read_b64_tr_b16 a[102:103], v3 offset:25856
    ds_read_b64_tr_b16 a[104:105], v3 offset:26624
    ds_read_b64_tr_b16 a[106:107], v3 offset:26880
    ds_read_b64_tr_b16 a[108:109], v3 offset:27648
    ds_read_b64_tr_b16 a[110:111], v3 offset:27904
    s_waitcnt lgkmcnt(0)
    ds_read_b64_tr_b16 a[112:113], v3 offset:28672
    ds_read_b64_tr_b16 a[114:115], v3 offset:28928
    ds_read_b64_tr_b16 a[116:117], v3 offset:29696
    ds_read_b64_tr_b16 a[118:119], v3 offset:29952
    ds_read_b64_tr_b16 a[120:121], v3 offset:30720
    ds_read_b64_tr_b16 a[122:123], v3 offset:30976
    ds_read_b64_tr_b16 a[124:125], v3 offset:31744
    ds_read_b64_tr_b16 a[126:127], v3 offset:32000
    s_waitcnt lgkmcnt(0)
    s_mov_b32 m0, s22
    s_mov_b32 s21, 32
el_24:
    buffer_load_dwordx4 v2, s[12:15], s18 offen lds
    s_add_u32 s18, s18, 32768
    s_add_u32 m0, m0, 1024
    s_sub_u32 s21, s21, 1
    s_cmp_lg_u32 s21, 0
    s_cbranch_scc1 el_24
    s_waitcnt vmcnt(0)
    ds_read_b64_tr_b16 a[128:129], v3 offset:0
    ds_read_b64_tr_b16 a[130:131], v3 offset:256
    ds_read_b64_tr_b16 a[132:133], v3 offset:1024
    ds_read_b64_tr_b16 a[134:135], v3 offset:1280
    ds_read_b64_tr_b16 a[136:137], v3 offset:2048
    ds_read_b64_tr_b16 a[138:139], v3 offset:2304
    ds_read_b64_tr_b16 a[140:141], v3 offset:3072
    ds_read_b64_tr_b16 a[142:143], v3 offset:3328
    s_waitcnt lgkmcnt(0)
    ds_read_b64_tr_b16 a[144:145], v3 offset:4096
    ds_read_b64_tr_b16 a[146:147], v3 offset:4352
    ds_read_b64_tr_b16 a[148:149], v3 offset:5120
    ds_read_b64_tr_b16 a[150:151], v3 offset:5376
    ds_read_b64_tr_b16 a[152:153], v3 offset:6144
    ds_read_b64_tr_b16 a[154:155], v3 offset:6400
    ds_read_b64_tr_b16 a[156:157], v3 offset:7168
    ds_read_b64_tr_b16 a[158:159], v3 offset:7424
    s_waitcnt lgkmcnt(0)
    ds_read_b64_tr_b16 a[160:161], v3 offset:8192
    ds_read_b64_tr_b16 a[162:163], v3 offset:8448
    ds_read_b64_tr_b16 a[164:165], v3 offset:9216
    ds_read_b64_tr_b16 a[166:167], v3 offset:9472
    ds_read_b64_tr_b16 a[168:169], v3 offset:10240
    ds_read_b64_tr_b16 a[170:171], v3 offset:10496
    ds_read_b64_tr_b16 a[172:173], v3 offset:11264
    ds_read_b64_tr_b16 a[174:175], v3 offset:11520
    s_waitcnt lgkmcnt(0)
    ds_read_b64_tr_b16 a[176:177], v3 offset:12288
    ds_read_b64_tr_b16 a[178:179], v3 offset:12544
    ds_read_b64_tr_b16 a[180:181], v3 offset:13312
    ds_read_b64_tr_b16 a[182:183], v3 offset:13568
    ds_read_b64_tr_b16 a[184:185], v3 offset:14336
    ds_read_b64_tr_b16 a[186:187], v3 offset:14592
    ds_read_b64_tr_b16 a[188:189], v3 offset:15360
    ds_read_b64_tr_b16 a[190:191], v3 offset:15616
    s_waitcnt lgkmcnt(0)
    ds_read_b64_tr_b16 a[192:193], v3 offset:16384
    ds_read_b64_tr_b16 a[194:195], v3 offset:16640
    ds_read_b64_tr_b16 a[196:197], v3 offset:17408
    ds_read_b64_tr_b16 a[198:199], v3 offset:17664
    ds_read_b64_tr_b16 a[200:201], v3 offset:18432
    ds_read_b64_tr_b16 a[202:203], v3 offset:18688
    ds_read_b64_tr_b16 a[204:205], v3 offset:19456
    ds_read_b64_tr_b16 a[206:207], v3 offset:19712
    s_waitcnt lgkmcnt(0)
    ds_read_b64_tr_b16 a[208:209], v3 offset:20480
    ds_read_b64_tr_b16 a[210:211], v3 offset:20736
    ds_read_b64_tr_b16 a[212:213], v3 offset:21504
    ds_read_b64_tr_b16 a[214:215], v3 offset:21760
    ds_read_b64_tr_b16 a[216:217], v3 offset:22528
    ds_read_b64_tr_b16 a[218:219], v3 offset:22784
    ds_read_b64_tr_b16 a[220:221], v3 offset:23552
    ds_read_b64_tr_b16 a[222:223], v3 offset:23808
    s_waitcnt lgkmcnt(0)
    ds_read_b64_tr_b16 a[224:225], v3 offset:24576
    ds_read_b64_tr_b16 a[226:227], v3 offset:24832
    ds_read_b64_tr_b16 a[228:229], v3 offset:25600
    ds_read_b64_tr_b16 a[230:231], v3 offset:25856
    ds_read_b64_tr_b16 a[232:233], v3 offset:26624
    ds_read_b64_tr_b16 a[234:235], v3 offset:26880
    ds_read_b64_tr_b16 a[236:237], v3 offset:27648
    ds_read_b64_tr_b16 a[238:239], v3 offset:27904
    s_waitcnt lgkmcnt(0)
    ds_read_b64_tr_b16 a[240:241], v3 offset:28672
    ds_read_b64_tr_b16 a[242:243], v3 offset:28928
    ds_read_b64_tr_b16 a[244:245], v3 offset:29696
    ds_read_b64_tr_b16 a[246:247], v3 offset:29952
    ds_read_b64_tr_b16 a[248:249], v3 offset:30720
    ds_read_b64_tr_b16 a[250:251], v3 offset:30976
    ds_read_b64_tr_b16 a[252:253], v3 offset:31744
    ds_read_b64_tr_b16 a[254:255], v3 offset:32000
    s_waitcnt lgkmcnt(0)
    s_barrier
    v_and_b32 v10, 31, v9
    v_lshrrev_b32 v11, 5, v9
    v_lshlrev_b32 v4, 11, v10
    v_lshl_add_u32 v4, v11, 3, v4
    v_lshlrev_b32 v5, 4, v10
    v_lshl_add_u32 v5, v11, 3, v5
    s_lshl_b32 s24, s3, 12
    v_add_u32 v6, s24, v1
    s_lshl_b32 s24, s3, 10
    v_add_u32 v7, s24, v1
    s_cmp_lt_u32 s51, 2
    s_cselect_b32 s40, 48, 60
    s_add_u32 s40, s40, s51
eng_loop:
    s_mul_i32 s16, s40, 491520
    s_lshl_b32 s24, s3, 16
    s_add_u32 s16, s16, s24
    s_add_u32 s16, s16, 54525952
    s_lshl_b32 s45, s40, 16
    s_lshl_b32 s24, s5, 6
    s_add_u32 s45, s45, s24
    s_lshl_b32 s24, s3, 4
    s_add_u32 s45, s45, s24
    s_lshr_b32 s43, s40, 2
    s_lshl_b32 s59, s43, 7
    s_add_u32 s59, s59, 105910272
    s_lshl_b32 s43, s43, 18
    s_lshr_b32 s24, s5, 2
    s_lshl_b32 s24, s24, 15
    s_add_u32 s43, s43, s24
    s_bfe_u32 s24, s40, 0x10001
    s_lshl_b32 s24, s24, 14
    s_add_u32 s43, s43, s24
    s_bfe_u32 s24, s5, 0x10001
    s_lshl_b32 s24, s24, 13
    s_add_u32 s43, s43, s24
    s_and_b32 s24, s40, 1
    s_lshl_b32 s24, s24, 12
    s_add_u32 s43, s43, s24
    s_and_b32 s24, s5, 1
    s_lshl_b32 s24, s24, 11
    s_add_u32 s43, s43, s24
    s_lshl_b32 s24, s3, 9
    s_add_u32 s43, s43, s24
    s_add_u32 s43, s43, 96468992
wait_25:
    buffer_load_dword v10, off, s[8:11], s59 sc1
    s_waitcnt vmcnt(0)
    v_readfirstlane_b32 s24, v10
    s_cmp_ge_u32 s24, 8
    s_cbranch_scc1 waitok_26
    s_sleep 16
    s_sub_u32 s95, s95, 1
    s_cbranch_scc0 wait_25
    s_mov_b32 s95, 0
waitok_26:
    buffer_load_dwordx2 v[12:13], v4, s[28:31], s45 offen
    buffer_load_dwordx2 v[14:15], v5, s[8:11], s43 offen sc1
    s_lshl_b32 s59, s40, 10
    s_lshl_b32 s24, s3, 8
    s_add_u32 s59, s59, s24
    s_add_u32 s59, s59, 105897984
    v_lshlrev_b32 v11, 3, v1
    s_mov_b64 exec, 3
eng_poll:
    buffer_load_dword v10, v11, s[8:11], s59 offen sc1
    s_waitcnt vmcnt(0)
    v_cmp_eq_u32 vcc, 0, v10
    s_cbranch_vccz eng_go
    s_sleep 2
    s_sub_u32 s95, s95, 1
    s_cbranch_scc0 eng_poll
    s_mov_b32 s95, 0
eng_go:
    s_mov_b64 exec, -1
    buffer_load_dwordx4 v[64:67], v1, s[8:11], s16 offen offset:0 sc1
    buffer_load_dwordx4 v[68:71], v1, s[8:11], s16 offen offset:1024 sc1
    buffer_load_dwordx4 v[72:75], v1, s[8:11], s16 offen offset:2048 sc1
    buffer_load_dwordx4 v[76:79], v1, s[8:11], s16 offen offset:3072 sc1
    s_add_u32 s16, s16, 4096
    buffer_load_dwordx4 v[80:83], v1, s[8:11], s16 offen offset:0 sc1
    buffer_load_dwordx4 v[84:87], v1, s[8:11], s16 offen offset:1024 sc1
    buffer_load_dwordx4 v[88:91], v1, s[8:11], s16 offen offset:2048 sc1
    buffer_load_dwordx4 v[92:95], v1, s[8:11], s16 offen offset:3072 sc1
    s_add_u32 s16, s16, 4096
    buffer_load_dwordx4 v[96:99], v1, s[8:11], s16 offen offset:0 sc1
    buffer_load_dwordx4 v[100:103], v1, s[8:11], s16 offen offset:1024 sc1
    buffer_load_dwordx4 v[104:107], v1, s[8:11], s16 offen offset:2048 sc1
    buffer_load_dwordx4 v[108:111], v1, s[8:11], s16 offen offset:3072 sc1
    s_add_u32 s16, s16, 4096
    buffer_load_dwordx4 v[112:115], v1, s[8:11], s16 offen offset:0 sc1
    buffer_load_dwordx4 v[116:119], v1, s[8:11], s16 offen offset:1024 sc1
    buffer_load_dwordx4 v[120:123], v1, s[8:11], s16 offen offset:2048 sc1
    buffer_load_dwordx4 v[124:127], v1, s[8:11], s16 offen offset:3072 sc1
    s_add_u32 s16, s16, 4096
    buffer_load_dwordx4 v[128:131], v1, s[8:11], s16 offen offset:0 sc1
    buffer_load_dwordx4 v[132:135], v1, s[8:11], s16 offen offset:1024 sc1
    buffer_load_dwordx4 v[136:139], v1, s[8:11], s16 offen offset:2048 sc1
    buffer_load_dwordx4 v[140:143], v1, s[8:11], s16 offen offset:3072 sc1
    s_add_u32 s16, s16, 4096
    buffer_load_dwordx4 v[144:147], v1, s[8:11], s16 offen offset:0 sc1
    buffer_load_dwordx4 v[148:151], v1, s[8:11], s16 offen offset:1024 sc1
    buffer_load_dwordx4 v[152:155], v1, s[8:11], s16 offen offset:2048 sc1
    buffer_load_dwordx4 v[156:159], v1, s[8:11], s16 offen offset:3072 sc1
    s_add_u32 s16, s16, 4096
    buffer_load_dwordx4 v[160:163], v1, s[8:11], s16 offen offset:0 sc1
    buffer_load_dwordx4 v[164:167], v1, s[8:11], s16 offen offset:1024 sc1
    buffer_load_dwordx4 v[168:171], v1, s[8:11], s16 offen offset:2048 sc1
    buffer_load_dwordx4 v[172:175], v1, s[8:11], s16 offen offset:3072 sc1
    s_add_u32 s16, s16, 4096
    buffer_load_dwordx4 v[176:179], v1, s[8:11], s16 offen offset:0 sc1
    buffer_load_dwordx4 v[180:183], v1, s[8:11], s16 offen offset:1024 sc1
    buffer_load_dwordx4 v[184:187], v1, s[8:11], s16 offen offset:2048 sc1
    buffer_load_dwordx4 v[188:191], v1, s[8:11], s16 offen offset:3072 sc1
    s_add_u32 s16, s16, 4096
    buffer_load_dwordx4 v[192:195], v1, s[8:11], s16 offen offset:0 sc1
    buffer_load_dwordx4 v[196:199], v1, s[8:11], s16 offen offset:1024 sc1
    buffer_load_dwordx4 v[200:203], v1, s[8:11], s16 offen offset:2048 sc1
    buffer_load_dwordx4 v[204:207], v1, s[8:11], s16 offen offset:3072 sc1
    s_add_u32 s16, s16, 4096
    buffer_load_dwordx4 v[208:211], v1, s[8:11], s16 offen offset:0 sc1
    buffer_load_dwordx4 v[212:215], v1, s[8:11], s16 offen offset:1024 sc1
    buffer_load_dwordx4 v[216:219], v1, s[8:11], s16 offen offset:2048 sc1
    buffer_load_dwordx4 v[220:223], v1, s[8:11], s16 offen offset:3072 sc1
    s_add_u32 s16, s16, 4096
    buffer_load_dwordx4 v[224:227], v1, s[8:11], s16 offen offset:0 sc1
    buffer_load_dwordx4 v[228:231], v1, s[8:11], s16 offen offset:1024 sc1
    buffer_load_dwordx4 v[232:235], v1, s[8:11], s16 offen offset:2048 sc1
    buffer_load_dwordx4 v[236:239], v1, s[8:11], s16 offen offset:3072 sc1
    s_add_u32 s16, s16, 4096
    buffer_load_dwordx4 v[240:243], v1, s[8:11], s16 offen offset:0 sc1
    buffer_load_dwordx4 v[244:247], v1, s[8:11], s16 offen offset:1024 sc1
    buffer_load_dwordx4 v[248:251], v1, s[8:11], s16 offen offset:2048 sc1
    buffer_load_dwordx4 v[252:255], v1, s[8:11], s16 offen offset:3072 sc1
    s_waitcnt vmcnt(47)
    v_mfma_f32_32x32x16_bf16 v[16:31], a[0:3], v[64:67], 0
    s_add_u32 s16, s16, 4096
    buffer_load_dwordx4 v[64:67], v1, s[8:11], s16 offen offset:0 sc1
    s_waitcnt vmcnt(47)
    v_mfma_f32_32x32x16_bf16 v[16:31], a[4:7], v[68:71], v[16:31]
    buffer_load_dwordx4 v[68:71], v1, s[8:11], s16 offen offset:1024 sc1
    s_waitcnt vmcnt(47)
    v_mfma_f32_32x32x16_bf16 v[16:31], a[8:11], v[72:75], v[16:31]
    buffer_load_dwordx4 v[72:75], v1, s[8:11], s16 offen offset:2048 sc1
    s_waitcnt vmcnt(47)
    v_mfma_f32_32x32x16_bf16 v[16:31], a[12:15], v[76:79], v[16:31]
    buffer_load_dwordx4 v[76:79], v1, s[8:11], s16 offen offset:3072 sc1
    s_waitcnt vmcnt(47)
    v_mfma_f32_32x32x16_bf16 v[16:31], a[16:19], v[80:83], v[16:31]
    s_add_u32 s16, s16, 4096
    buffer_load_dwordx4 v[80:83], v1, s[8:11], s16 offen offset:0 sc1
    s_waitcnt vmcnt(47)
    v_mfma_f32_32x32x16_bf16 v[16:31], a[20:23], v[84:87], v[16:31]
    buffer_load_dwordx4 v[84:87], v1, s[8:11], s16 offen offset:1024 sc1
    s_waitcnt vmcnt(47)
    v_mfma_f32_32x32x16_bf16 v[16:31], a[24:27], v[88:91], v[16:31]
    buffer_load_dwordx4 v[88:91], v1, s[8:11], s16 offen offset:2048 sc1
    s_waitcnt vmcnt(47)
    v_mfma_f32_32x32x16_bf16 v[16:31], a[28:31], v[92:95], v[16:31]
    buffer_load_dwordx4 v[92:95], v1, s[8:11], s16 offen offset:3072 sc1
    s_waitcnt vmcnt(47)
    v_mfma_f32_32x32x16_bf16 v[16:31], a[32:35], v[96:99], v[16:31]
    s_add_u32 s16, s16, 4096
    buffer_load_dwordx4 v[96:99], v1, s[8:11], s16 offen offset:0 sc1
    s_waitcnt vmcnt(47)
    v_mfma_f32_32x32x16_bf16 v[16:31], a[36:39], v[100:103], v[16:31]
    buffer_load_dwordx4 v[100:103], v1, s[8:11], s16 offen offset:1024 sc1
    s_waitcnt vmcnt(47)
    v_mfma_f32_32x32x16_bf16 v[16:31], a[40:43], v[104:107], v[16:31]
    buffer_load_dwordx4 v[104:107], v1, s[8:11], s16 offen offset:2048 sc1
    s_waitcnt vmcnt(47)
    v_mfma_f32_32x32x16_bf16 v[16:31], a[44:47], v[108:111], v[16:31]
    buffer_load_dwordx4 v[108:111], v1, s[8:11], s16 offen offset:3072 sc1
    s_waitcnt vmcnt(47)
    v_mfma_f32_32x32x16_bf16 v[16:31], a[48:51], v[112:115], v[16:31]
    s_add_u32 s16, s16, 4096
    buffer_load_dwordx4 v[112:115], v1, s[8:11], s16 offen offset:0 sc1
    s_waitcnt vmcnt(47)
    v_mfma_f32_32x32x16_bf16 v[16:31], a[52:55], v[116:119], v[16:31]
    buffer_load_dwordx4 v[116:119], v1, s[8:11], s16 offen offset:1024 sc1
    s_waitcnt vmcnt(47)
    v_mfma_f32_32x32x16_bf16 v[16:31], a[56:59], v[120:123], v[16:31]
    buffer_load_dwordx4 v[120:123], v1, s[8:11], s16 offen offset:2048 sc1
    s_waitcnt vmcnt(47)
    v_mfma_f32_32x32x16_bf16 v[16:31], a[60:63], v[124:127], v[16:31]
    buffer_load_dwordx4 v[124:127], v1, s[8:11], s16 offen offset:3072 sc1
    s_waitcnt vmcnt(47)
    v_mfma_f32_32x32x16_bf16 v[16:31], a[64:67], v[128:131], v[16:31]
    s_waitcnt vmcnt(46)
    v_mfma_f32_32x32x16_bf16 v[16:31], a[68:71], v[132:135], v[16:31]
    s_waitcnt vmcnt(45)
    v_mfma_f32_32x32x16_bf16 v[16:31], a[72:75], v[136:139], v[16:31]
    s_waitcnt vmcnt(44)
    v_mfma_f32_32x32x16_bf16 v[16:31], a[76:79], v[140:143], v[16:31]
    s_waitcnt vmcnt(43)
    v_mfma_f32_32x32x16_bf16 v[16:31], a[80:83], v[144:147], v[16:31]
    s_waitcnt vmcnt(42)
    v_mfma_f32_32x32x16_bf16 v[16:31], a[84:87], v[148:151], v[16:31]
    s_waitcnt vmcnt(41)
    v_mfma_f32_32x32x16_bf16 v[16:31], a[88:91], v[152:155], v[16:31]
    s_waitcnt vmcnt(40)
    v_mfma_f32_32x32x16_bf16 v[16:31], a[92:95], v[156:159], v[16:31]
    s_waitcnt vmcnt(39)
    v_mfma_f32_32x32x16_bf16 v[16:31], a[96:99], v[160:163], v[16:31]
    s_waitcnt vmcnt(38)
    v_mfma_f32_32x32x16_bf16 v[16:31], a[100:103], v[164:167], v[16:31]
    s_waitcnt vmcnt(37)
    v_mfma_f32_32x32x16_bf16 v[16:31], a[104:107], v[168:171], v[16:31]
    s_waitcnt vmcnt(36)
    v_mfma_f32_32x32x16_bf16 v[16:31], a[108:111], v[172:175], v[16:31]
    s_waitcnt vmcnt(35)
    v_mfma_f32_32x32x16_bf16 v[16:31], a[112:115], v[176:179], v[16:31]
    s_waitcnt vmcnt(34)
    v_mfma_f32_32x32x16_bf16 v[16:31], a[116:119], v[180:183], v[16:31]
    s_waitcnt vmcnt(33)
    v_mfma_f32_32x32x16_bf16 v[16:31], a[120:123], v[184:187], v[16:31]
    s_waitcnt vmcnt(32)
    v_mfma_f32_32x32x16_bf16 v[16:31], a[124:127], v[188:191], v[16:31]
    s_waitcnt vmcnt(31)
    v_mfma_f32_32x32x16_bf16 v[16:31], a[128:131], v[192:195], v[16:31]
    s_waitcnt vmcnt(30)
    v_mfma_f32_32x32x16_bf16 v[16:31], a[132:135], v[196:199], v[16:31]
    s_waitcnt vmcnt(29)
    v_mfma_f32_32x32x16_bf16 v[16:31], a[136:139], v[200:203], v[16:31]
    s_waitcnt vmcnt(28)
    v_mfma_f32_32x32x16_bf16 v[16:31], a[140:143], v[204:207], v[16:31]
    s_waitcnt vmcnt(27)
    v_mfma_f32_32x32x16_bf16 v[16:31], a[144:147], v[208:211], v[16:31]
    s_waitcnt vmcnt(26)
    v_mfma_f32_32x32x16_bf16 v[16:31], a[148:151], v[212:215], v[16:31]
    s_waitcnt vmcnt(25)
    v_mfma_f32_32x32x16_bf16 v[16:31], a[152:155], v[216:219], v[16:31]
    s_waitcnt vmcnt(24)
    v_mfma_f32_32x32x16_bf16 v[16:31], a[156:159], v[220:223], v[16:31]
    s_waitcnt vmcnt(23)
    v_mfma_f32_32x32x16_bf16 v[16:31], a[160:163], v[224:227], v[16:31]
    s_waitcnt vmcnt(22)
    v_mfma_f32_32x32x16_bf16 v[16:31], a[164:167], v[228:231], v[16:31]
    s_waitcnt vmcnt(21)
    v_mfma_f32_32x32x16_bf16 v[16:31], a[168:171], v[232:235], v[16:31]
    s_waitcnt vmcnt(20)
    v_mfma_f32_32x32x16_bf16 v[16:31], a[172:175], v[236:239], v[16:31]
    s_waitcnt vmcnt(19)
    v_mfma_f32_32x32x16_bf16 v[16:31], a[176:179], v[240:243], v[16:31]
    s_waitcnt vmcnt(18)
    v_mfma_f32_32x32x16_bf16 v[16:31], a[180:183], v[244:247], v[16:31]
    s_waitcnt vmcnt(17)
    v_mfma_f32_32x32x16_bf16 v[16:31], a[184:187], v[248:251], v[16:31]
    s_waitcnt vmcnt(16)
    v_mfma_f32_32x32x16_bf16 v[16:31], a[188:191], v[252:255], v[16:31]
    s_waitcnt vmcnt(15)
    v_mfma_f32_32x32x16_bf16 v[16:31], a[192:195], v[64:67], v[16:31]
    s_waitcnt vmcnt(14)
    v_mfma_f32_32x32x16_bf16 v[16:31], a[196:199], v[68:71], v[16:31]
    s_waitcnt vmcnt(13)
    v_mfma_f32_32x32x16_bf16 v[16:31], a[200:203], v[72:75], v[16:31]
    s_waitcnt vmcnt(12)
    v_mfma_f32_32x32x16_bf16 v[16:31], a[204:207], v[76:79], v[16:31]
    s_waitcnt vmcnt(11)
    v_mfma_f32_32x32x16_bf16 v[16:31], a[208:211], v[80:83], v[16:31]
    s_waitcnt vmcnt(10)
    v_mfma_f32_32x32x16_bf16 v[16:31], a[212:215], v[84:87], v[16:31]
    s_waitcnt vmcnt(9)
    v_mfma_f32_32x32x16_bf16 v[16:31], a[216:219], v[88:91], v[16:31]
    s_waitcnt vmcnt(8)
    v_mfma_f32_32x32x16_bf16 v[16:31], a[220:223], v[92:95], v[16:31]
    s_waitcnt vmcnt(7)
    v_mfma_f32_32x32x16_bf16 v[16:31], a[224:227], v[96:99], v[16:31]
    s_waitcnt vmcnt(6)
    v_mfma_f32_32x32x16_bf16 v[16:31], a[228:231], v[100:103], v[16:31]
    s_waitcnt vmcnt(5)
    v_mfma_f32_32x32x16_bf16 v[16:31], a[232:235], v[104:107], v[16:31]
    s_waitcnt vmcnt(4)
    v_mfma_f32_32x32x16_bf16 v[16:31], a[236:239], v[108:111], v[16:31]
    s_waitcnt vmcnt(3)
    v_mfma_f32_32x32x16_bf16 v[16:31], a[240:243], v[112:115], v[16:31]
    s_waitcnt vmcnt(2)
    v_mfma_f32_32x32x16_bf16 v[16:31], a[244:247], v[116:119], v[16:31]
    s_waitcnt vmcnt(1)
    v_mfma_f32_32x32x16_bf16 v[16:31], a[248:251], v[120:123], v[16:31]
    s_waitcnt vmcnt(0)
    v_mfma_f32_32x32x16_bf16 v[16:31], a[252:255], v[124:127], v[16:31]
    s_nop 11
    ds_write_b128 v6, v[16:19] offset:0
    ds_write_b128 v6, v[20:23] offset:1024
    ds_write_b128 v6, v[24:27] offset:2048
    ds_write_b128 v6, v[28:31] offset:3072
    s_waitcnt lgkmcnt(0)
    s_barrier
    ds_read_b128 v[32:35], v7 offset:0
    ds_read_b128 v[36:39], v7 offset:4096
    ds_read_b128 v[40:43], v7 offset:8192
    ds_read_b128 v[44:47], v7 offset:12288
    s_waitcnt lgkmcnt(0)
    s_barrier
    v_pk_add_f32 v[32:33], v[32:33], v[36:37]
    v_pk_add_f32 v[34:35], v[34:35], v[38:39]
    v_pk_add_f32 v[40:41], v[40:41], v[44:45]
    v_pk_add_f32 v[42:43], v[42:43], v[46:47]
    v_pk_add_f32 v[32:33], v[32:33], v[40:41]
    v_pk_add_f32 v[34:35], v[34:35], v[42:43]
    v_cvt_pk_bf16_f32 v36, v32, v33
    v_lshlrev_b32 v10, 16, v12
    v_and_b32 v11, 0xffff0000, v12
    v_lshlrev_b32 v38, 16, v36
    v_and_b32 v39, 0xffff0000, v36
    v_add_f32 v10, v10, v38
    v_add_f32 v11, v11, v39
    v_cvt_pk_bf16_f32 v36, v10, v11
    v_lshlrev_b32 v10, 16, v14
    v_and_b32 v11, 0xffff0000, v14
    v_lshlrev_b32 v38, 16, v36
    v_and_b32 v39, 0xffff0000, v36
    v_add_f32 v10, v10, v38
    v_add_f32 v11, v11, v39
    v_cvt_pk_bf16_f32 v36, v10, v11
    v_cvt_pk_bf16_f32 v37, v34, v35
    v_lshlrev_b32 v10, 16, v13
    v_and_b32 v11, 0xffff0000, v13
    v_lshlrev_b32 v38, 16, v37
    v_and_b32 v39, 0xffff0000, v37
    v_add_f32 v10, v10, v38
    v_add_f32 v11, v11, v39
    v_cvt_pk_bf16_f32 v37, v10, v11
    v_lshlrev_b32 v10, 16, v15
    v_and_b32 v11, 0xffff0000, v15
    v_lshlrev_b32 v38, 16, v37
    v_and_b32 v39, 0xffff0000, v37
    v_add_f32 v10, v10, v38
    v_add_f32 v11, v11, v39
    v_cvt_pk_bf16_f32 v37, v10, v11
    buffer_store_dwordx2 v[36:37], v4, s[32:35], s45 offen
    s_add_u32 s40, s40, 2
    s_cmp_lt_u32 s40, 63
    s_cbranch_scc1 eng_loop
    s_branch ub_done
ub_at:
    s_lshl_b32 s40, s51, 2
    s_lshr_b32 s24, s5, 3
    s_add_u32 s40, s40, s24
    s_and_b32 s41, s5, 7
    s_lshl_b32 s41, s41, 2
    s_add_u32 s41, s41, s3
    s_lshl_b32 s42, s40, 5
    s_add_u32 s42, s42, s41
    s_lshl_b32 s16, s42, 13
    s_add_u32 s16, s16, 4194304
    s_lshl_b32 s17, s42, 12
    s_add_u32 s17, s17, 117440512
    s_mul_i32 s18, s40, 491520
    s_lshl_b32 s19, s41, 13
    s_add_u32 s18, s18, s19
    s_add_u32 s18, s18, 54525952
    s_lshl_b32 s58, s51, 7
    s_add_u32 s58, s58, 105912320
    s_cmp_ge_u32 s51, 4
    s_cbranch_scc1 ub_nopf
    s_mov_b32 s12, s52
    s_and_b32 s13, s53, 0xffff
    s_mov_b32 s14, 0x700000
    s_mov_b32 s15, 0x20000
    s_lshl_b32 s24, s51, 5
    s_add_u32 s24, s24, s5
    s_lshl_b32 s24, s24, 16
    v_lshlrev_b32 v1, 7, v0
    buffer_load_dword v2, v1, s[12:15], s24 offen
    s_add_u32 s24, s24, 0x8000
    buffer_load_dword v3, v1, s[12:15], s24 offen
    s_waitcnt vmcnt(0)
ub_nopf:
    v_and_b32 v9, 63, v0
    v_lshlrev_b32 v1, 4, v9
    v_and_b32 v10, 0x33, v9
    v_bfe_u32 v11, v9, 2, 1
    v_lshl_add_u32 v10, v11, 3, v10
    v_bfe_u32 v11, v9, 3, 1
    v_lshl_add_u32 v10, v11, 2, v10
    v_lshlrev_b32 v2, 4, v10
    v_and_b32 v10, 7, v9
    v_lshlrev_b32 v10, 4, v10
    v_lshrrev_b32 v11, 5, v9
    v_lshl_add_u32 v3, v11, 8, v10
    v_add_u32 v3, 128, v3
    v_bfe_u32 v12, v9, 3, 2
    v_lshlrev_b32 v12, 5, v12
    v_and_b32 v10, 3, v9
    v_lshl_add_u32 v12, v10, 3, v12
    v_and_b32 v10, 4, v9
    v_add_u32 v12, v12, v10
    v_lshl_add_u32 v4, v11, 8, v12
    v_and_b32 v10, 31, v9
    v_lshlrev_b32 v11, 3, v11
    v_sub_u32 v5, v10, v11
    s_lshr_b32 s59, s40, 3
    s_lshl_b32 s59, s59, 7
    s_add_u32 s59, s59, 105907200
    v_lshlrev_b32 v11, 6, v1
    v_lshlrev_b32 v12, 2, v1
    v_sub_u32 v12, 0x80, v12
    s_mov_b64 exec, 3
at_poll:
    buffer_load_dword v10, v11, s[8:11], s59 offen sc1
    s_waitcnt vmcnt(0)
    v_cmp_lt_u32 vcc, v10, v12
    s_cbranch_vccz at_go
    s_sleep 16
    s_sub_u32 s95, s95, 1
    s_cbranch_scc0 at_poll
    s_mov_b32 s95, 0
at_go:
    s_mov_b64 exec, -1
    s_add_u32 s49, s40, 2
    s_cmp_ge_u32 s40, 60
    s_subb_u32 s49, s49, 0
    s_min_u32 s49, s49, 63
    s_mov_b32 s59, 105906176
    s_lshl_b32 s57, s40, 10
    s_and_b32 s24, s5, 7
    s_lshl_b32 s24, s24, 7
    s_add_u32 s57, s57, s24
    s_add_u32 s57, s57, 105897984
    s_cmp_ge_u32 s40, 48
    s_cselect_b32 s58, s57, s58
    s_add_u32 s24, s16, 4096
    buffer_load_dwordx4 v[16:19], v1, s[8:11], s16 offen offset:0 sc1
    buffer_load_dwordx4 v[20:23], v1, s[8:11], s16 offen offset:1024 sc1
    buffer_load_dwordx4 v[24:27], v1, s[8:11], s16 offen offset:2048 sc1
    buffer_load_dwordx4 v[28:31], v1, s[8:11], s16 offen offset:3072 sc1
    buffer_load_dwordx4 v[32:35], v1, s[8:11], s24 offen offset:0 sc1
    buffer_load_dwordx4 v[36:39], v1, s[8:11], s24 offen offset:1024 sc1
    buffer_load_dwordx4 v[40:43], v1, s[8:11], s24 offen offset:2048 sc1
    buffer_load_dwordx4 v[44:47], v1, s[8:11], s24 offen offset:3072 sc1
    s_add_u32 s25, s16, 16777216
    s_add_u32 s24, s25, 4096
    buffer_load_dwordx4 v[48:51], v2, s[8:11], s25 offen offset:0 sc1
    buffer_load_dwordx4 v[52:55], v2, s[8:11], s25 offen offset:1024 sc1
    buffer_load_dwordx4 v[56:59], v2, s[8:11], s25 offen offset:2048 sc1
    buffer_load_dwordx4 v[60:63], v2, s[8:11], s25 offen offset:3072 sc1
    buffer_load_dwordx4 v[64:67], v2, s[8:11], s24 offen offset:0 sc1
    buffer_load_dwordx4 v[68:71], v2, s[8:11], s24 offen offset:1024 sc1
    buffer_load_dwordx4 v[72:75], v2, s[8:11], s24 offen offset:2048 sc1
    buffer_load_dwordx4 v[76:79], v2, s[8:11], s24 offen offset:3072 sc1
    s_add_u32 s25, s16, 33554432
    s_add_u32 s24, s25, 4096
    buffer_load_dwordx4 v[80:83], v1, s[8:11], s25 offen offset:0 sc1
    buffer_load_dwordx4 v[84:87], v1, s[8:11], s25 offen offset:1024 sc1
    buffer_load_dwordx4 v[88:91], v1, s[8:11], s25 offen offset:2048 sc1
    buffer_load_dwordx4 v[92:95], v1, s[8:11], s25 offen offset:3072 sc1
    buffer_load_dwordx4 v[96:99], v1, s[8:11], s24 offen offset:0 sc1
    buffer_load_dwordx4 v[100:103], v1, s[8:11], s24 offen offset:1024 sc1
    buffer_load_dwordx4 v[104:107], v1, s[8:11], s24 offen offset:2048 sc1
    buffer_load_dwordx4 v[108:111], v1, s[8:11], s24 offen offset:3072 sc1
    s_waitcnt vmcnt(8)
    v_mfma_f32_32x32x16_bf16 v[152:167], v[48:51], v[16:19], 0
    v_mfma_f32_32x32x16_bf16 v[152:167], v[52:55], v[20:23], v[152:167]
    v_mfma_f32_32x32x16_bf16 v[152:167], v[56:59], v[24:27], v[152:167]
    v_mfma_f32_32x32x16_bf16 v[152:167], v[60:63], v[28:31], v[152:167]
    v_mfma_f32_32x32x16_bf16 v[152:167], v[64:67], v[32:35], v[152:167]
    v_mfma_f32_32x32x16_bf16 v[152:167], v[68:71], v[36:39], v[152:167]
    v_mfma_f32_32x32x16_bf16 v[152:167], v[72:75], v[40:43], v[152:167]
    v_mfma_f32_32x32x16_bf16 v[152:167], v[76:79], v[44:47], v[152:167]
wait_27:
    buffer_load_dword v10, off, s[8:11], s59 sc1
    s_waitcnt vmcnt(0)
    v_readfirstlane_b32 s24, v10
    s_cmp_ge_u32 s24, s49
    s_cbranch_scc1 waitok_28
    s_sleep 4
    s_sub_u32 s95, s95, 1
    s_cbranch_scc0 wait_27
    s_mov_b32 s95, 0
waitok_28:
    s_add_u32 s25, s17, 9437184
    buffer_load_dwordx4 v[112:115], v3, s[8:11], s17 offen offset:0 sc1
    buffer_load_dwordx4 v[116:119], v3, s[8:11], s17 offen offset:512 sc1
    buffer_load_dwordx4 v[120:123], v3, s[8:11], s17 offen offset:1024 sc1
    buffer_load_dwordx4 v[124:127], v3, s[8:11], s17 offen offset:1536 sc1
    buffer_load_dwordx4 v[128:131], v3, s[8:11], s17 offen offset:2048 sc1
    buffer_load_dwordx4 v[132:135], v3, s[8:11], s17 offen offset:2560 sc1
    buffer_load_dwordx4 v[136:139], v3, s[8:11], s17 offen offset:3072 sc1
    buffer_load_dwordx4 v[140:143], v3, s[8:11], s17 offen offset:3584 sc1
    buffer_load_dword v144, v4, s[8:11], s25 offen offset:0 sc1
    buffer_load_dword v145, v4, s[8:11], s25 offen offset:128 sc1
    buffer_load_dword v146, v4, s[8:11], s25 offen offset:1024 sc1
    buffer_load_dword v147, v4, s[8:11], s25 offen offset:1152 sc1
    buffer_load_dword v148, v4, s[8:11], s25 offen offset:2048 sc1
    buffer_load_dword v149, v4, s[8:11], s25 offen offset:2176 sc1
    buffer_load_dword v150, v4, s[8:11], s25 offen offset:3072 sc1
    buffer_load_dword v151, v4, s[8:11], s25 offen offset:3200 sc1
    s_mov_b32 s26, 0x3e0293ee
    v_mov_b32 v6, 0xff800000
    s_nop 2
    v_cmp_le_i32 vcc, 0, v5
    s_nop 1
    v_cndmask_b32 v152, v6, v152, vcc
    v_cmp_le_i32 vcc, 1, v5
    s_nop 1
    v_cndmask_b32 v153, v6, v153, vcc
    v_cmp_le_i32 vcc, 2, v5
    s_nop 1
    v_cndmask_b32 v154, v6, v154, vcc
    v_cmp_le_i32 vcc, 3, v5
    s_nop 1
    v_cndmask_b32 v155, v6, v155, vcc
    v_cmp_le_i32 vcc, 4, v5
    s_nop 1
    v_cndmask_b32 v156, v6, v156, vcc
    v_cmp_le_i32 vcc, 5, v5
    s_nop 1
    v_cndmask_b32 v157, v6, v157, vcc
    v_cmp_le_i32 vcc, 6, v5
    s_nop 1
    v_cndmask_b32 v158, v6, v158, vcc
    v_cmp_le_i32 vcc, 7, v5
    s_nop 1
    v_cndmask_b32 v159, v6, v159, vcc
    v_cmp_le_i32 vcc, 16, v5
    s_nop 1
    v_cndmask_b32 v160, v6, v160, vcc
    v_cmp_le_i32 vcc, 17, v5
    s_nop 1
    v_cndmask_b32 v161, v6, v161, vcc
    v_cmp_le_i32 vcc, 18, v5
    s_nop 1
    v_cndmask_b32 v162, v6, v162, vcc
    v_cmp_le_i32 vcc, 19, v5
    s_nop 1
    v_cndmask_b32 v163, v6, v163, vcc
    v_cmp_le_i32 vcc, 20, v5
    s_nop 1
    v_cndmask_b32 v164, v6, v164, vcc
    v_cmp_le_i32 vcc, 21, v5
    s_nop 1
    v_cndmask_b32 v165, v6, v165, vcc
    v_cmp_le_i32 vcc, 22, v5
    s_nop 1
    v_cndmask_b32 v166, v6, v166, vcc
    v_cmp_le_i32 vcc, 23, v5
    s_nop 1
    v_cndmask_b32 v167, v6, v167, vcc
    v_max3_f32 v7, v152, v153, v154
    v_max3_f32 v7, v7, v155, v156
    v_max3_f32 v7, v7, v157, v158
    v_max3_f32 v7, v7, v159, v160
    v_max3_f32 v7, v7, v161, v162
    v_max3_f32 v7, v7, v163, v164
    v_max3_f32 v7, v7, v165, v166
kmpoll_29:
    s_waitcnt vmcnt(0)
    v_mfma_f32_32x32x16_bf16 v[168:183], v[112:115], v[16:19], 0
    v_mfma_f32_32x32x16_bf16 v[168:183], v[116:119], v[20:23], v[168:183]
    v_mfma_f32_32x32x16_bf16 v[168:183], v[120:123], v[24:27], v[168:183]
    v_mfma_f32_32x32x16_bf16 v[168:183], v[124:127], v[28:31], v[168:183]
    v_mfma_f32_32x32x16_bf16 v[168:183], v[128:131], v[32:35], v[168:183]
    v_mfma_f32_32x32x16_bf16 v[168:183], v[132:135], v[36:39], v[168:183]
    v_mfma_f32_32x32x16_bf16 v[168:183], v[136:139], v[40:43], v[168:183]
    v_mfma_f32_32x32x16_bf16 v[168:183], v[140:143], v[44:47], v[168:183]
    v_max3_u32 v8, v112, v113, v114
    v_max3_u32 v8, v8, v115, v116
    v_max3_u32 v8, v8, v117, v118
    v_max3_u32 v8, v8, v119, v120
    v_max3_u32 v8, v8, v121, v122
    v_max3_u32 v8, v8, v123, v124
    v_max3_u32 v8, v8, v125, v126
    v_max3_u32 v8, v8, v127, v128
    v_max3_u32 v8, v8, v129, v130
    v_max3_u32 v8, v8, v131, v132
    v_max3_u32 v8, v8, v133, v134
    v_max3_u32 v8, v8, v135, v136
    v_max3_u32 v8, v8, v137, v138
    v_max3_u32 v8, v8, v139, v140
    v_max3_u32 v8, v8, v141, v142
    v_max3_u32 v8, v8, v143, v144
    v_max3_u32 v8, v8, v145, v146
    v_max3_u32 v8, v8, v147, v148
    v_max3_u32 v8, v8, v149, v150
    v_max_u32 v8, v8, v151
    v_cmp_eq_u32 vcc, -1, v8
    s_cbranch_vccz kmok_30
    buffer_load_dwordx4 v[112:115], v3, s[8:11], s17 offen offset:0 sc1
    buffer_load_dwordx4 v[116:119], v3, s[8:11], s17 offen offset:512 sc1
    buffer_load_dwordx4 v[120:123], v3, s[8:11], s17 offen offset:1024 sc1
    buffer_load_dwordx4 v[124:127], v3, s[8:11], s17 offen offset:1536 sc1
    buffer_load_dwordx4 v[128:131], v3, s[8:11], s17 offen offset:2048 sc1
    buffer_load_dwordx4 v[132:135], v3, s[8:11], s17 offen offset:2560 sc1
    buffer_load_dwordx4 v[136:139], v3, s[8:11], s17 offen offset:3072 sc1
    buffer_load_dwordx4 v[140:143], v3, s[8:11], s17 offen offset:3584 sc1
    buffer_load_dword v144, v4, s[8:11], s25 offen offset:0 sc1
    buffer_load_dword v145, v4, s[8:11], s25 offen offset:128 sc1
    buffer_load_dword v146, v4, s[8:11], s25 offen offset:1024 sc1
    buffer_load_dword v147, v4, s[8:11], s25 offen offset:1152 sc1
    buffer_load_dword v148, v4, s[8:11], s25 offen offset:2048 sc1
    buffer_load_dword v149, v4, s[8:11], s25 offen offset:2176 sc1
    buffer_load_dword v150, v4, s[8:11], s25 offen offset:3072 sc1
    buffer_load_dword v151, v4, s[8:11], s25 offen offset:3200 sc1
    s_sub_u32 s95, s95, 1
    s_cbranch_scc0 kmpoll_29
    s_mov_b32 s95, 0
    s_waitcnt vmcnt(0)
kmok_30:
    v_max3_f32 v7, v7, v167, v168
    v_max3_f32 v7, v7, v169, v170
    v_max_f32 v7, v7, v171
    v_mov_b32 v8, v7
    s_nop 1
    v_permlane32_swap_b32 v8, v7
    v_max_f32 v7, v7, v8
    v_mul_f32 v7, s26, v7
    v_fma_f32 v152, v152, s26, -v7
    v_fma_f32 v153, v153, s26, -v7
    v_fma_f32 v154, v154, s26, -v7
    v_fma_f32 v155, v155, s26, -v7
    v_fma_f32 v156, v156, s26, -v7
    v_fma_f32 v157, v157, s26, -v7
    v_fma_f32 v158, v158, s26, -v7
    v_fma_f32 v159, v159, s26, -v7
    v_fma_f32 v160, v160, s26, -v7
    v_fma_f32 v161, v161, s26, -v7
    v_fma_f32 v162, v162, s26, -v7
    v_fma_f32 v163, v163, s26, -v7
    v_fma_f32 v164, v164, s26, -v7
    v_fma_f32 v165, v165, s26, -v7
    v_fma_f32 v166, v166, s26, -v7
    v_fma_f32 v167, v167, s26, -v7
    v_fma_f32 v168, v168, s26, -v7
    v_fma_f32 v169, v169, s26, -v7
    v_fma_f32 v170, v170, s26, -v7
    v_fma_f32 v171, v171, s26, -v7
    v_exp_f32 v152, v152
    v_exp_f32 v153, v153
    v_exp_f32 v154, v154
    v_exp_f32 v155, v155
    v_exp_f32 v156, v156
    v_exp_f32 v157, v157
    v_exp_f32 v158, v158
    v_exp_f32 v159, v159
    v_exp_f32 v160, v160
    v_exp_f32 v161, v161
    v_exp_f32 v162, v162
    v_exp_f32 v163, v163
    v_exp_f32 v164, v164
    v_exp_f32 v165, v165
    v_exp_f32 v166, v166
    v_exp_f32 v167, v167
    v_exp_f32 v168, v168
    v_exp_f32 v169, v169
    v_exp_f32 v170, v170
    v_exp_f32 v171, v171
    s_nop 0
    v_add_f32 v7, v152, v153
    v_add_f32 v7, v7, v154
    v_add_f32 v7, v7, v155
    v_add_f32 v7, v7, v156
    v_add_f32 v7, v7, v157
    v_add_f32 v7, v7, v158
    v_add_f32 v7, v7, v159
    v_add_f32 v7, v7, v160
    v_add_f32 v7, v7, v161
    v_add_f32 v7, v7, v162
    v_add_f32 v7, v7, v163
    v_add_f32 v7, v7, v164
    v_add_f32 v7, v7, v165
    v_add_f32 v7, v7, v166
    v_add_f32 v7, v7, v167
    v_add_f32 v7, v7, v168
    v_add_f32 v7, v7, v169
    v_add_f32 v7, v7, v170
    v_add_f32 v7, v7, v171
    v_mov_b32 v8, v7
    s_nop 1
    v_permlane32_swap_b32 v8, v7
    v_add_f32 v7, v7, v8
    v_rcp_f32 v7, v7
    s_nop 0
    v_mul_f32 v152, v152, v7
    v_mul_f32 v153, v153, v7
    v_mul_f32 v154, v154, v7
    v_mul_f32 v155, v155, v7
    v_mul_f32 v156, v156, v7
    v_mul_f32 v157, v157, v7
    v_mul_f32 v158, v158, v7
    v_mul_f32 v159, v159, v7
    v_mul_f32 v160, v160, v7
    v_mul_f32 v161, v161, v7
    v_mul_f32 v162, v162, v7
    v_mul_f32 v163, v163, v7
    v_mul_f32 v164, v164, v7
    v_mul_f32 v165, v165, v7
    v_mul_f32 v166, v166, v7
    v_mul_f32 v167, v167, v7
    v_mul_f32 v168, v168, v7
    v_mul_f32 v169, v169, v7
    v_mul_f32 v170, v170, v7
    v_mul_f32 v171, v171, v7
    v_cvt_pk_bf16_f32 v16, v152, v153
    v_cvt_pk_bf16_f32 v17, v154, v155
    v_cvt_pk_bf16_f32 v18, v156, v157
    v_cvt_pk_bf16_f32 v19, v158, v159
    v_cvt_pk_bf16_f32 v20, v160, v161
    v_cvt_pk_bf16_f32 v21, v162, v163
    v_cvt_pk_bf16_f32 v22, v164, v165
    v_cvt_pk_bf16_f32 v23, v166, v167
    v_cvt_pk_bf16_f32 v24, v168, v169
    v_cvt_pk_bf16_f32 v25, v170, v171
    s_waitcnt vmcnt(0)
    s_nop 1
    v_mfma_f32_32x32x8_bf16 v[48:63], v[144:145], v[24:25], 0
    v_mfma_f32_32x32x8_bf16 v[64:79], v[146:147], v[24:25], 0
    v_mfma_f32_32x32x8_bf16 v[112:127], v[148:149], v[24:25], 0
    v_mfma_f32_32x32x8_bf16 v[128:143], v[150:151], v[24:25], 0
    s_nop 7
    v_mfma_f32_32x32x16_bf16 v[48:63], v[80:83], v[16:19], v[48:63]
    v_mfma_f32_32x32x16_bf16 v[48:63], v[84:87], v[20:23], v[48:63]
    v_mfma_f32_32x32x16_bf16 v[64:79], v[88:91], v[16:19], v[64:79]
    v_mfma_f32_32x32x16_bf16 v[64:79], v[92:95], v[20:23], v[64:79]
    v_mfma_f32_32x32x16_bf16 v[112:127], v[96:99], v[16:19], v[112:127]
    v_mfma_f32_32x32x16_bf16 v[112:127], v[100:103], v[20:23], v[112:127]
    v_mfma_f32_32x32x16_bf16 v[128:143], v[104:107], v[16:19], v[128:143]
    v_mfma_f32_32x32x16_bf16 v[128:143], v[108:111], v[20:23], v[128:143]
    s_nop 7
    s_add_u32 s24, s18, 4096
    v_cvt_pk_bf16_f32 v152, v48, v49
    v_cvt_pk_bf16_f32 v153, v50, v51
    v_cvt_pk_bf16_f32 v154, v52, v53
    v_cvt_pk_bf16_f32 v155, v54, v55
    v_cvt_pk_bf16_f32 v156, v56, v57
    v_cvt_pk_bf16_f32 v157, v58, v59
    v_cvt_pk_bf16_f32 v158, v60, v61
    v_cvt_pk_bf16_f32 v159, v62, v63
    s_nop 0
    v_permlane32_swap_b32 v152, v154
    v_permlane32_swap_b32 v153, v155
    v_permlane32_swap_b32 v156, v158
    v_permlane32_swap_b32 v157, v159
    buffer_store_dwordx4 v[152:155], v1, s[8:11], s18 offen offset:0 sc1
    buffer_store_dwordx4 v[156:159], v1, s[8:11], s18 offen offset:1024 sc1
    v_cvt_pk_bf16_f32 v160, v64, v65
    v_cvt_pk_bf16_f32 v161, v66, v67
    v_cvt_pk_bf16_f32 v162, v68, v69
    v_cvt_pk_bf16_f32 v163, v70, v71
    v_cvt_pk_bf16_f32 v164, v72, v73
    v_cvt_pk_bf16_f32 v165, v74, v75
    v_cvt_pk_bf16_f32 v166, v76, v77
    v_cvt_pk_bf16_f32 v167, v78, v79
    s_nop 0
    v_permlane32_swap_b32 v160, v162
    v_permlane32_swap_b32 v161, v163
    v_permlane32_swap_b32 v164, v166
    v_permlane32_swap_b32 v165, v167
    buffer_store_dwordx4 v[160:163], v1, s[8:11], s18 offen offset:2048 sc1
    buffer_store_dwordx4 v[164:167], v1, s[8:11], s18 offen offset:3072 sc1
    v_cvt_pk_bf16_f32 v152, v112, v113
    v_cvt_pk_bf16_f32 v153, v114, v115
    v_cvt_pk_bf16_f32 v154, v116, v117
    v_cvt_pk_bf16_f32 v155, v118, v119
    v_cvt_pk_bf16_f32 v156, v120, v121
    v_cvt_pk_bf16_f32 v157, v122, v123
    v_cvt_pk_bf16_f32 v158, v124, v125
    v_cvt_pk_bf16_f32 v159, v126, v127
    s_nop 0
    v_permlane32_swap_b32 v152, v154
    v_permlane32_swap_b32 v153, v155
    v_permlane32_swap_b32 v156, v158
    v_permlane32_swap_b32 v157, v159
    buffer_store_dwordx4 v[152:155], v1, s[8:11], s24 offen offset:0 sc1
    buffer_store_dwordx4 v[156:159], v1, s[8:11], s24 offen offset:1024 sc1
    s_nop 3
    v_cvt_pk_bf16_f32 v160, v128, v129
    v_cvt_pk_bf16_f32 v161, v130, v131
    v_cvt_pk_bf16_f32 v162, v132, v133
    v_cvt_pk_bf16_f32 v163, v134, v135
    v_cvt_pk_bf16_f32 v164, v136, v137
    v_cvt_pk_bf16_f32 v165, v138, v139
    v_cvt_pk_bf16_f32 v166, v140, v141
    v_cvt_pk_bf16_f32 v167, v142, v143
    s_nop 0
    v_permlane32_swap_b32 v160, v162
    v_permlane32_swap_b32 v161, v163
    v_permlane32_swap_b32 v164, v166
    v_permlane32_swap_b32 v165, v167
    buffer_store_dwordx4 v[160:163], v1, s[8:11], s24 offen offset:2048 sc1
    buffer_store_dwordx4 v[164:167], v1, s[8:11], s24 offen offset:3072 sc1
    s_waitcnt vmcnt(0)
    s_barrier
    s_cmp_lg_u32 s3, 0
    s_cbranch_scc1 ub_next
    v_mov_b32 v10, 1
    s_mov_b64 exec, 1
    buffer_atomic_add v10, off, s[8:11], s58
    s_mov_b64 exec, -1
    s_branch ub_next
ub_rec:
    s_mov_b32 s4, s5
    s_mov_b32 s40, s94
    s_mov_b32 s6, 0
    s_load_dwordx4 s[28:31], s[0:1], 16
    s_load_dwordx4 s[32:35], s[0:1], 32
    s_lshr_b32 s41, s4, 1
    s_and_b32 s42, s4, 1
    s_lshl_b32 s43, s41, 1
    s_add_u32 s43, s43, s40
    s_lshl_b32 s5, s40, 5
    s_add_u32 s5, s5, s4
    s_lshl_b32 s54, s40, 4
    s_add_u32 s54, s54, s41
    s_mov_b32 s92, 0
    s_lshr_b32 s7, s3, 1
    s_cmp_eq_u32 s7, s42
    s_cselect_b32 s58, 0x00ff00ff, 0
    s_mov_b32 s36, 0xff00ff00
    s_cselect_b32 s38, -1, 0
    s_cselect_b32 s93, 1, 0
    s_mov_b32 s59, s58
    s_mov_b32 s39, s38
    s_mov_b32 s37, s36
    s_mov_b32 s45, 0x200000
    s_mov_b32 s56, 0x00ff00ff
    s_mov_b32 s57, 0x00ff00ff
    s_mov_b32 s55, 0x3e0293ee
    v_and_b32 v31, 63, v0
    v_and_b32 v48, 15, v31
    v_lshrrev_b32 v49, 4, v31
    v_lshlrev_b32 v2, 4, v31
    v_mov_b32 v1, 0x44444444
    v_mov_b32 v30, 0xeeeeeeee
    v_cmp_lt_u32 vcc, 7, v48
    s_nop 1
    v_cndmask_b32 v1, v1, v30, vcc
    v_lshrrev_b32 v50, 1, v49
    v_lshlrev_b32 v50, 3, v50
    v_sub_u32 v50, v48, v50
    v_mov_b32 v4, 0
    v_cmp_eq_u32 vcc, 0, v50
    v_mov_b32 v30, 0x3f80
    s_nop 0
    v_cndmask_b32 v4, v4, v30, vcc
    v_cmp_eq_u32 vcc, 1, v50
    v_mov_b32 v30, 0x3f800000
    s_nop 0
    v_cndmask_b32 v4, v4, v30, vcc
    v_mov_b32 v5, 0
    v_cmp_eq_u32 vcc, 2, v50
    v_mov_b32 v30, 0x3f80
    s_nop 0
    v_cndmask_b32 v5, v5, v30, vcc
    v_cmp_eq_u32 vcc, 3, v50
    v_mov_b32 v30, 0x3f800000
    s_nop 0
    v_cndmask_b32 v5, v5, v30, vcc
    v_mov_b32 v6, 0
    v_cmp_eq_u32 vcc, 4, v50
    v_mov_b32 v30, 0x3f80
    s_nop 0
    v_cndmask_b32 v6, v6, v30, vcc
    v_cmp_eq_u32 vcc, 5, v50
    v_mov_b32 v30, 0x3f800000
    s_nop 0
    v_cndmask_b32 v6, v6, v30, vcc
    v_mov_b32 v7, 0
    v_cmp_eq_u32 vcc, 6, v50
    v_mov_b32 v30, 0x3f80
    s_nop 0
    v_cndmask_b32 v7, v7, v30, vcc
    v_cmp_eq_u32 vcc, 7, v50
    v_mov_b32 v30, 0x3f800000
    s_nop 0
    v_cndmask_b32 v7, v7, v30, vcc
    v_lshlrev_b32 v50, 2, v49
    v_sub_u32 v50, v48, v50
    v_mov_b32 v8, 0
    v_cmp_eq_u32 vcc, 0, v50
    v_mov_b32 v30, 0x3f80
    s_nop 0
    v_cndmask_b32 v8, v8, v30, vcc
    v_cmp_eq_u32 vcc, 1, v50
    v_mov_b32 v30, 0x3f800000
    s_nop 0
    v_cndmask_b32 v8, v8, v30, vcc
    v_mov_b32 v9, 0
    v_cmp_eq_u32 vcc, 2, v50
    v_mov_b32 v30, 0x3f80
    s_nop 0
    v_cndmask_b32 v9, v9, v30, vcc
    v_cmp_eq_u32 vcc, 3, v50
    v_mov_b32 v30, 0x3f800000
    s_nop 0
    v_cndmask_b32 v9, v9, v30, vcc
    v_mov_b32 v10, 0
    v_cmp_eq_u32 vcc, 4, v50
    v_mov_b32 v30, 0x3f80
    s_nop 0
    v_cndmask_b32 v10, v10, v30, vcc
    v_cmp_eq_u32 vcc, 5, v50
    v_mov_b32 v30, 0x3f800000
    s_nop 0
    v_cndmask_b32 v10, v10, v30, vcc
    v_mov_b32 v11, 0
    v_cmp_eq_u32 vcc, 6, v50
    v_mov_b32 v30, 0x3f80
    s_nop 0
    v_cndmask_b32 v11, v11, v30, vcc
    v_cmp_eq_u32 vcc, 7, v50
    v_mov_b32 v30, 0x3f800000
    s_nop 0
    v_cndmask_b32 v11, v11, v30, vcc
    v_mov_b32 v10, v8
    v_mov_b32 v11, v9
    v_bfe_u32 v50, v48, 3, 1
    v_and_b32 v51, 2, v48
    v_or_b32 v50, v50, v51
    v_xor_b32 v50, v50, v49
    v_lshlrev_b32 v50, 4, v50
    v_bfe_u32 v51, v48, 2, 1
    v_lshl_add_u32 v50, v51, 1, v50
    v_and_b32 v51, 1, v48
    v_add_u32 v50, v50, v51
    v_mov_b32 v12, 0
    v_cmp_eq_u32 vcc, 0, v50
    v_mov_b32 v30, 0x3f80
    s_nop 0
    v_cndmask_b32 v12, v12, v30, vcc
    v_cmp_eq_u32 vcc, 1, v50
    v_mov_b32 v30, 0x3f800000
    s_nop 0
    v_cndmask_b32 v12, v12, v30, vcc
    v_mov_b32 v13, 0
    v_cmp_eq_u32 vcc, 2, v50
    v_mov_b32 v30, 0x3f80
    s_nop 0
    v_cndmask_b32 v13, v13, v30, vcc
    v_cmp_eq_u32 vcc, 3, v50
    v_mov_b32 v30, 0x3f800000
    s_nop 0
    v_cndmask_b32 v13, v13, v30, vcc
    v_mov_b32 v14, 0
    v_cmp_eq_u32 vcc, 4, v50
    v_mov_b32 v30, 0x3f80
    s_nop 0
    v_cndmask_b32 v14, v14, v30, vcc
    v_cmp_eq_u32 vcc, 5, v50
    v_mov_b32 v30, 0x3f800000
    s_nop 0
    v_cndmask_b32 v14, v14, v30, vcc
    v_mov_b32 v15, 0
    v_cmp_eq_u32 vcc, 6, v50
    v_mov_b32 v30, 0x3f80
    s_nop 0
    v_cndmask_b32 v15, v15, v30, vcc
    v_cmp_eq_u32 vcc, 7, v50
    v_mov_b32 v30, 0x3f800000
    s_nop 0
    v_cndmask_b32 v15, v15, v30, vcc
    v_mov_b32 v14, v12
    v_mov_b32 v15, v13
    v_lshrrev_b32 v50, 1, v49
    v_lshlrev_b32 v50, 8, v50
    v_lshl_add_u32 v50, v48, 4, v50
    v_and_b32 v51, 1, v49
    v_mov_b32 v3, v50
    v_lshlrev_b32 v50, 9, v49
    v_lshl_add_u32 v16, v48, 4, v50
    v_lshrrev_b32 v51, 2, v48
    v_lshlrev_b32 v51, 3, v51
    v_and_b32 v52, 3, v48
    v_add_u32 v51, v51, v52
    s_lshl_b32 s24, s3, 11
    v_lshl_add_u32 v52, v51, 4, v50
    v_add_u32 v18, s24, v52
    v_and_b32 v52, 7, v48
    v_bfe_u32 v53, v48, 3, 1
    v_lshlrev_b32 v54, 7, v49
    v_lshl_add_u32 v54, v52, 4, v54
    s_lshl_b32 s24, s3, 10
    s_add_u32 s24, s24, 139264
    v_add_u32 v19, s24, v54
    v_lshl_add_u32 v28, v53, 9, v54
    v_add_u32 v28, 139264, v28
    v_lshlrev_b32 v17, 10, v49
    v_lshl_add_u32 v17, v52, 4, v17
    v_lshlrev_b32 v55, 5, v52
    v_and_b32 v56, 1, v49
    v_lshl_add_u32 v55, v56, 4, v55
    s_lshl_b32 s24, s3, 8
    s_add_u32 s24, s24, 143360
    v_add_u32 v24, s24, v55
    v_add_u32 v56, 152576, v55
    v_cmp_gt_u32 vcc, 2, v49
    s_nop 1
    v_cndmask_b32 v24, v24, v56, vcc
    v_lshlrev_b32 v55, 5, v52
    v_lshl_add_u32 v55, v49, 3, v55
    v_lshl_add_u32 v55, v53, 2, v55
    v_add_u32 v0, 143360, v55
    s_lshl_b32 s24, s3, 14
    v_add_u32 v25, s24, v2
    v_add_u32 v27, 0x10000, v25
    s_lshl_b32 s24, s3, 11
    s_add_u32 s24, s24, 131072
    v_add_u32 v26, s24, v2
    s_xor_b32 s24, s40, 1
    s_lshl_b32 s24, s24, 1
    s_add_u32 s24, s24, s42
    s_lshl_b32 s24, s24, 15
    s_lshr_b32 s25, s3, 1
    s_lshl_b32 s25, s25, 14
    s_add_u32 s24, s24, s25
    s_and_b32 s25, s3, 1
    s_lshl_b32 s25, s25, 12
    s_add_u32 s24, s24, s25
    s_add_u32 s46, s24, 100663296
    s_and_b32 s25, s3, 1
    s_lshl_b32 s24, s40, 1
    s_add_u32 s24, s24, s42
    s_lshl_b32 s24, s24, 15
    s_lshl_b32 s25, s25, 10
    s_add_u32 s24, s24, s25
    s_bfe_u32 s25, s41, 0x10002
    s_lshl_b32 s25, s25, 14
    s_add_u32 s24, s24, s25
    s_and_b32 s25, s41, 3
    s_lshl_b32 s25, s25, 11
    s_add_u32 s24, s24, s25
    s_lshr_b32 s25, s41, 3
    s_lshl_b32 s25, s25, 9
    s_add_u32 s24, s24, s25
    s_add_u32 s51, s24, 100663296
    s_mul_i32 s24, s5, 6144
    s_mul_i32 s25, s3, 1536
    s_add_u32 s24, s24, s25
    s_add_u32 s47, s24, 101187584
    s_xor_b32 s24, s5, 1
    s_mul_i32 s24, s24, 6144
    s_add_u32 s24, s24, s25
    s_add_u32 s48, s24, 101187584
    s_lshr_b32 s24, s54, 1
    s_lshl_b32 s24, s24, 12
    s_and_b32 s25, s54, 1
    s_lshl_b32 s25, s25, 9
    s_add_u32 s24, s24, s25
    s_lshl_b32 s25, s3, 7
    s_add_u32 s24, s24, s25
    s_add_u32 s49, s24, 101974016
    s_lshr_b32 s24, s54, 3
    s_lshl_b32 s24, s24, 2
    s_add_u32 s24, s24, s3
    s_lshl_b32 s24, s24, 12
    s_add_u32 s50, s24, 101974016
    s_lshl_b32 s24, s43, 13
    s_add_u32 s52, s24, 20971520
    s_add_u32 s61, s24, 37748736
    s_lshl_b32 s24, s43, 12
    s_lshl_b32 s25, s3, 10
    s_add_u32 s24, s24, s25
    s_add_u32 s53, s24, 117309440
    s_cmp_eq_u32 s93, 0
    s_cselect_b32 s24, 0, 9437184
    s_add_u32 s53, s53, s24
    s_waitcnt lgkmcnt(0)
    v_lshlrev_b32 v32, 13, v49
    v_lshl_add_u32 v32, v48, 4, v32
    v_lshrrev_b32 v33, 3, v31
    v_lshlrev_b32 v33, 11, v33
    v_and_b32 v50, 7, v31
    v_lshl_add_u32 v33, v50, 4, v33
    v_and_b32 v51, 3, v48
    v_lshlrev_b32 v53, 2, v49
    v_bfe_u32 v54, v48, 2, 1
    v_add_u32 v53, v53, v54
    v_bfe_u32 v54, v48, 3, 1
    v_lshl_add_u32 v53, v54, 5, v53
    v_lshlrev_b32 v54, 4, v51
    s_lshl_b32 s24, s3, 14
    v_add_u32 v54, s24, v54
    v_lshl_add_u32 v35, v53, 7, v54
    v_lshl_add_u32 v34, v53, 8, v54
    s_lshl_b32 s25, s3, 6
    v_add_u32 v34, s25, v34
    s_lshl_b32 s25, s42, 22
    s_lshl_b32 s26, s43, 8
    s_add_u32 s25, s25, s26
    s_lshl_b32 s26, s3, 20
    s_add_u32 s25, s25, s26
    s_lshr_b32 s26, s41, 3
    s_lshl_b32 s26, s26, 22
    s_lshl_b32 s27, s3, 20
    s_add_u32 s26, s26, s27
    s_lshl_b32 s27, s40, 18
    s_add_u32 s26, s26, s27
    s_lshl_b32 s27, s42, 10
    s_add_u32 s26, s26, s27
    s_and_b32 s27, s41, 7
    s_lshl_b32 s27, s27, 7
    s_add_u32 s26, s26, s27
    s_mov_b32 s12, s28
    s_and_b32 s13, s29, 0xffff
    s_mov_b32 s14, 0x800000
    s_mov_b32 s15, 0x20000
    s_add_u32 m0, s24, 0
    s_add_u32 s27, s25, 0
    buffer_load_dwordx4 v32, s[12:15], s27 offen lds
    s_add_u32 m0, s24, 1024
    s_add_u32 s27, s25, 32768
    buffer_load_dwordx4 v32, s[12:15], s27 offen lds
    s_add_u32 m0, s24, 2048
    s_add_u32 s27, s25, 65536
    buffer_load_dwordx4 v32, s[12:15], s27 offen lds
    s_add_u32 m0, s24, 3072
    s_add_u32 s27, s25, 98304
    buffer_load_dwordx4 v32, s[12:15], s27 offen lds
    s_add_u32 m0, s24, 4096
    s_add_u32 s27, s25, 131072
    buffer_load_dwordx4 v32, s[12:15], s27 offen lds
    s_add_u32 m0, s24, 5120
    s_add_u32 s27, s25, 163840
    buffer_load_dwordx4 v32, s[12:15], s27 offen lds
    s_add_u32 m0, s24, 6144
    s_add_u32 s27, s25, 196608
    buffer_load_dwordx4 v32, s[12:15], s27 offen lds
    s_add_u32 m0, s24, 7168
    s_add_u32 s27, s25, 229376
    buffer_load_dwordx4 v32, s[12:15], s27 offen lds
    s_add_u32 m0, s24, 8192
    s_add_u32 s27, s25, 262144
    buffer_load_dwordx4 v32, s[12:15], s27 offen lds
    s_add_u32 m0, s24, 9216
    s_add_u32 s27, s25, 294912
    buffer_load_dwordx4 v32, s[12:15], s27 offen lds
    s_add_u32 m0, s24, 10240
    s_add_u32 s27, s25, 327680
    buffer_load_dwordx4 v32, s[12:15], s27 offen lds
    s_add_u32 m0, s24, 11264
    s_add_u32 s27, s25, 360448
    buffer_load_dwordx4 v32, s[12:15], s27 offen lds
    s_add_u32 m0, s24, 12288
    s_add_u32 s27, s25, 393216
    buffer_load_dwordx4 v32, s[12:15], s27 offen lds
    s_add_u32 m0, s24, 13312
    s_add_u32 s27, s25, 425984
    buffer_load_dwordx4 v32, s[12:15], s27 offen lds
    s_add_u32 m0, s24, 14336
    s_add_u32 s27, s25, 458752
    buffer_load_dwordx4 v32, s[12:15], s27 offen lds
    s_add_u32 m0, s24, 15360
    s_add_u32 s27, s25, 491520
    buffer_load_dwordx4 v32, s[12:15], s27 offen lds
    s_add_u32 m0, s24, 65536
    s_add_u32 s27, s25, 524288
    buffer_load_dwordx4 v32, s[12:15], s27 offen lds
    s_add_u32 m0, s24, 66560
    s_add_u32 s27, s25, 557056
    buffer_load_dwordx4 v32, s[12:15], s27 offen lds
    s_add_u32 m0, s24, 67584
    s_add_u32 s27, s25, 589824
    buffer_load_dwordx4 v32, s[12:15], s27 offen lds
    s_add_u32 m0, s24, 68608
    s_add_u32 s27, s25, 622592
    buffer_load_dwordx4 v32, s[12:15], s27 offen lds
    s_add_u32 m0, s24, 69632
    s_add_u32 s27, s25, 655360
    buffer_load_dwordx4 v32, s[12:15], s27 offen lds
    s_add_u32 m0, s24, 70656
    s_add_u32 s27, s25, 688128
    buffer_load_dwordx4 v32, s[12:15], s27 offen lds
    s_add_u32 m0, s24, 71680
    s_add_u32 s27, s25, 720896
    buffer_load_dwordx4 v32, s[12:15], s27 offen lds
    s_add_u32 m0, s24, 72704
    s_add_u32 s27, s25, 753664
    buffer_load_dwordx4 v32, s[12:15], s27 offen lds
    s_add_u32 m0, s24, 73728
    s_add_u32 s27, s25, 786432
    buffer_load_dwordx4 v32, s[12:15], s27 offen lds
    s_add_u32 m0, s24, 74752
    s_add_u32 s27, s25, 819200
    buffer_load_dwordx4 v32, s[12:15], s27 offen lds
    s_add_u32 m0, s24, 75776
    s_add_u32 s27, s25, 851968
    buffer_load_dwordx4 v32, s[12:15], s27 offen lds
    s_add_u32 m0, s24, 76800
    s_add_u32 s27, s25, 884736
    buffer_load_dwordx4 v32, s[12:15], s27 offen lds
    s_add_u32 m0, s24, 77824
    s_add_u32 s27, s25, 917504
    buffer_load_dwordx4 v32, s[12:15], s27 offen lds
    s_add_u32 m0, s24, 78848
    s_add_u32 s27, s25, 950272
    buffer_load_dwordx4 v32, s[12:15], s27 offen lds
    s_add_u32 m0, s24, 79872
    s_add_u32 s27, s25, 983040
    buffer_load_dwordx4 v32, s[12:15], s27 offen lds
    s_add_u32 m0, s24, 80896
    s_add_u32 s27, s25, 1015808
    buffer_load_dwordx4 v32, s[12:15], s27 offen lds
    s_waitcnt vmcnt(16)
    s_barrier
    v_xor_b32 v36, 0, v34
    ds_read_b64_tr_b16 a[0:1], v36 offset:0
    ds_read_b64_tr_b16 a[2:3], v36 offset:512
    ds_read_b64_tr_b16 a[4:5], v36 offset:4096
    ds_read_b64_tr_b16 a[6:7], v36 offset:4608
    ds_read_b64_tr_b16 a[128:129], v36 offset:8
    ds_read_b64_tr_b16 a[130:131], v36 offset:520
    ds_read_b64_tr_b16 a[132:133], v36 offset:4104
    ds_read_b64_tr_b16 a[134:135], v36 offset:4616
    s_waitcnt lgkmcnt(0)
    v_xor_b32 v36, 16384, v34
    ds_read_b64_tr_b16 a[16:17], v36 offset:0
    ds_read_b64_tr_b16 a[18:19], v36 offset:512
    ds_read_b64_tr_b16 a[20:21], v36 offset:4096
    ds_read_b64_tr_b16 a[22:23], v36 offset:4608
    ds_read_b64_tr_b16 a[144:145], v36 offset:8
    ds_read_b64_tr_b16 a[146:147], v36 offset:520
    ds_read_b64_tr_b16 a[148:149], v36 offset:4104
    ds_read_b64_tr_b16 a[150:151], v36 offset:4616
    s_waitcnt lgkmcnt(0)
    v_xor_b32 v36, 32768, v34
    ds_read_b64_tr_b16 a[32:33], v36 offset:0
    ds_read_b64_tr_b16 a[34:35], v36 offset:512
    ds_read_b64_tr_b16 a[36:37], v36 offset:4096
    ds_read_b64_tr_b16 a[38:39], v36 offset:4608
    ds_read_b64_tr_b16 a[160:161], v36 offset:8
    ds_read_b64_tr_b16 a[162:163], v36 offset:520
    ds_read_b64_tr_b16 a[164:165], v36 offset:4104
    ds_read_b64_tr_b16 a[166:167], v36 offset:4616
    s_waitcnt lgkmcnt(0)
    v_xor_b32 v36, 49152, v34
    ds_read_b64_tr_b16 a[48:49], v36 offset:0
    ds_read_b64_tr_b16 a[50:51], v36 offset:512
    ds_read_b64_tr_b16 a[52:53], v36 offset:4096
    ds_read_b64_tr_b16 a[54:55], v36 offset:4608
    ds_read_b64_tr_b16 a[176:177], v36 offset:8
    ds_read_b64_tr_b16 a[178:179], v36 offset:520
    ds_read_b64_tr_b16 a[180:181], v36 offset:4104
    ds_read_b64_tr_b16 a[182:183], v36 offset:4616
    s_waitcnt lgkmcnt(0)
    s_barrier
    s_mov_b32 s12, s30
    s_and_b32 s13, s31, 0xffff
    s_mov_b32 s14, 0x800000
    s_mov_b32 s15, 0x20000
    s_add_u32 m0, s24, 0
    s_add_u32 s27, s25, 0
    buffer_load_dwordx4 v32, s[12:15], s27 offen lds
    s_add_u32 m0, s24, 1024
    s_add_u32 s27, s25, 32768
    buffer_load_dwordx4 v32, s[12:15], s27 offen lds
    s_add_u32 m0, s24, 2048
    s_add_u32 s27, s25, 65536
    buffer_load_dwordx4 v32, s[12:15], s27 offen lds
    s_add_u32 m0, s24, 3072
    s_add_u32 s27, s25, 98304
    buffer_load_dwordx4 v32, s[12:15], s27 offen lds
    s_add_u32 m0, s24, 4096
    s_add_u32 s27, s25, 131072
    buffer_load_dwordx4 v32, s[12:15], s27 offen lds
    s_add_u32 m0, s24, 5120
    s_add_u32 s27, s25, 163840
    buffer_load_dwordx4 v32, s[12:15], s27 offen lds
    s_add_u32 m0, s24, 6144
    s_add_u32 s27, s25, 196608
    buffer_load_dwordx4 v32, s[12:15], s27 offen lds
    s_add_u32 m0, s24, 7168
    s_add_u32 s27, s25, 229376
    buffer_load_dwordx4 v32, s[12:15], s27 offen lds
    s_add_u32 m0, s24, 8192
    s_add_u32 s27, s25, 262144
    buffer_load_dwordx4 v32, s[12:15], s27 offen lds
    s_add_u32 m0, s24, 9216
    s_add_u32 s27, s25, 294912
    buffer_load_dwordx4 v32, s[12:15], s27 offen lds
    s_add_u32 m0, s24, 10240
    s_add_u32 s27, s25, 327680
    buffer_load_dwordx4 v32, s[12:15], s27 offen lds
    s_add_u32 m0, s24, 11264
    s_add_u32 s27, s25, 360448
    buffer_load_dwordx4 v32, s[12:15], s27 offen lds
    s_add_u32 m0, s24, 12288
    s_add_u32 s27, s25, 393216
    buffer_load_dwordx4 v32, s[12:15], s27 offen lds
    s_add_u32 m0, s24, 13312
    s_add_u32 s27, s25, 425984
    buffer_load_dwordx4 v32, s[12:15], s27 offen lds
    s_add_u32 m0, s24, 14336
    s_add_u32 s27, s25, 458752
    buffer_load_dwordx4 v32, s[12:15], s27 offen lds
    s_add_u32 m0, s24, 15360
    s_add_u32 s27, s25, 491520
    buffer_load_dwordx4 v32, s[12:15], s27 offen lds
    s_waitcnt vmcnt(16)
    s_barrier
    v_xor_b32 v36, 65536, v34
    ds_read_b64_tr_b16 a[8:9], v36 offset:0
    ds_read_b64_tr_b16 a[10:11], v36 offset:512
    ds_read_b64_tr_b16 a[12:13], v36 offset:4096
    ds_read_b64_tr_b16 a[14:15], v36 offset:4608
    ds_read_b64_tr_b16 a[136:137], v36 offset:8
    ds_read_b64_tr_b16 a[138:139], v36 offset:520
    ds_read_b64_tr_b16 a[140:141], v36 offset:4104
    ds_read_b64_tr_b16 a[142:143], v36 offset:4616
    s_waitcnt lgkmcnt(0)
    v_xor_b32 v36, 81920, v34
    ds_read_b64_tr_b16 a[24:25], v36 offset:0
    ds_read_b64_tr_b16 a[26:27], v36 offset:512
    ds_read_b64_tr_b16 a[28:29], v36 offset:4096
    ds_read_b64_tr_b16 a[30:31], v36 offset:4608
    ds_read_b64_tr_b16 a[152:153], v36 offset:8
    ds_read_b64_tr_b16 a[154:155], v36 offset:520
    ds_read_b64_tr_b16 a[156:157], v36 offset:4104
    ds_read_b64_tr_b16 a[158:159], v36 offset:4616
    s_waitcnt lgkmcnt(0)
    v_xor_b32 v36, 98304, v34
    ds_read_b64_tr_b16 a[40:41], v36 offset:0
    ds_read_b64_tr_b16 a[42:43], v36 offset:512
    ds_read_b64_tr_b16 a[44:45], v36 offset:4096
    ds_read_b64_tr_b16 a[46:47], v36 offset:4608
    ds_read_b64_tr_b16 a[168:169], v36 offset:8
    ds_read_b64_tr_b16 a[170:171], v36 offset:520
    ds_read_b64_tr_b16 a[172:173], v36 offset:4104
    ds_read_b64_tr_b16 a[174:175], v36 offset:4616
    s_waitcnt lgkmcnt(0)
    v_xor_b32 v36, 114688, v34
    ds_read_b64_tr_b16 a[56:57], v36 offset:0
    ds_read_b64_tr_b16 a[58:59], v36 offset:512
    ds_read_b64_tr_b16 a[60:61], v36 offset:4096
    ds_read_b64_tr_b16 a[62:63], v36 offset:4608
    ds_read_b64_tr_b16 a[184:185], v36 offset:8
    ds_read_b64_tr_b16 a[186:187], v36 offset:520
    ds_read_b64_tr_b16 a[188:189], v36 offset:4104
    ds_read_b64_tr_b16 a[190:191], v36 offset:4616
    s_waitcnt lgkmcnt(0)
    s_barrier
    s_add_u32 m0, s24, 65536
    s_add_u32 s27, s25, 524288
    buffer_load_dwordx4 v32, s[12:15], s27 offen lds
    s_add_u32 m0, s24, 66560
    s_add_u32 s27, s25, 557056
    buffer_load_dwordx4 v32, s[12:15], s27 offen lds
    s_add_u32 m0, s24, 67584
    s_add_u32 s27, s25, 589824
    buffer_load_dwordx4 v32, s[12:15], s27 offen lds
    s_add_u32 m0, s24, 68608
    s_add_u32 s27, s25, 622592
    buffer_load_dwordx4 v32, s[12:15], s27 offen lds
    s_add_u32 m0, s24, 69632
    s_add_u32 s27, s25, 655360
    buffer_load_dwordx4 v32, s[12:15], s27 offen lds
    s_add_u32 m0, s24, 70656
    s_add_u32 s27, s25, 688128
    buffer_load_dwordx4 v32, s[12:15], s27 offen lds
    s_add_u32 m0, s24, 71680
    s_add_u32 s27, s25, 720896
    buffer_load_dwordx4 v32, s[12:15], s27 offen lds
    s_add_u32 m0, s24, 72704
    s_add_u32 s27, s25, 753664
    buffer_load_dwordx4 v32, s[12:15], s27 offen lds
    s_add_u32 m0, s24, 73728
    s_add_u32 s27, s25, 786432
    buffer_load_dwordx4 v32, s[12:15], s27 offen lds
    s_add_u32 m0, s24, 74752
    s_add_u32 s27, s25, 819200
    buffer_load_dwordx4 v32, s[12:15], s27 offen lds
    s_add_u32 m0, s24, 75776
    s_add_u32 s27, s25, 851968
    buffer_load_dwordx4 v32, s[12:15], s27 offen lds
    s_add_u32 m0, s24, 76800
    s_add_u32 s27, s25, 884736
    buffer_load_dwordx4 v32, s[12:15], s27 offen lds
    s_add_u32 m0, s24, 77824
    s_add_u32 s27, s25, 917504
    buffer_load_dwordx4 v32, s[12:15], s27 offen lds
    s_add_u32 m0, s24, 78848
    s_add_u32 s27, s25, 950272
    buffer_load_dwordx4 v32, s[12:15], s27 offen lds
    s_add_u32 m0, s24, 79872
    s_add_u32 s27, s25, 983040
    buffer_load_dwordx4 v32, s[12:15], s27 offen lds
    s_add_u32 m0, s24, 80896
    s_add_u32 s27, s25, 1015808
    buffer_load_dwordx4 v32, s[12:15], s27 offen lds
    s_waitcnt vmcnt(16)
    s_barrier
    v_xor_b32 v36, 0, v34
    ds_read_b64_tr_b16 a[64:65], v36 offset:0
    ds_read_b64_tr_b16 a[66:67], v36 offset:512
    ds_read_b64_tr_b16 a[68:69], v36 offset:4096
    ds_read_b64_tr_b16 a[70:71], v36 offset:4608
    ds_read_b64_tr_b16 a[192:193], v36 offset:8
    ds_read_b64_tr_b16 a[194:195], v36 offset:520
    ds_read_b64_tr_b16 a[196:197], v36 offset:4104
    ds_read_b64_tr_b16 a[198:199], v36 offset:4616
    s_waitcnt lgkmcnt(0)
    v_xor_b32 v36, 16384, v34
    ds_read_b64_tr_b16 a[80:81], v36 offset:0
    ds_read_b64_tr_b16 a[82:83], v36 offset:512
    ds_read_b64_tr_b16 a[84:85], v36 offset:4096
    ds_read_b64_tr_b16 a[86:87], v36 offset:4608
    ds_read_b64_tr_b16 a[208:209], v36 offset:8
    ds_read_b64_tr_b16 a[210:211], v36 offset:520
    ds_read_b64_tr_b16 a[212:213], v36 offset:4104
    ds_read_b64_tr_b16 a[214:215], v36 offset:4616
    s_waitcnt lgkmcnt(0)
    v_xor_b32 v36, 32768, v34
    ds_read_b64_tr_b16 a[96:97], v36 offset:0
    ds_read_b64_tr_b16 a[98:99], v36 offset:512
    ds_read_b64_tr_b16 a[100:101], v36 offset:4096
    ds_read_b64_tr_b16 a[102:103], v36 offset:4608
    ds_read_b64_tr_b16 a[224:225], v36 offset:8
    ds_read_b64_tr_b16 a[226:227], v36 offset:520
    ds_read_b64_tr_b16 a[228:229], v36 offset:4104
    ds_read_b64_tr_b16 a[230:231], v36 offset:4616
    s_waitcnt lgkmcnt(0)
    v_xor_b32 v36, 49152, v34
    ds_read_b64_tr_b16 a[112:113], v36 offset:0
    ds_read_b64_tr_b16 a[114:115], v36 offset:512
    ds_read_b64_tr_b16 a[116:117], v36 offset:4096
    ds_read_b64_tr_b16 a[118:119], v36 offset:4608
    ds_read_b64_tr_b16 a[240:241], v36 offset:8
    ds_read_b64_tr_b16 a[242:243], v36 offset:520
    ds_read_b64_tr_b16 a[244:245], v36 offset:4104
    ds_read_b64_tr_b16 a[246:247], v36 offset:4616
    s_waitcnt lgkmcnt(0)
    s_barrier
    s_mov_b32 s12, s34
    s_and_b32 s13, s35, 0xffff
    s_mov_b32 s14, 0x800000
    s_mov_b32 s15, 0x20000
    s_add_u32 m0, s24, 0
    s_add_u32 s27, s26, 0
    buffer_load_dwordx4 v33, s[12:15], s27 offen lds
    s_add_u32 m0, s24, 1024
    s_add_u32 s27, s26, 131072
    buffer_load_dwordx4 v33, s[12:15], s27 offen lds
    s_add_u32 m0, s24, 2048
    s_add_u32 s27, s26, 524288
    buffer_load_dwordx4 v33, s[12:15], s27 offen lds
    s_add_u32 m0, s24, 3072
    s_add_u32 s27, s26, 655360
    buffer_load_dwordx4 v33, s[12:15], s27 offen lds
    s_add_u32 m0, s24, 4096
    s_add_u32 s27, s26, 65536
    buffer_load_dwordx4 v33, s[12:15], s27 offen lds
    s_add_u32 m0, s24, 5120
    s_add_u32 s27, s26, 196608
    buffer_load_dwordx4 v33, s[12:15], s27 offen lds
    s_add_u32 m0, s24, 6144
    s_add_u32 s27, s26, 589824
    buffer_load_dwordx4 v33, s[12:15], s27 offen lds
    s_add_u32 m0, s24, 7168
    s_add_u32 s27, s26, 720896
    buffer_load_dwordx4 v33, s[12:15], s27 offen lds
    s_add_u32 m0, s24, 8192
    s_add_u32 s27, s26, 16384
    buffer_load_dwordx4 v33, s[12:15], s27 offen lds
    s_add_u32 m0, s24, 9216
    s_add_u32 s27, s26, 147456
    buffer_load_dwordx4 v33, s[12:15], s27 offen lds
    s_add_u32 m0, s24, 10240
    s_add_u32 s27, s26, 540672
    buffer_load_dwordx4 v33, s[12:15], s27 offen lds
    s_add_u32 m0, s24, 11264
    s_add_u32 s27, s26, 671744
    buffer_load_dwordx4 v33, s[12:15], s27 offen lds
    s_add_u32 m0, s24, 12288
    s_add_u32 s27, s26, 81920
    buffer_load_dwordx4 v33, s[12:15], s27 offen lds
    s_add_u32 m0, s24, 13312
    s_add_u32 s27, s26, 212992
    buffer_load_dwordx4 v33, s[12:15], s27 offen lds
    s_add_u32 m0, s24, 14336
    s_add_u32 s27, s26, 606208
    buffer_load_dwordx4 v33, s[12:15], s27 offen lds
    s_add_u32 m0, s24, 15360
    s_add_u32 s27, s26, 737280
    buffer_load_dwordx4 v33, s[12:15], s27 offen lds
    s_waitcnt vmcnt(16)
    s_barrier
    v_xor_b32 v36, 65536, v34
    ds_read_b64_tr_b16 a[72:73], v36 offset:0
    ds_read_b64_tr_b16 a[74:75], v36 offset:512
    ds_read_b64_tr_b16 a[76:77], v36 offset:4096
    ds_read_b64_tr_b16 a[78:79], v36 offset:4608
    ds_read_b64_tr_b16 a[200:201], v36 offset:8
    ds_read_b64_tr_b16 a[202:203], v36 offset:520
    ds_read_b64_tr_b16 a[204:205], v36 offset:4104
    ds_read_b64_tr_b16 a[206:207], v36 offset:4616
    s_waitcnt lgkmcnt(0)
    v_xor_b32 v36, 81920, v34
    ds_read_b64_tr_b16 a[88:89], v36 offset:0
    ds_read_b64_tr_b16 a[90:91], v36 offset:512
    ds_read_b64_tr_b16 a[92:93], v36 offset:4096
    ds_read_b64_tr_b16 a[94:95], v36 offset:4608
    ds_read_b64_tr_b16 a[216:217], v36 offset:8
    ds_read_b64_tr_b16 a[218:219], v36 offset:520
    ds_read_b64_tr_b16 a[220:221], v36 offset:4104
    ds_read_b64_tr_b16 a[222:223], v36 offset:4616
    s_waitcnt lgkmcnt(0)
    v_xor_b32 v36, 98304, v34
    ds_read_b64_tr_b16 a[104:105], v36 offset:0
    ds_read_b64_tr_b16 a[106:107], v36 offset:512
    ds_read_b64_tr_b16 a[108:109], v36 offset:4096
    ds_read_b64_tr_b16 a[110:111], v36 offset:4608
    ds_read_b64_tr_b16 a[232:233], v36 offset:8
    ds_read_b64_tr_b16 a[234:235], v36 offset:520
    ds_read_b64_tr_b16 a[236:237], v36 offset:4104
    ds_read_b64_tr_b16 a[238:239], v36 offset:4616
    s_waitcnt lgkmcnt(0)
    v_xor_b32 v36, 114688, v34
    ds_read_b64_tr_b16 a[120:121], v36 offset:0
    ds_read_b64_tr_b16 a[122:123], v36 offset:512
    ds_read_b64_tr_b16 a[124:125], v36 offset:4096
    ds_read_b64_tr_b16 a[126:127], v36 offset:4608
    ds_read_b64_tr_b16 a[248:249], v36 offset:8
    ds_read_b64_tr_b16 a[250:251], v36 offset:520
    ds_read_b64_tr_b16 a[252:253], v36 offset:4104
    ds_read_b64_tr_b16 a[254:255], v36 offset:4616
    s_waitcnt lgkmcnt(0)
    s_barrier
    s_add_u32 m0, s24, 65536
    s_add_u32 s27, s26, 32768
    buffer_load_dwordx4 v33, s[12:15], s27 offen lds
    s_add_u32 m0, s24, 66560
    s_add_u32 s27, s26, 163840
    buffer_load_dwordx4 v33, s[12:15], s27 offen lds
    s_add_u32 m0, s24, 67584
    s_add_u32 s27, s26, 557056
    buffer_load_dwordx4 v33, s[12:15], s27 offen lds
    s_add_u32 m0, s24, 68608
    s_add_u32 s27, s26, 688128
    buffer_load_dwordx4 v33, s[12:15], s27 offen lds
    s_add_u32 m0, s24, 69632
    s_add_u32 s27, s26, 98304
    buffer_load_dwordx4 v33, s[12:15], s27 offen lds
    s_add_u32 m0, s24, 70656
    s_add_u32 s27, s26, 229376
    buffer_load_dwordx4 v33, s[12:15], s27 offen lds
    s_add_u32 m0, s24, 71680
    s_add_u32 s27, s26, 622592
    buffer_load_dwordx4 v33, s[12:15], s27 offen lds
    s_add_u32 m0, s24, 72704
    s_add_u32 s27, s26, 753664
    buffer_load_dwordx4 v33, s[12:15], s27 offen lds
    s_add_u32 m0, s24, 73728
    s_add_u32 s27, s26, 49152
    buffer_load_dwordx4 v33, s[12:15], s27 offen lds
    s_add_u32 m0, s24, 74752
    s_add_u32 s27, s26, 180224
    buffer_load_dwordx4 v33, s[12:15], s27 offen lds
    s_add_u32 m0, s24, 75776
    s_add_u32 s27, s26, 573440
    buffer_load_dwordx4 v33, s[12:15], s27 offen lds
    s_add_u32 m0, s24, 76800
    s_add_u32 s27, s26, 704512
    buffer_load_dwordx4 v33, s[12:15], s27 offen lds
    s_add_u32 m0, s24, 77824
    s_add_u32 s27, s26, 114688
    buffer_load_dwordx4 v33, s[12:15], s27 offen lds
    s_add_u32 m0, s24, 78848
    s_add_u32 s27, s26, 245760
    buffer_load_dwordx4 v33, s[12:15], s27 offen lds
    s_add_u32 m0, s24, 79872
    s_add_u32 s27, s26, 638976
    buffer_load_dwordx4 v33, s[12:15], s27 offen lds
    s_add_u32 m0, s24, 80896
    s_add_u32 s27, s26, 770048
    buffer_load_dwordx4 v33, s[12:15], s27 offen lds
    s_waitcnt vmcnt(16)
    s_barrier
    v_add_u32 v36, 0, v35
    ds_read_b64_tr_b16 v[176:177], v36 offset:0
    ds_read_b64_tr_b16 v[178:179], v36 offset:256
    ds_read_b64_tr_b16 v[180:181], v36 offset:2048
    ds_read_b64_tr_b16 v[182:183], v36 offset:2304
    ds_read_b64_tr_b16 v[184:185], v36 offset:8
    ds_read_b64_tr_b16 v[186:187], v36 offset:264
    ds_read_b64_tr_b16 v[188:189], v36 offset:2056
    ds_read_b64_tr_b16 v[190:191], v36 offset:2312
    s_waitcnt lgkmcnt(0)
    ds_read_b64_tr_b16 v[192:193], v36 offset:64
    ds_read_b64_tr_b16 v[194:195], v36 offset:320
    ds_read_b64_tr_b16 v[196:197], v36 offset:2112
    ds_read_b64_tr_b16 v[198:199], v36 offset:2368
    ds_read_b64_tr_b16 v[200:201], v36 offset:72
    ds_read_b64_tr_b16 v[202:203], v36 offset:328
    ds_read_b64_tr_b16 v[204:205], v36 offset:2120
    ds_read_b64_tr_b16 v[206:207], v36 offset:2376
    s_waitcnt lgkmcnt(0)
    ds_read_b64_tr_b16 v[208:209], v36 offset:8192
    ds_read_b64_tr_b16 v[210:211], v36 offset:8448
    ds_read_b64_tr_b16 v[212:213], v36 offset:10240
    ds_read_b64_tr_b16 v[214:215], v36 offset:10496
    ds_read_b64_tr_b16 v[216:217], v36 offset:8200
    ds_read_b64_tr_b16 v[218:219], v36 offset:8456
    ds_read_b64_tr_b16 v[220:221], v36 offset:10248
    ds_read_b64_tr_b16 v[222:223], v36 offset:10504
    s_waitcnt lgkmcnt(0)
    ds_read_b64_tr_b16 v[224:225], v36 offset:8256
    ds_read_b64_tr_b16 v[226:227], v36 offset:8512
    ds_read_b64_tr_b16 v[228:229], v36 offset:10304
    ds_read_b64_tr_b16 v[230:231], v36 offset:10560
    ds_read_b64_tr_b16 v[232:233], v36 offset:8264
    ds_read_b64_tr_b16 v[234:235], v36 offset:8520
    ds_read_b64_tr_b16 v[236:237], v36 offset:10312
    ds_read_b64_tr_b16 v[238:239], v36 offset:10568
    s_waitcnt lgkmcnt(0)
    s_barrier
    s_mov_b32 s12, s32
    s_and_b32 s13, s33, 0xffff
    s_mov_b32 s14, 0x800000
    s_mov_b32 s15, 0x20000
    s_add_u32 m0, s24, 0
    s_add_u32 s27, s25, 0
    buffer_load_dwordx4 v32, s[12:15], s27 offen lds
    s_add_u32 m0, s24, 1024
    s_add_u32 s27, s25, 32768
    buffer_load_dwordx4 v32, s[12:15], s27 offen lds
    s_add_u32 m0, s24, 2048
    s_add_u32 s27, s25, 65536
    buffer_load_dwordx4 v32, s[12:15], s27 offen lds
    s_add_u32 m0, s24, 3072
    s_add_u32 s27, s25, 98304
    buffer_load_dwordx4 v32, s[12:15], s27 offen lds
    s_add_u32 m0, s24, 4096
    s_add_u32 s27, s25, 131072
    buffer_load_dwordx4 v32, s[12:15], s27 offen lds
    s_add_u32 m0, s24, 5120
    s_add_u32 s27, s25, 163840
    buffer_load_dwordx4 v32, s[12:15], s27 offen lds
    s_add_u32 m0, s24, 6144
    s_add_u32 s27, s25, 196608
    buffer_load_dwordx4 v32, s[12:15], s27 offen lds
    s_add_u32 m0, s24, 7168
    s_add_u32 s27, s25, 229376
    buffer_load_dwordx4 v32, s[12:15], s27 offen lds
    s_add_u32 m0, s24, 8192
    s_add_u32 s27, s25, 262144
    buffer_load_dwordx4 v32, s[12:15], s27 offen lds
    s_add_u32 m0, s24, 9216
    s_add_u32 s27, s25, 294912
    buffer_load_dwordx4 v32, s[12:15], s27 offen lds
    s_add_u32 m0, s24, 10240
    s_add_u32 s27, s25, 327680
    buffer_load_dwordx4 v32, s[12:15], s27 offen lds
    s_add_u32 m0, s24, 11264
    s_add_u32 s27, s25, 360448
    buffer_load_dwordx4 v32, s[12:15], s27 offen lds
    s_add_u32 m0, s24, 12288
    s_add_u32 s27, s25, 393216
    buffer_load_dwordx4 v32, s[12:15], s27 offen lds
    s_add_u32 m0, s24, 13312
    s_add_u32 s27, s25, 425984
    buffer_load_dwordx4 v32, s[12:15], s27 offen lds
    s_add_u32 m0, s24, 14336
    s_add_u32 s27, s25, 458752
    buffer_load_dwordx4 v32, s[12:15], s27 offen lds
    s_add_u32 m0, s24, 15360
    s_add_u32 s27, s25, 491520
    buffer_load_dwordx4 v32, s[12:15], s27 offen lds
    s_waitcnt vmcnt(16)
    s_barrier
    v_add_u32 v36, 65536, v35
    ds_read_b64_tr_b16 v[240:241], v36 offset:0
    ds_read_b64_tr_b16 v[242:243], v36 offset:256
    ds_read_b64_tr_b16 v[244:245], v36 offset:2048
    ds_read_b64_tr_b16 v[246:247], v36 offset:2304
    ds_read_b64_tr_b16 v[248:249], v36 offset:8
    ds_read_b64_tr_b16 v[250:251], v36 offset:264
    ds_read_b64_tr_b16 v[252:253], v36 offset:2056
    ds_read_b64_tr_b16 v[254:255], v36 offset:2312
    s_waitcnt lgkmcnt(0)
    ds_read_b64_tr_b16 v[128:129], v36 offset:64
    ds_read_b64_tr_b16 v[130:131], v36 offset:320
    ds_read_b64_tr_b16 v[132:133], v36 offset:2112
    ds_read_b64_tr_b16 v[134:135], v36 offset:2368
    ds_read_b64_tr_b16 v[136:137], v36 offset:72
    ds_read_b64_tr_b16 v[138:139], v36 offset:328
    ds_read_b64_tr_b16 v[140:141], v36 offset:2120
    ds_read_b64_tr_b16 v[142:143], v36 offset:2376
    s_waitcnt lgkmcnt(0)
    ds_read_b64_tr_b16 v[144:145], v36 offset:8192
    ds_read_b64_tr_b16 v[146:147], v36 offset:8448
    ds_read_b64_tr_b16 v[148:149], v36 offset:10240
    ds_read_b64_tr_b16 v[150:151], v36 offset:10496
    ds_read_b64_tr_b16 v[152:153], v36 offset:8200
    ds_read_b64_tr_b16 v[154:155], v36 offset:8456
    ds_read_b64_tr_b16 v[156:157], v36 offset:10248
    ds_read_b64_tr_b16 v[158:159], v36 offset:10504
    s_waitcnt lgkmcnt(0)
    ds_read_b64_tr_b16 v[160:161], v36 offset:8256
    ds_read_b64_tr_b16 v[162:163], v36 offset:8512
    ds_read_b64_tr_b16 v[164:165], v36 offset:10304
    ds_read_b64_tr_b16 v[166:167], v36 offset:10560
    ds_read_b64_tr_b16 v[168:169], v36 offset:8264
    ds_read_b64_tr_b16 v[170:171], v36 offset:8520
    ds_read_b64_tr_b16 v[172:173], v36 offset:10312
    ds_read_b64_tr_b16 v[174:175], v36 offset:10568
    s_waitcnt lgkmcnt(0)
    s_barrier
    s_add_u32 m0, s24, 65536
    s_add_u32 s27, s25, 524288
    buffer_load_dwordx4 v32, s[12:15], s27 offen lds
    s_add_u32 m0, s24, 66560
    s_add_u32 s27, s25, 557056
    buffer_load_dwordx4 v32, s[12:15], s27 offen lds
    s_add_u32 m0, s24, 67584
    s_add_u32 s27, s25, 589824
    buffer_load_dwordx4 v32, s[12:15], s27 offen lds
    s_add_u32 m0, s24, 68608
    s_add_u32 s27, s25, 622592
    buffer_load_dwordx4 v32, s[12:15], s27 offen lds
    s_add_u32 m0, s24, 69632
    s_add_u32 s27, s25, 655360
    buffer_load_dwordx4 v32, s[12:15], s27 offen lds
    s_add_u32 m0, s24, 70656
    s_add_u32 s27, s25, 688128
    buffer_load_dwordx4 v32, s[12:15], s27 offen lds
    s_add_u32 m0, s24, 71680
    s_add_u32 s27, s25, 720896
    buffer_load_dwordx4 v32, s[12:15], s27 offen lds
    s_add_u32 m0, s24, 72704
    s_add_u32 s27, s25, 753664
    buffer_load_dwordx4 v32, s[12:15], s27 offen lds
    s_add_u32 m0, s24, 73728
    s_add_u32 s27, s25, 786432
    buffer_load_dwordx4 v32, s[12:15], s27 offen lds
    s_add_u32 m0, s24, 74752
    s_add_u32 s27, s25, 819200
    buffer_load_dwordx4 v32, s[12:15], s27 offen lds
    s_add_u32 m0, s24, 75776
    s_add_u32 s27, s25, 851968
    buffer_load_dwordx4 v32, s[12:15], s27 offen lds
    s_add_u32 m0, s24, 76800
    s_add_u32 s27, s25, 884736
    buffer_load_dwordx4 v32, s[12:15], s27 offen lds
    s_add_u32 m0, s24, 77824
    s_add_u32 s27, s25, 917504
    buffer_load_dwordx4 v32, s[12:15], s27 offen lds
    s_add_u32 m0, s24, 78848
    s_add_u32 s27, s25, 950272
    buffer_load_dwordx4 v32, s[12:15], s27 offen lds
    s_add_u32 m0, s24, 79872
    s_add_u32 s27, s25, 983040
    buffer_load_dwordx4 v32, s[12:15], s27 offen lds
    s_add_u32 m0, s24, 80896
    s_add_u32 s27, s25, 1015808
    buffer_load_dwordx4 v32, s[12:15], s27 offen lds
    s_waitcnt vmcnt(16)
    s_barrier
    v_xor_b32 v36, 0, v34
    ds_read_b64_tr_b16 v[48:49], v36 offset:0
    ds_read_b64_tr_b16 v[50:51], v36 offset:512
    ds_read_b64_tr_b16 v[52:53], v36 offset:4096
    ds_read_b64_tr_b16 v[54:55], v36 offset:4608
    ds_read_b64_tr_b16 v[56:57], v36 offset:8
    ds_read_b64_tr_b16 v[58:59], v36 offset:520
    ds_read_b64_tr_b16 v[60:61], v36 offset:4104
    ds_read_b64_tr_b16 v[62:63], v36 offset:4616
    s_waitcnt lgkmcnt(0)
    v_xor_b32 v36, 16384, v34
    ds_read_b64_tr_b16 v[64:65], v36 offset:0
    ds_read_b64_tr_b16 v[66:67], v36 offset:512
    ds_read_b64_tr_b16 v[68:69], v36 offset:4096
    ds_read_b64_tr_b16 v[70:71], v36 offset:4608
    ds_read_b64_tr_b16 v[72:73], v36 offset:8
    ds_read_b64_tr_b16 v[74:75], v36 offset:520
    ds_read_b64_tr_b16 v[76:77], v36 offset:4104
    ds_read_b64_tr_b16 v[78:79], v36 offset:4616
    s_waitcnt lgkmcnt(0)
    v_xor_b32 v36, 32768, v34
    ds_read_b64_tr_b16 v[80:81], v36 offset:0
    ds_read_b64_tr_b16 v[82:83], v36 offset:512
    ds_read_b64_tr_b16 v[84:85], v36 offset:4096
    ds_read_b64_tr_b16 v[86:87], v36 offset:4608
    ds_read_b64_tr_b16 v[88:89], v36 offset:8
    ds_read_b64_tr_b16 v[90:91], v36 offset:520
    ds_read_b64_tr_b16 v[92:93], v36 offset:4104
    ds_read_b64_tr_b16 v[94:95], v36 offset:4616
    s_waitcnt lgkmcnt(0)
    v_xor_b32 v36, 49152, v34
    ds_read_b64_tr_b16 v[96:97], v36 offset:0
    ds_read_b64_tr_b16 v[98:99], v36 offset:512
    ds_read_b64_tr_b16 v[100:101], v36 offset:4096
    ds_read_b64_tr_b16 v[102:103], v36 offset:4608
    ds_read_b64_tr_b16 v[104:105], v36 offset:8
    ds_read_b64_tr_b16 v[106:107], v36 offset:520
    ds_read_b64_tr_b16 v[108:109], v36 offset:4104
    ds_read_b64_tr_b16 v[110:111], v36 offset:4616
    s_waitcnt lgkmcnt(0)
    s_barrier
    ds_write_b128 v25, v[48:51] offset:0
    ds_write_b128 v25, v[52:55] offset:1024
    ds_write_b128 v25, v[56:59] offset:2048
    ds_write_b128 v25, v[60:63] offset:3072
    ds_write_b128 v25, v[64:67] offset:4096
    ds_write_b128 v25, v[68:71] offset:5120
    ds_write_b128 v25, v[72:75] offset:6144
    ds_write_b128 v25, v[76:79] offset:7168
    ds_write_b128 v25, v[80:83] offset:8192
    ds_write_b128 v25, v[84:87] offset:9216
    ds_write_b128 v25, v[88:91] offset:10240
    ds_write_b128 v25, v[92:95] offset:11264
    ds_write_b128 v25, v[96:99] offset:12288
    ds_write_b128 v25, v[100:103] offset:13312
    ds_write_b128 v25, v[104:107] offset:14336
    ds_write_b128 v25, v[108:111] offset:15360
    s_waitcnt lgkmcnt(0)
    s_waitcnt vmcnt(0)
    s_barrier
    v_xor_b32 v36, 65536, v34
    ds_read_b64_tr_b16 v[48:49], v36 offset:0
    ds_read_b64_tr_b16 v[50:51], v36 offset:512
    ds_read_b64_tr_b16 v[52:53], v36 offset:4096
    ds_read_b64_tr_b16 v[54:55], v36 offset:4608
    ds_read_b64_tr_b16 v[56:57], v36 offset:8
    ds_read_b64_tr_b16 v[58:59], v36 offset:520
    ds_read_b64_tr_b16 v[60:61], v36 offset:4104
    ds_read_b64_tr_b16 v[62:63], v36 offset:4616
    s_waitcnt lgkmcnt(0)
    v_xor_b32 v36, 81920, v34
    ds_read_b64_tr_b16 v[64:65], v36 offset:0
    ds_read_b64_tr_b16 v[66:67], v36 offset:512
    ds_read_b64_tr_b16 v[68:69], v36 offset:4096
    ds_read_b64_tr_b16 v[70:71], v36 offset:4608
    ds_read_b64_tr_b16 v[72:73], v36 offset:8
    ds_read_b64_tr_b16 v[74:75], v36 offset:520
    ds_read_b64_tr_b16 v[76:77], v36 offset:4104
    ds_read_b64_tr_b16 v[78:79], v36 offset:4616
    s_waitcnt lgkmcnt(0)
    v_xor_b32 v36, 98304, v34
    ds_read_b64_tr_b16 v[80:81], v36 offset:0
    ds_read_b64_tr_b16 v[82:83], v36 offset:512
    ds_read_b64_tr_b16 v[84:85], v36 offset:4096
    ds_read_b64_tr_b16 v[86:87], v36 offset:4608
    ds_read_b64_tr_b16 v[88:89], v36 offset:8
    ds_read_b64_tr_b16 v[90:91], v36 offset:520
    ds_read_b64_tr_b16 v[92:93], v36 offset:4104
    ds_read_b64_tr_b16 v[94:95], v36 offset:4616
    s_waitcnt lgkmcnt(0)
    v_xor_b32 v36, 114688, v34
    ds_read_b64_tr_b16 v[96:97], v36 offset:0
    ds_read_b64_tr_b16 v[98:99], v36 offset:512
    ds_read_b64_tr_b16 v[100:101], v36 offset:4096
    ds_read_b64_tr_b16 v[102:103], v36 offset:4608
    ds_read_b64_tr_b16 v[104:105], v36 offset:8
    ds_read_b64_tr_b16 v[106:107], v36 offset:520
    ds_read_b64_tr_b16 v[108:109], v36 offset:4104
    ds_read_b64_tr_b16 v[110:111], v36 offset:4616
    s_waitcnt lgkmcnt(0)
    s_barrier
    ds_write_b128 v27, v[96:99] offset:0
    ds_write_b128 v27, v[100:103] offset:1024
    ds_write_b128 v27, v[104:107] offset:2048
    ds_write_b128 v27, v[108:111] offset:3072
    ds_write_b128 v27, v[128:131] offset:4096
    ds_write_b128 v27, v[132:135] offset:5120
    ds_write_b128 v27, v[136:139] offset:6144
    ds_write_b128 v27, v[140:143] offset:7168
    ds_write_b128 v27, v[144:147] offset:8192
    ds_write_b128 v27, v[148:151] offset:9216
    ds_write_b128 v27, v[152:155] offset:10240
    ds_write_b128 v27, v[156:159] offset:11264
    ds_write_b128 v27, v[160:163] offset:12288
    ds_write_b128 v27, v[164:167] offset:13312
    ds_write_b128 v27, v[168:171] offset:14336
    ds_write_b128 v27, v[172:175] offset:15360
    s_waitcnt lgkmcnt(0)
    v_mov_b32 v128, v48
    v_mov_b32 v129, v49
    v_mov_b32 v130, v50
    v_mov_b32 v131, v51
    v_mov_b32 v132, v52
    v_mov_b32 v133, v53
    v_mov_b32 v134, v54
    v_mov_b32 v135, v55
    v_mov_b32 v136, v56
    v_mov_b32 v137, v57
    v_mov_b32 v138, v58
    v_mov_b32 v139, v59
    v_mov_b32 v140, v60
    v_mov_b32 v141, v61
    v_mov_b32 v142, v62
    v_mov_b32 v143, v63
    v_mov_b32 v144, v64
    v_mov_b32 v145, v65
    v_mov_b32 v146, v66
    v_mov_b32 v147, v67
    v_mov_b32 v148, v68
    v_mov_b32 v149, v69
    v_mov_b32 v150, v70
    v_mov_b32 v151, v71
    v_mov_b32 v152, v72
    v_mov_b32 v153, v73
    v_mov_b32 v154, v74
    v_mov_b32 v155, v75
    v_mov_b32 v156, v76
    v_mov_b32 v157, v77
    v_mov_b32 v158, v78
    v_mov_b32 v159, v79
    v_mov_b32 v160, v80
    v_mov_b32 v161, v81
    v_mov_b32 v162, v82
    v_mov_b32 v163, v83
    v_mov_b32 v164, v84
    v_mov_b32 v165, v85
    v_mov_b32 v166, v86
    v_mov_b32 v167, v87
    v_mov_b32 v168, v88
    v_mov_b32 v169, v89
    v_mov_b32 v170, v90
    v_mov_b32 v171, v91
    v_mov_b32 v172, v92
    v_mov_b32 v173, v93
    v_mov_b32 v174, v94
    v_mov_b32 v175, v95
    v_lshlrev_b32 v31, 2, v31
    v_mov_b32 v48, 32
    v_mov_b32 v49, 4194304
    v_cmp_eq_u32 vcc, 0, v31
    s_nop 1
    v_cndmask_b32 v48, v48, v49, vcc
    s_mov_b64 exec, 6
    v_add_u32 v31, 160, v31
    s_mov_b64 exec, 0x1ff
hk_31:
    buffer_load_dword v29, v31, s[96:99], 0 offen offset:28 sc1
    s_waitcnt vmcnt(0)
    v_cmp_lt_u32 vcc, v29, v48
    s_cbranch_vccz hkok_32
    s_sleep 4
    s_sub_u32 s95, s95, 1
    s_cbranch_scc0 hk_31
    s_mov_b32 s95, 0
hkok_32:
    v_readfirstlane_b32 s24, v29
    s_mov_b64 exec, -1
    s_movk_i32 s100, 0xff
    s_and_b32 s24, s24, 0xffff
    s_cmp_gt_u32 s24, 32
    s_cselect_b32 s24, 0x2000, 0
    s_xor_b32 s46, s46, s24
    s_xor_b32 s51, s51, s24
    s_mov_b32 s44, 0
    s_barrier
    s_mov_b32 s24, s46
    s_xor_b32 s26, s24, 0x12000
    s_mov_b64 s[28:29], -1
    v_lshrrev_b32 v30, 1, v2
    v_xor_b32 v21, 2048, v26
    v_xor_b32 v22, 4096, v26
    v_xor_b32 v23, 6144, v26
    s_mov_b32 s30, 0xffff
    s_mov_b32 s31, 0xffff
    s_mov_b32 s60, 0x3f803f80
    s_mov_b32 s58, 0x43800000
    s_mov_b32 s16, 0
    s_mov_b32 s19, 0
    s_and_b32 s25, s3, 1
    s_lshl_b32 s25, s25, 10
    s_add_u32 s25, s25, 144384
    v_add_u32 v20, s25, v2
    s_mov_b32 s32, 105907200
    s_xor_b32 s21, s3, 3
    s_or_b32 s21, s21, s5
    s_cmp_eq_u32 s21, 0
    s_cselect_b32 s38, 1, 0
    s_mov_b32 s39, 0
    s_mov_b32 s33, 105906176
kvw_33:
    buffer_load_dword v29, off, s[8:11], s32 sc1
    s_sub_u32 s45, s45, 1
    s_cselect_b64 s[28:29], 0, s[28:29]
    s_waitcnt vmcnt(0)
    v_readfirstlane_b32 s21, v29
    s_orn2_b32 s21, s21, s28
    s_cmp_ge_u32 s21, 128
    s_cbranch_scc1 kvok_34
    s_sleep 6
    s_branch kvw_33
kvok_34:
    s_add_u32 s32, s32, 128
    v_mov_b32 v96, 0
    v_mov_b32 v97, 0
    v_mov_b32 v98, 0
    v_mov_b32 v99, 0
    v_mov_b32 v100, 0
    v_mov_b32 v101, 0
    v_mov_b32 v102, 0
    v_mov_b32 v103, 0
    v_mov_b32 v104, 0
    v_mov_b32 v105, 0
    v_mov_b32 v106, 0
    v_mov_b32 v107, 0
    v_mov_b32 v108, 0
    v_mov_b32 v109, 0
    v_mov_b32 v110, 0
    v_mov_b32 v111, 0
    s_branch rec_x_36
.p2align 6
rec_loop_35:
    v_mov_b32 v64, 0
    v_mov_b32 v65, 0
    v_mov_b32 v66, 0
    v_mov_b32 v67, 0
    v_mov_b32 v68, 0
    v_mov_b32 v69, 0
    v_mov_b32 v70, 0
    v_mov_b32 v71, 0
    buffer_load_dwordx4 v[56:59], v2, s[8:11], s50 offen offset:2048 sc1
    buffer_load_dwordx4 v[60:63], v2, s[8:11], s50 offen offset:3072 sc1
    ds_read_b128 v[112:115], v27 offset:8192
    ds_read_b128 v[116:119], v27 offset:9216
    ds_read_b128 v[120:123], v27 offset:10240
    ds_read_b128 v[124:127], v27 offset:11264
    ds_read_b128 v[32:35], v27 offset:12288
    ds_read_b128 v[36:39], v27 offset:13312
    ds_read_b128 v[40:43], v27 offset:14336
    ds_read_b128 v[44:47], v27 offset:15360
    v_mov_b32 v72, 0
    v_mov_b32 v73, 0
    v_mov_b32 v74, 0
    v_mov_b32 v75, 0
    v_mov_b32 v76, 0
    v_mov_b32 v77, 0
    v_mov_b32 v78, 0
    v_mov_b32 v79, 0
    s_bfe_u32 s16, s44, 0x10001
    s_add_u32 s44, s44, 1
    s_and_b32 s24, s44, 1
    s_add_u32 s24, s24, 1
    s_lshl_b32 s24, s24, 17
    s_add_u32 s20, s24, s51
    s_xor_b32 s22, s20, 0x2000
opoll2_43:
    buffer_load_dwordx4 v[48:51], v2, s[8:11], s50 offen offset:0 sc1
    buffer_load_dwordx4 v[52:55], v2, s[8:11], s50 offen offset:1024 sc1
    s_mov_b64 exec, -1
    s_sub_u32 s45, s45, 1
    s_cselect_b64 s[28:29], 0, s[28:29]
    s_waitcnt vmcnt(2)
    v_xor_b32 v29, s18, v56
    v_bitop3_b32 v29, v29, v60, s18 bitop3:0xf6
    v_and_b32 v29, 1, v29
    v_cmp_ne_u32 vcc, 0, v29
    s_and_b64 exec, vcc, s[28:29]
    s_cbranch_scc0 ookb_41
    buffer_load_dwordx4 v[56:59], v2, s[8:11], s50 offen offset:2048 sc1
    buffer_load_dwordx4 v[60:63], v2, s[8:11], s50 offen offset:3072 sc1
    s_mov_b64 exec, -1
    s_sub_u32 s45, s45, 1
    s_cselect_b64 s[28:29], 0, s[28:29]
    s_waitcnt vmcnt(2)
    v_xor_b32 v29, s18, v48
    v_bitop3_b32 v29, v29, v52, s18 bitop3:0xf6
    v_and_b32 v29, 1, v29
    v_cmp_ne_u32 vcc, 0, v29
    s_and_b64 exec, vcc, s[28:29]
    s_cbranch_scc1 opoll2_43
    s_mov_b64 exec, -1
    s_waitcnt lgkmcnt(0)
    v_smfmac_f32_16x16x64_bf16 v[64:67], v[48:51], v[176:183], v1
    v_smfmac_f32_16x16x64_bf16 v[68:71], v[48:51], v[184:191], v1
    v_smfmac_f32_16x16x64_bf16 v[64:67], v[52:55], v[208:215], v1
    v_smfmac_f32_16x16x64_bf16 v[68:71], v[52:55], v[216:223], v1
    v_smfmac_f32_16x16x64_bf16 v[72:75], v[48:51], v[192:199], v1
    v_smfmac_f32_16x16x64_bf16 v[76:79], v[48:51], v[200:207], v1
    s_waitcnt vmcnt(0)
    v_smfmac_f32_16x16x64_bf16 v[64:67], v[56:59], v[240:247], v1
    v_smfmac_f32_16x16x64_bf16 v[68:71], v[56:59], v[248:255], v1
    v_smfmac_f32_16x16x64_bf16 v[64:67], v[60:63], v[112:119], v1
    v_smfmac_f32_16x16x64_bf16 v[68:71], v[60:63], v[120:127], v1
    v_smfmac_f32_16x16x64_bf16 v[72:75], v[52:55], v[224:231], v1
    v_xor_b32 v29, s18, v56
    v_smfmac_f32_16x16x64_bf16 v[76:79], v[52:55], v[232:239], v1
    v_bitop3_b32 v29, v29, v60, s18 bitop3:0xf6
    v_smfmac_f32_16x16x64_bf16 v[72:75], v[56:59], v[80:87], v1
    v_and_b32 v29, 1, v29
    v_smfmac_f32_16x16x64_bf16 v[76:79], v[56:59], v[88:95], v1
    v_cmp_ne_u32 vcc, 0, v29
    v_smfmac_f32_16x16x64_bf16 v[72:75], v[60:63], v[32:39], v1
    v_permlane32_swap_b32 v64, v68
    v_smfmac_f32_16x16x64_bf16 v[76:79], v[60:63], v[40:47], v1
    v_permlane32_swap_b32 v65, v69
ofin_42:
    v_permlane32_swap_b32 v66, v70
    v_permlane32_swap_b32 v67, v71
    v_pk_add_f32 v[64:65], v[64:65], v[68:69]
    v_pk_add_f32 v[66:67], v[66:67], v[70:71]
    ds_write_b128 v26, v[64:67] offset:13312
    s_and_b64 vcc, vcc, s[28:29]
    s_cbranch_scc1 oslow_40
    s_cmp_lg_u32 s93, 0
    v_permlane32_swap_b32 v72, v76
    v_permlane32_swap_b32 v73, v77
    v_permlane32_swap_b32 v74, v78
    v_permlane32_swap_b32 v75, v79
    v_pk_add_f32 v[72:73], v[72:73], v[76:77]
    v_pk_add_f32 v[74:75], v[74:75], v[78:79]
    ds_write_b128 v26, v[72:75] offset:14336
    s_waitcnt lgkmcnt(0)
    s_barrier
    s_cbranch_scc1 nduty_44
    ds_read_b128 v[48:51], v20 offset:0
    ds_read_b128 v[52:55], v20 offset:2048
    ds_read_b128 v[56:59], v20 offset:4096
    ds_read_b128 v[60:63], v20 offset:6144
    s_waitcnt lgkmcnt(2)
    v_pk_add_f32 v[112:113], v[48:49], v[52:53]
    v_pk_add_f32 v[114:115], v[50:51], v[54:55]
    s_waitcnt lgkmcnt(1)
    v_pk_add_f32 v[112:113], v[112:113], v[56:57]
    v_pk_add_f32 v[114:115], v[114:115], v[58:59]
    s_waitcnt lgkmcnt(0)
    v_pk_add_f32 v[112:113], v[112:113], v[60:61]
    v_pk_add_f32 v[114:115], v[114:115], v[62:63]
    v_cvt_pk_bf16_f32 v116, v112, v113
    v_cvt_pk_bf16_f32 v118, v112, v113
    v_cvt_pk_bf16_f32 v117, v114, v115
    v_cvt_pk_bf16_f32 v119, v114, v115
    v_permlane16_swap_b32 v116, v118
    v_bfi_b32 v116, 1, s16, v116
    v_permlane16_swap_b32 v117, v119
    s_mov_b64 exec, s[30:31]
    buffer_store_dwordx4 v[116:119], v3, s[8:11], s20 offen sc1
    buffer_store_dwordx4 v[116:119], v3, s[8:11], s22 offen
    s_mov_b64 exec, -1
    s_barrier
rec_x2_45:
    s_add_u32 s24, s24, s46
    s_xor_b32 s26, s24, 0x12000
    s_mov_b32 s19, 1
    s_add_u32 s52, s52, 262144
    s_add_u32 s61, s61, 262144
    s_add_u32 s53, s53, 131072
rec_x_36:
    s_and_b32 s25, s44, 1
    s_mul_i32 s25, s25, 393216
    s_add_u32 s23, s25, s47
    s_add_u32 s25, s25, s48
    s_bfe_u32 s17, s44, 0x10001
    s_and_b32 s18, s44, 1
    s_and_b32 s34, s44, 7
    s_cmp_eq_u32 s34, 7
    s_cselect_b64 s[34:35], 1, 0
    v_mov_b32 v80, 0
    v_mov_b32 v81, 0
    v_mov_b32 v82, 0
    v_mov_b32 v83, 0
    v_mov_b32 v84, 0
    v_mov_b32 v85, 0
    v_mov_b32 v86, 0
    v_mov_b32 v87, 0
    buffer_load_dwordx4 v[48:51], v16, s[8:11], s26 offen offset:0 sc1
    buffer_load_dwordx4 v[52:55], v16, s[8:11], s26 offen offset:256 sc1
    buffer_load_dwordx4 v[56:59], v16, s[8:11], s26 offen offset:2048 sc1
    buffer_load_dwordx4 v[60:63], v16, s[8:11], s26 offen offset:2304 sc1
    v_mov_b32 v88, 0
    v_mov_b32 v89, 0
    v_mov_b32 v90, 0
    v_mov_b32 v91, 0
    v_mov_b32 v92, 0
    v_mov_b32 v93, 0
    v_mov_b32 v94, 0
    v_mov_b32 v95, 0
    v_mov_b32 v96, 0
    v_mov_b32 v97, 0
    v_mov_b32 v98, 0
    v_mov_b32 v99, 0
    v_mov_b32 v100, 0
    v_mov_b32 v101, 0
    v_mov_b32 v102, 0
    v_mov_b32 v103, 0
    buffer_load_dwordx4 v[64:67], v16, s[8:11], s24 offen offset:0 sc1
    buffer_load_dwordx4 v[68:71], v16, s[8:11], s24 offen offset:256 sc1
    buffer_load_dwordx4 v[72:75], v16, s[8:11], s24 offen offset:2048 sc1
    buffer_load_dwordx4 v[76:79], v16, s[8:11], s24 offen offset:2304 sc1
    s_cmp_eq_u32 s93, 0
    s_cbranch_scc1 nonown_38
    s_waitcnt vmcnt(4)
    v_xor_b32 v29, s16, v48
    v_mfma_f32_16x16x32_bf16 v[112:115], v[48:51], v[4:7], 0
    v_mfma_f32_16x16x32_bf16 v[116:119], v[52:55], v[4:7], 0
    v_bitop3_b32 v29, v29, v52, s16 bitop3:0xf6
    v_mfma_f32_16x16x32_bf16 v[120:123], v[56:59], v[4:7], 0
    v_bitop3_b32 v29, v29, v56, s16 bitop3:0xf6
    v_mfma_f32_16x16x32_bf16 v[124:127], v[60:63], v[4:7], 0
    v_bitop3_b32 v29, v29, v60, s16 bitop3:0xf6
    s_waitcnt vmcnt(3)
    v_mfma_f32_16x16x32_bf16 v[112:115], v[64:67], v[4:7], v[112:115]
    v_bitop3_b32 v29, v29, v64, s16 bitop3:0xf6
    s_waitcnt vmcnt(2)
    v_mfma_f32_16x16x32_bf16 v[116:119], v[68:71], v[4:7], v[116:119]
    v_bitop3_b32 v29, v29, v68, s16 bitop3:0xf6
    s_waitcnt vmcnt(1)
    v_mfma_f32_16x16x32_bf16 v[120:123], v[72:75], v[4:7], v[120:123]
    v_bitop3_b32 v29, v29, v72, s16 bitop3:0xf6
    s_waitcnt vmcnt(0)
    v_mfma_f32_16x16x32_bf16 v[124:127], v[76:79], v[4:7], v[124:127]
    v_bitop3_b32 v29, v29, v76, s16 bitop3:0xf6
    v_and_b32 v29, s19, v29
    v_cmp_ne_u32 vcc, 0, v29
    s_and_b64 vcc, vcc, s[28:29]
    s_cbranch_scc1 xslow_48
xok_49:
    v_cvt_pk_bf16_f32 v72, v112, v113
    v_cvt_pk_bf16_f32 v73, v114, v115
    v_cvt_pk_bf16_f32 v74, v116, v117
    v_cvt_pk_bf16_f32 v75, v118, v119
    ds_write_b128 v26, v[72:75]
    v_cvt_pk_bf16_f32 v76, v120, v121
    v_cvt_pk_bf16_f32 v77, v122, v123
    v_cvt_pk_bf16_f32 v78, v124, v125
    v_cvt_pk_bf16_f32 v79, v126, v127
    ds_write_b128 v26, v[76:79] offset:1024
    v_smfmac_f32_16x16x64_bf16 v[80:83], v[72:75], a[0:7], v1
    v_smfmac_f32_16x16x64_bf16 v[84:87], v[72:75], a[64:71], v1
    v_smfmac_f32_16x16x64_bf16 v[88:91], v[72:75], a[128:135], v1
    v_smfmac_f32_16x16x64_bf16 v[92:95], v[72:75], a[192:199], v1
    s_waitcnt vmcnt(0) lgkmcnt(0)
    s_barrier
    ds_read_b128 v[48:51], v21 offset:0
    ds_read_b128 v[52:55], v21 offset:1024
    ds_read_b128 v[56:59], v22 offset:0
    ds_read_b128 v[60:63], v22 offset:1024
    ds_read_b128 v[64:67], v23 offset:0
    ds_read_b128 v[68:71], v23 offset:1024
    v_smfmac_f32_16x16x64_bf16 v[80:83], v[76:79], a[8:15], v1
    buffer_store_dwordx2 v[108:109], v30, s[8:11], s53 offen sc1
    v_smfmac_f32_16x16x64_bf16 v[84:87], v[76:79], a[72:79], v1
    v_smfmac_f32_16x16x64_bf16 v[88:91], v[76:79], a[136:143], v1
    v_smfmac_f32_16x16x64_bf16 v[92:95], v[76:79], a[200:207], v1
    buffer_load_dwordx4 v[32:35], v18, s[8:11], s52 offen offset:0
    s_waitcnt lgkmcnt(5)
    v_smfmac_f32_16x16x64_bf16 v[80:83], v[48:51], a[16:23], v1
    v_smfmac_f32_16x16x64_bf16 v[84:87], v[48:51], a[80:87], v1
    s_waitcnt lgkmcnt(4)
    v_smfmac_f32_16x16x64_bf16 v[80:83], v[52:55], a[24:31], v1
    buffer_load_dwordx4 v[36:39], v18, s[8:11], s52 offen offset:64
    v_smfmac_f32_16x16x64_bf16 v[84:87], v[52:55], a[88:95], v1
    s_waitcnt lgkmcnt(3)
    v_smfmac_f32_16x16x64_bf16 v[80:83], v[56:59], a[32:39], v1
    v_smfmac_f32_16x16x64_bf16 v[84:87], v[56:59], a[96:103], v1
    buffer_load_dwordx4 v[40:43], v18, s[8:11], s61 offen offset:0
    s_waitcnt lgkmcnt(2)
    v_smfmac_f32_16x16x64_bf16 v[80:83], v[60:63], a[40:47], v1
    v_smfmac_f32_16x16x64_bf16 v[84:87], v[60:63], a[104:111], v1
    s_waitcnt lgkmcnt(1)
    v_smfmac_f32_16x16x64_bf16 v[80:83], v[64:67], a[48:55], v1
    buffer_load_dwordx4 v[44:47], v18, s[8:11], s61 offen offset:64
    v_smfmac_f32_16x16x64_bf16 v[84:87], v[64:67], a[112:119], v1
    s_waitcnt lgkmcnt(0)
    v_smfmac_f32_16x16x64_bf16 v[80:83], v[68:71], a[56:63], v1
    v_smfmac_f32_16x16x64_bf16 v[84:87], v[68:71], a[120:127], v1
    v_smfmac_f32_16x16x64_bf16 v[88:91], v[48:51], a[144:151], v1
    ds_read_b128 v[112:115], v25 offset:0
    v_smfmac_f32_16x16x64_bf16 v[92:95], v[48:51], a[208:215], v1
    ds_read_b128 v[116:119], v25 offset:1024
    v_smfmac_f32_16x16x64_bf16 v[88:91], v[52:55], a[152:159], v1
    ds_read_b128 v[120:123], v25 offset:2048
    v_smfmac_f32_16x16x64_bf16 v[92:95], v[52:55], a[216:223], v1
    ds_read_b128 v[124:127], v25 offset:3072
    v_smfmac_f32_16x16x64_bf16 v[88:91], v[56:59], a[160:167], v1
    v_permlane32_swap_b32 v80, v84
    v_smfmac_f32_16x16x64_bf16 v[92:95], v[56:59], a[224:231], v1
    v_permlane32_swap_b32 v81, v85
    v_smfmac_f32_16x16x64_bf16 v[88:91], v[60:63], a[168:175], v1
    v_permlane32_swap_b32 v82, v86
    v_smfmac_f32_16x16x64_bf16 v[92:95], v[60:63], a[232:239], v1
    v_permlane32_swap_b32 v83, v87
    v_smfmac_f32_16x16x64_bf16 v[88:91], v[64:67], a[176:183], v1
    v_pk_add_f32 v[80:81], v[80:81], v[84:85]
    v_smfmac_f32_16x16x64_bf16 v[92:95], v[64:67], a[240:247], v1
    v_pk_add_f32 v[82:83], v[82:83], v[86:87]
    v_smfmac_f32_16x16x64_bf16 v[88:91], v[68:71], a[184:191], v1
    v_cvt_pk_bf16_f32 v104, v80, v81
    v_smfmac_f32_16x16x64_bf16 v[92:95], v[68:71], a[248:255], v1
    v_cvt_pk_bf16_f32 v105, v82, v83
    v_bfi_b32 v104, 1, s17, v104
    buffer_store_dwordx2 v[104:105], v30, s[8:11], s23 offen
    s_waitcnt lgkmcnt(0)
    v_smfmac_f32_16x16x64_bf16 v[96:99], v[72:75], v[112:119], v1
    ds_read_b128 v[80:83], v25 offset:4096
    v_smfmac_f32_16x16x64_bf16 v[100:103], v[72:75], v[120:127], v1
    ds_read_b128 v[84:87], v25 offset:5120
    v_permlane32_swap_b32 v88, v92
    v_permlane32_swap_b32 v89, v93
    v_permlane32_swap_b32 v90, v94
    v_permlane32_swap_b32 v91, v95
    v_pk_add_f32 v[88:89], v[88:89], v[92:93]
    v_pk_add_f32 v[90:91], v[90:91], v[94:95]
    v_cvt_pk_bf16_f32 v108, v88, v89
    v_cvt_pk_bf16_f32 v109, v90, v91
    v_bfi_b32 v108, 1, s17, v108
    buffer_store_dwordx2 v[108:109], v30, s[8:11], s23 offen offset:512
    ds_read_b128 v[88:91], v25 offset:6144
    ds_read_b128 v[92:95], v25 offset:7168
    ds_read_b128 v[112:115], v25 offset:8192
    ds_read_b128 v[116:119], v25 offset:9216
    ds_read_b128 v[120:123], v25 offset:10240
    ds_read_b128 v[124:127], v25 offset:11264
    v_smfmac_f32_16x16x64_bf16 v[96:99], v[76:79], v[128:135], v1
    v_smfmac_f32_16x16x64_bf16 v[100:103], v[76:79], v[136:143], v1
    s_waitcnt lgkmcnt(4)
    v_smfmac_f32_16x16x64_bf16 v[96:99], v[48:51], v[80:87], v1
    v_smfmac_f32_16x16x64_bf16 v[100:103], v[48:51], v[88:95], v1
    ds_read_b128 v[80:83], v25 offset:12288
    ds_read_b128 v[84:87], v25 offset:13312
    ds_read_b128 v[88:91], v25 offset:14336
    ds_read_b128 v[92:95], v25 offset:15360
    v_smfmac_f32_16x16x64_bf16 v[96:99], v[52:55], v[144:151], v1
    v_smfmac_f32_16x16x64_bf16 v[100:103], v[52:55], v[152:159], v1
    v_mov_b32 v72, v104
    v_mov_b32 v73, v105
    v_mov_b32 v76, v108
    v_mov_b32 v77, v109
    s_waitcnt lgkmcnt(4)
    v_smfmac_f32_16x16x64_bf16 v[96:99], v[56:59], v[112:119], v1
    v_smfmac_f32_16x16x64_bf16 v[100:103], v[56:59], v[120:127], v1
    v_mov_b32 v48, v104
    v_mov_b32 v49, v105
    v_mov_b32 v52, v108
    v_mov_b32 v53, v109
    ds_read_b128 v[112:115], v27 offset:0
    ds_read_b128 v[116:119], v27 offset:1024
    ds_read_b128 v[120:123], v27 offset:2048
    ds_read_b128 v[124:127], v27 offset:3072
    v_smfmac_f32_16x16x64_bf16 v[96:99], v[60:63], v[160:167], v1
    v_smfmac_f32_16x16x64_bf16 v[100:103], v[60:63], v[168:175], v1
    buffer_load_dwordx2 v[74:75], v30, s[8:11], s25 offen offset:0 sc1
    buffer_load_dwordx2 v[78:79], v30, s[8:11], s25 offen offset:512 sc1
    s_waitcnt lgkmcnt(4)
    v_smfmac_f32_16x16x64_bf16 v[96:99], v[64:67], v[80:87], v1
    v_smfmac_f32_16x16x64_bf16 v[100:103], v[64:67], v[88:95], v1
    s_waitcnt lgkmcnt(0)
    v_smfmac_f32_16x16x64_bf16 v[96:99], v[68:71], v[112:119], v1
    v_smfmac_f32_16x16x64_bf16 v[100:103], v[68:71], v[120:127], v1
    buffer_load_dwordx2 v[50:51], v30, s[8:11], s25 offen offset:0 sc1
    buffer_load_dwordx2 v[54:55], v30, s[8:11], s25 offen offset:512 sc1
    s_waitcnt vmcnt(2)
    v_mfma_f32_16x16x32_bf16 v[56:59], v[72:75], v[8:11], 0
    v_mfma_f32_16x16x32_bf16 v[60:63], v[76:79], v[8:11], 0
    v_xor_b32 v29, s17, v74
    v_bitop3_b32 v29, v29, v78, s17 bitop3:0xf6
    v_and_b32 v29, 1, v29
    v_cmp_ne_u32 vcc, 0, v29
    s_and_b64 vcc, vcc, s[28:29]
    s_cbranch_scc1 bpoll_50
bok_51:
    v_permlane32_swap_b32 v96, v100
    v_cvt_pk_bf16_f32 v104, v56, v57
    v_cvt_pk_bf16_f32 v105, v58, v59
    v_cvt_pk_bf16_f32 v106, v60, v61
    v_cvt_pk_bf16_f32 v107, v62, v63
    v_permlane32_swap_b32 v97, v101
    s_nop 0
    v_mfma_f32_16x16x32_bf16 v[64:67], v[32:35], v[104:107], 0
    v_permlane32_swap_b32 v98, v102
    v_mfma_f32_16x16x32_bf16 v[68:71], v[36:39], v[104:107], 0
    v_permlane32_swap_b32 v99, v103
    v_mfma_f32_16x16x32_bf16 v[56:59], v[104:107], v[104:107], 0
    v_pk_add_f32 v[96:97], v[96:97], v[100:101]
    v_pk_add_f32 v[98:99], v[98:99], v[102:103]
    v_cvt_pk_bf16_f32 v124, v96, v97
    s_mov_b64 exec, s[56:57]
    ds_write_b128 v19, v[64:67]
    s_nop 0
    ds_write_b128 v19, v[68:71] offset:512
    s_nop 0
    ds_write_b128 v24, v[56:59]
    s_mov_b64 exec, -1
    v_cvt_pk_bf16_f32 v125, v98, v99
    buffer_load_dwordx2 v[126:127], v30, s[8:11], s25 offen offset:1024 sc1
    v_mov_b32 v113, 0
    v_mov_b32 v114, 0
    v_mov_b32 v115, 0
    v_mov_b32 v116, 0
    v_mov_b32 v120, s60
    v_mov_b32 v121, s60
    v_mov_b32 v122, s60
    v_mov_b32 v123, s60
    s_cmp_eq_u32 s44, 63
    s_waitcnt vmcnt(1) lgkmcnt(0)
    s_barrier
    s_cbranch_scc1 rec_lasto_52
    ds_read_b128 v[48:51], v28 offset:0
    ds_read_b128 v[52:55], v28 offset:1024
    ds_read_b128 v[56:59], v28 offset:2048
    ds_read_b128 v[60:63], v28 offset:3072
    ds_read2_b32 v[68:69], v0 offset0:0 offset1:64
    ds_read2_b32 v[70:71], v0 offset0:128 offset1:192
    s_waitcnt lgkmcnt(4)
    v_pk_add_f32 v[48:49], v[48:49], v[52:53]
    v_pk_add_f32 v[50:51], v[50:51], v[54:55]
    s_waitcnt lgkmcnt(2)
    v_pk_add_f32 v[56:57], v[56:57], v[60:61]
    v_pk_add_f32 v[58:59], v[58:59], v[62:63]
    v_pk_add_f32 v[48:49], v[48:49], v[56:57]
    v_pk_add_f32 v[50:51], v[50:51], v[58:59]
    s_waitcnt lgkmcnt(0)
    v_pk_add_f32 v[68:69], v[68:69], v[70:71]
    v_max3_f32 v53, abs(v48), abs(v49), abs(v50)
    v_add_f32 v52, v68, v69
    v_max3_f32 v53, v53, abs(v51), abs(v52)
    v_cmp_nge_f32 vcc, s58, v53
    s_cbranch_vccnz smax_55
    v_mul_f32 v48, s55, v48
    v_mul_f32 v49, s55, v49
    v_mul_f32 v50, s55, v50
    v_mul_f32 v51, s55, v51
    v_mul_f32 v52, s55, v52
smaxb_56:
    v_exp_f32 v48, v48
    v_exp_f32 v49, v49
    v_exp_f32 v50, v50
    v_exp_f32 v51, v51
    v_exp_f32 v52, v52
    v_cvt_pk_bf16_f32 v56, v48, v49
    v_cvt_pk_bf16_f32 v57, v50, v51
    v_mov_b32_dpp v55, v52 row_ror:8 row_mask:0xf bank_mask:0xf
    v_mov_b32_dpp v58, v56 row_ror:8 row_mask:0xf bank_mask:0xf
    v_mov_b32_dpp v59, v57 row_ror:8 row_mask:0xf bank_mask:0xf
    v_cvt_pk_bf16_f32 v112, v52, v55
    v_cvt_pk_bf16_f32 v117, v52, v55
    s_waitcnt vmcnt(0)
    v_mfma_f32_16x16x32_bf16 v[72:75], v[12:15], v[124:127], 0
    v_xor_b32 v29, s17, v126
    v_mfma_f32_16x16x32_bf16 v[76:79], v[120:123], v[56:59], 0
    v_and_b32 v29, 1, v29
    v_mfma_f32_16x16x32_bf16 v[76:79], v[120:123], v[112:115], v[76:79]
    s_cmp_eq_u32 s44, 63
    v_mfma_f32_16x16x32_bf16 v[60:63], v[40:43], v[56:59], 0
    s_nop 0
vpoll2_54:
    v_cmp_ne_u32 vcc, 0, v29
    v_cvt_pk_bf16_f32 v108, v72, v73
    v_cvt_pk_bf16_f32 v109, v74, v75
    v_mfma_f32_16x16x32_bf16 v[68:71], v[44:47], v[56:59], 0
    s_cbranch_vccnz stub_57
back_58:
    v_mfma_f32_16x16x32_bf16 v[60:63], v[108:111], v[112:115], v[60:63]
    v_mfma_f32_16x16x32_bf16 v[68:71], v[106:109], v[114:117], v[68:71]
    v_rcp_f32 v53, v76
    v_rcp_f32 v52, v76
    ds_read_b128 v[80:83], v27 offset:4096
    ds_read_b128 v[84:87], v27 offset:5120
    ds_read_b128 v[88:91], v27 offset:6144
    ds_read_b128 v[92:95], v27 offset:7168
    s_nop 0
    v_pk_mul_f32 v[60:61], v[60:61], v[52:53]
    v_pk_mul_f32 v[62:63], v[62:63], v[52:53]
    v_pk_mul_f32 v[68:69], v[68:69], v[52:53]
    v_pk_mul_f32 v[70:71], v[70:71], v[52:53]
    v_cvt_pk_bf16_f32 v72, v60, v61
    v_cvt_pk_bf16_f32 v73, v62, v63
    v_cvt_pk_bf16_f32 v74, v68, v69
    v_cvt_pk_bf16_f32 v75, v70, v71
    v_bfi_b32 v72, 1, s18, v72
    s_mov_b64 exec, s[56:57]
    buffer_store_dwordx4 v[72:75], v17, s[8:11], s49 offen
    s_mov_b64 exec, -1
    s_barrier
    s_branch rec_loop_35
rec_lasto2_59:
    buffer_load_dwordx2 v[126:127], v30, s[8:11], s25 offen offset:1024 sc1
    s_sub_u32 s45, s45, 1
    s_cselect_b64 s[28:29], 0, s[28:29]
rec_lasto_52:
    s_waitcnt vmcnt(0)
    v_mfma_f32_16x16x32_bf16 v[72:75], v[12:15], v[124:127], 0
    v_xor_b32 v29, s17, v126
    v_and_b32 v29, 1, v29
    v_cmp_ne_u32 vcc, 0, v29
    s_and_b64 vcc, vcc, s[28:29]
    s_cbranch_scc1 rec_lasto2_59
    s_add_u32 s53, s53, 131072
    s_nop 1
    v_cvt_pk_bf16_f32 v108, v72, v73
    v_cvt_pk_bf16_f32 v109, v74, v75
    buffer_store_dwordx2 v[108:109], v30, s[8:11], s53 offen sc1
    s_branch rec_last_37
nonown_38:
    s_waitcnt vmcnt(4)
    v_xor_b32 v29, s16, v48
    v_mfma_f32_16x16x32_bf16 v[112:115], v[48:51], v[4:7], 0
    v_mfma_f32_16x16x32_bf16 v[116:119], v[52:55], v[4:7], 0
    v_bitop3_b32 v29, v29, v52, s16 bitop3:0xf6
    v_mfma_f32_16x16x32_bf16 v[120:123], v[56:59], v[4:7], 0
    v_bitop3_b32 v29, v29, v56, s16 bitop3:0xf6
    v_mfma_f32_16x16x32_bf16 v[124:127], v[60:63], v[4:7], 0
    v_bitop3_b32 v29, v29, v60, s16 bitop3:0xf6
    s_waitcnt vmcnt(3)
    v_mfma_f32_16x16x32_bf16 v[112:115], v[64:67], v[4:7], v[112:115]
    v_bitop3_b32 v29, v29, v64, s16 bitop3:0xf6
    s_waitcnt vmcnt(2)
    v_mfma_f32_16x16x32_bf16 v[116:119], v[68:71], v[4:7], v[116:119]
    v_bitop3_b32 v29, v29, v68, s16 bitop3:0xf6
    s_waitcnt vmcnt(1)
    v_mfma_f32_16x16x32_bf16 v[120:123], v[72:75], v[4:7], v[120:123]
    v_bitop3_b32 v29, v29, v72, s16 bitop3:0xf6
    s_waitcnt vmcnt(0)
    v_mfma_f32_16x16x32_bf16 v[124:127], v[76:79], v[4:7], v[124:127]
    v_bitop3_b32 v29, v29, v76, s16 bitop3:0xf6
    v_and_b32 v29, s19, v29
    v_cmp_ne_u32 vcc, 0, v29
    s_and_b64 vcc, vcc, s[28:29]
    s_cbranch_scc1 xslow_60
xok_61:
    v_cvt_pk_bf16_f32 v72, v112, v113
    v_cvt_pk_bf16_f32 v73, v114, v115
    v_cvt_pk_bf16_f32 v74, v116, v117
    v_cvt_pk_bf16_f32 v75, v118, v119
    ds_write_b128 v26, v[72:75]
    v_cvt_pk_bf16_f32 v76, v120, v121
    v_cvt_pk_bf16_f32 v77, v122, v123
    v_cvt_pk_bf16_f32 v78, v124, v125
    v_cvt_pk_bf16_f32 v79, v126, v127
    ds_write_b128 v26, v[76:79] offset:1024
    v_mov_b32 v29, s44
    v_smfmac_f32_16x16x64_bf16 v[80:83], v[72:75], a[0:7], v1
    v_smfmac_f32_16x16x64_bf16 v[84:87], v[72:75], a[64:71], v1
    v_smfmac_f32_16x16x64_bf16 v[88:91], v[72:75], a[128:135], v1
    v_smfmac_f32_16x16x64_bf16 v[92:95], v[72:75], a[192:199], v1
    s_waitcnt vmcnt(0) lgkmcnt(0)
    s_barrier
    ds_read_b128 v[48:51], v21 offset:0
    ds_read_b128 v[52:55], v21 offset:1024
    ds_read_b128 v[56:59], v22 offset:0
    ds_read_b128 v[60:63], v22 offset:1024
    ds_read_b128 v[64:67], v23 offset:0
    ds_read_b128 v[68:71], v23 offset:1024
    v_smfmac_f32_16x16x64_bf16 v[80:83], v[76:79], a[8:15], v1
    v_smfmac_f32_16x16x64_bf16 v[84:87], v[76:79], a[72:79], v1
    s_mov_b64 exec, s[36:37]
    buffer_store_dwordx4 v[104:107], v2, s[8:11], s53 offen sc1
    s_mov_b64 exec, -1
    v_smfmac_f32_16x16x64_bf16 v[88:91], v[76:79], a[136:143], v1
    v_smfmac_f32_16x16x64_bf16 v[92:95], v[76:79], a[200:207], v1
    s_waitcnt lgkmcnt(5)
    v_smfmac_f32_16x16x64_bf16 v[80:83], v[48:51], a[16:23], v1
    v_smfmac_f32_16x16x64_bf16 v[84:87], v[48:51], a[80:87], v1
    buffer_load_dwordx4 v[32:35], v18, s[8:11], s52 offen offset:0
    s_waitcnt lgkmcnt(4)
    v_smfmac_f32_16x16x64_bf16 v[80:83], v[52:55], a[24:31], v1
    v_smfmac_f32_16x16x64_bf16 v[84:87], v[52:55], a[88:95], v1
    s_waitcnt lgkmcnt(3)
    v_smfmac_f32_16x16x64_bf16 v[80:83], v[56:59], a[32:39], v1
    buffer_load_dwordx4 v[36:39], v18, s[8:11], s52 offen offset:64
    v_smfmac_f32_16x16x64_bf16 v[84:87], v[56:59], a[96:103], v1
    s_waitcnt lgkmcnt(2)
    v_smfmac_f32_16x16x64_bf16 v[80:83], v[60:63], a[40:47], v1
    v_smfmac_f32_16x16x64_bf16 v[84:87], v[60:63], a[104:111], v1
    s_waitcnt lgkmcnt(1)
    v_smfmac_f32_16x16x64_bf16 v[80:83], v[64:67], a[48:55], v1
    v_smfmac_f32_16x16x64_bf16 v[84:87], v[64:67], a[112:119], v1
    s_mov_b64 exec, s[38:39]
    buffer_store_dword v29, off, s[8:11], s33 sc1
    s_mov_b64 exec, s[34:35]
    buffer_load_dword v31, off, s[8:11], s32 sc1
    s_mov_b64 exec, -1
    s_waitcnt lgkmcnt(0)
    v_smfmac_f32_16x16x64_bf16 v[80:83], v[68:71], a[56:63], v1
    v_smfmac_f32_16x16x64_bf16 v[84:87], v[68:71], a[120:127], v1
    v_smfmac_f32_16x16x64_bf16 v[88:91], v[48:51], a[144:151], v1
    ds_read_b128 v[112:115], v25 offset:0
    v_smfmac_f32_16x16x64_bf16 v[92:95], v[48:51], a[208:215], v1
    ds_read_b128 v[116:119], v25 offset:1024
    v_smfmac_f32_16x16x64_bf16 v[88:91], v[52:55], a[152:159], v1
    ds_read_b128 v[120:123], v25 offset:2048
    v_smfmac_f32_16x16x64_bf16 v[92:95], v[52:55], a[216:223], v1
    ds_read_b128 v[124:127], v25 offset:3072
    v_smfmac_f32_16x16x64_bf16 v[88:91], v[56:59], a[160:167], v1
    v_permlane32_swap_b32 v80, v84
    v_smfmac_f32_16x16x64_bf16 v[92:95], v[56:59], a[224:231], v1
    v_permlane32_swap_b32 v81, v85
    v_smfmac_f32_16x16x64_bf16 v[88:91], v[60:63], a[168:175], v1
    v_permlane32_swap_b32 v82, v86
    v_smfmac_f32_16x16x64_bf16 v[92:95], v[60:63], a[232:239], v1
    v_permlane32_swap_b32 v83, v87
    v_smfmac_f32_16x16x64_bf16 v[88:91], v[64:67], a[176:183], v1
    v_pk_add_f32 v[80:81], v[80:81], v[84:85]
    v_smfmac_f32_16x16x64_bf16 v[92:95], v[64:67], a[240:247], v1
    v_pk_add_f32 v[82:83], v[82:83], v[86:87]
    v_smfmac_f32_16x16x64_bf16 v[88:91], v[68:71], a[184:191], v1
    v_cvt_pk_bf16_f32 v104, v80, v81
    v_smfmac_f32_16x16x64_bf16 v[92:95], v[68:71], a[248:255], v1
    v_cvt_pk_bf16_f32 v105, v82, v83
    v_bfi_b32 v104, 1, s17, v104
    buffer_store_dwordx2 v[104:105], v30, s[8:11], s23 offen
    s_waitcnt lgkmcnt(0)
    v_smfmac_f32_16x16x64_bf16 v[96:99], v[72:75], v[112:119], v1
    ds_read_b128 v[80:83], v25 offset:4096
    v_smfmac_f32_16x16x64_bf16 v[100:103], v[72:75], v[120:127], v1
    ds_read_b128 v[84:87], v25 offset:5120
    v_permlane32_swap_b32 v88, v92
    v_permlane32_swap_b32 v89, v93
    v_permlane32_swap_b32 v90, v94
    v_permlane32_swap_b32 v91, v95
    v_pk_add_f32 v[88:89], v[88:89], v[92:93]
    v_pk_add_f32 v[90:91], v[90:91], v[94:95]
    v_cvt_pk_bf16_f32 v108, v88, v89
    v_cvt_pk_bf16_f32 v109, v90, v91
    v_bfi_b32 v108, 1, s17, v108
    buffer_store_dwordx2 v[108:109], v30, s[8:11], s23 offen offset:512
    ds_read_b128 v[88:91], v25 offset:6144
    ds_read_b128 v[92:95], v25 offset:7168
    ds_read_b128 v[112:115], v25 offset:8192
    ds_read_b128 v[116:119], v25 offset:9216
    ds_read_b128 v[120:123], v25 offset:10240
    ds_read_b128 v[124:127], v25 offset:11264
    v_smfmac_f32_16x16x64_bf16 v[96:99], v[76:79], v[128:135], v1
    v_smfmac_f32_16x16x64_bf16 v[100:103], v[76:79], v[136:143], v1
    s_waitcnt lgkmcnt(4)
    v_smfmac_f32_16x16x64_bf16 v[96:99], v[48:51], v[80:87], v1
    v_smfmac_f32_16x16x64_bf16 v[100:103], v[48:51], v[88:95], v1
    ds_read_b128 v[80:83], v25 offset:12288
    ds_read_b128 v[84:87], v25 offset:13312
    ds_read_b128 v[88:91], v25 offset:14336
    ds_read_b128 v[92:95], v25 offset:15360
    v_smfmac_f32_16x16x64_bf16 v[96:99], v[52:55], v[144:151], v1
    v_smfmac_f32_16x16x64_bf16 v[100:103], v[52:55], v[152:159], v1
    v_mov_b32 v72, v104
    v_mov_b32 v73, v105
    v_mov_b32 v76, v108
    v_mov_b32 v77, v109
    s_waitcnt lgkmcnt(4)
    v_smfmac_f32_16x16x64_bf16 v[96:99], v[56:59], v[112:119], v1
    v_smfmac_f32_16x16x64_bf16 v[100:103], v[56:59], v[120:127], v1
    v_mov_b32 v48, v104
    v_mov_b32 v49, v105
    v_mov_b32 v52, v108
    v_mov_b32 v53, v109
    ds_read_b128 v[112:115], v27 offset:0
    ds_read_b128 v[116:119], v27 offset:1024
    ds_read_b128 v[120:123], v27 offset:2048
    ds_read_b128 v[124:127], v27 offset:3072
    v_smfmac_f32_16x16x64_bf16 v[96:99], v[60:63], v[160:167], v1
    v_smfmac_f32_16x16x64_bf16 v[100:103], v[60:63], v[168:175], v1
    buffer_load_dwordx2 v[74:75], v30, s[8:11], s25 offen offset:0 sc1
    buffer_load_dwordx2 v[78:79], v30, s[8:11], s25 offen offset:512 sc1
    s_waitcnt lgkmcnt(4)
    v_smfmac_f32_16x16x64_bf16 v[96:99], v[64:67], v[80:87], v1
    v_smfmac_f32_16x16x64_bf16 v[100:103], v[64:67], v[88:95], v1
    s_waitcnt lgkmcnt(0)
    v_smfmac_f32_16x16x64_bf16 v[96:99], v[68:71], v[112:119], v1
    v_smfmac_f32_16x16x64_bf16 v[100:103], v[68:71], v[120:127], v1
    buffer_load_dwordx2 v[50:51], v30, s[8:11], s25 offen offset:0 sc1
    buffer_load_dwordx2 v[54:55], v30, s[8:11], s25 offen offset:512 sc1
    s_nop 5
    v_permlane32_swap_b32 v96, v100
    v_permlane32_swap_b32 v97, v101
    v_permlane32_swap_b32 v98, v102
    v_permlane32_swap_b32 v99, v103
    v_pk_add_f32 v[96:97], v[96:97], v[100:101]
    v_pk_add_f32 v[98:99], v[98:99], v[102:103]
    v_cvt_pk_bf16_f32 v124, v96, v97
    v_cvt_pk_bf16_f32 v125, v98, v99
    v_bfi_b32 v124, 1, s17, v124
    buffer_store_dwordx2 v[124:125], v30, s[8:11], s23 offen offset:1024
    s_waitcnt vmcnt(3)
    v_mfma_f32_16x16x32_bf16 v[56:59], v[72:75], v[8:11], 0
    v_mfma_f32_16x16x32_bf16 v[60:63], v[76:79], v[8:11], 0
    v_xor_b32 v29, s17, v74
    v_bitop3_b32 v29, v29, v78, s17 bitop3:0xf6
    v_and_b32 v29, 1, v29
    v_cmp_ne_u32 vcc, 0, v29
    s_and_b64 vcc, vcc, s[28:29]
    s_cbranch_scc1 bpoll_62
bok_63:
    s_nop 0
    v_cvt_pk_bf16_f32 v104, v56, v57
    v_cvt_pk_bf16_f32 v105, v58, v59
    v_cvt_pk_bf16_f32 v106, v60, v61
    v_cvt_pk_bf16_f32 v107, v62, v63
    s_nop 0
    s_nop 0
    v_mfma_f32_16x16x32_bf16 v[64:67], v[32:35], v[104:107], 0
    s_nop 0
    v_mfma_f32_16x16x32_bf16 v[68:71], v[36:39], v[104:107], 0
    s_nop 0
    v_mfma_f32_16x16x32_bf16 v[56:59], v[104:107], v[104:107], 0
    s_nop 0
    s_nop 0
    s_nop 0
    s_mov_b64 exec, s[56:57]
    ds_write_b128 v19, v[64:67]
    s_nop 0
    ds_write_b128 v19, v[68:71] offset:512
    s_nop 0
    ds_write_b128 v24, v[56:59]
    s_mov_b64 exec, -1
    s_nop 0
    s_waitcnt lgkmcnt(0)
    s_barrier
    ds_read_b128 v[80:83], v27 offset:4096
    ds_read_b128 v[84:87], v27 offset:5120
    ds_read_b128 v[88:91], v27 offset:6144
    ds_read_b128 v[92:95], v27 offset:7168
    s_cmp_eq_u32 s44, 63
    s_cbranch_scc1 rec_lastn_64
    s_and_b32 s21, s44, 7
    s_cmp_lg_u32 s21, 7
    s_cbranch_scc1 nokvw_65
    v_readfirstlane_b32 s21, v31
    s_cmp_ge_u32 s21, 128
    s_cbranch_scc1 kvok_67
kvw_66:
    buffer_load_dword v29, off, s[8:11], s32 sc1
    s_sub_u32 s45, s45, 1
    s_cselect_b64 s[28:29], 0, s[28:29]
    s_waitcnt vmcnt(0)
    v_readfirstlane_b32 s21, v29
    s_orn2_b32 s21, s21, s28
    s_cmp_ge_u32 s21, 128
    s_cbranch_scc1 kvok_67
    s_sleep 6
    s_branch kvw_66
kvok_67:
    s_add_u32 s32, s32, 128
nokvw_65:
    s_barrier
    s_branch rec_loop_35
nduty_44:
    s_barrier
    s_branch rec_x2_45
rec_lastn_64:
    s_add_u32 s53, s53, 131072
    s_mov_b64 exec, s[36:37]
    buffer_store_dwordx4 v[104:107], v2, s[8:11], s53 offen sc1
    s_mov_b64 exec, -1
rec_last_37:
    v_lshrrev_b32 v0, 4, v2
    s_lshl_b32 s21, s3, 6
    v_add_u32 v0, s21, v0
    s_branch ub_recdone
bpoll_50:
    buffer_load_dwordx2 v[74:75], v30, s[8:11], s25 offen offset:0 sc1
    buffer_load_dwordx2 v[78:79], v30, s[8:11], s25 offen offset:512 sc1
    s_sub_u32 s45, s45, 1
    s_cselect_b64 s[28:29], 0, s[28:29]
    s_waitcnt vmcnt(2)
    v_mfma_f32_16x16x32_bf16 v[56:59], v[48:51], v[8:11], 0
    v_mfma_f32_16x16x32_bf16 v[60:63], v[52:55], v[8:11], 0
    v_xor_b32 v29, s17, v50
    v_bitop3_b32 v29, v29, v54, s17 bitop3:0xf6
    v_and_b32 v29, 1, v29
    v_cmp_ne_u32 vcc, 0, v29
    s_and_b64 vcc, vcc, s[28:29]
    s_cbranch_scc0 bok_51
    buffer_load_dwordx2 v[50:51], v30, s[8:11], s25 offen offset:0 sc1
    buffer_load_dwordx2 v[54:55], v30, s[8:11], s25 offen offset:512 sc1
    s_sub_u32 s45, s45, 1
    s_cselect_b64 s[28:29], 0, s[28:29]
    s_waitcnt vmcnt(2)
    v_mfma_f32_16x16x32_bf16 v[56:59], v[72:75], v[8:11], 0
    v_mfma_f32_16x16x32_bf16 v[60:63], v[76:79], v[8:11], 0
    v_xor_b32 v29, s17, v74
    v_bitop3_b32 v29, v29, v78, s17 bitop3:0xf6
    v_and_b32 v29, 1, v29
    v_cmp_ne_u32 vcc, 0, v29
    s_and_b64 vcc, vcc, s[28:29]
    s_cbranch_scc0 bok_51
    s_branch bpoll_50
bpoll_62:
    buffer_load_dwordx2 v[74:75], v30, s[8:11], s25 offen offset:0 sc1
    buffer_load_dwordx2 v[78:79], v30, s[8:11], s25 offen offset:512 sc1
    s_sub_u32 s45, s45, 1
    s_cselect_b64 s[28:29], 0, s[28:29]
    s_waitcnt vmcnt(2)
    v_mfma_f32_16x16x32_bf16 v[56:59], v[48:51], v[8:11], 0
    v_mfma_f32_16x16x32_bf16 v[60:63], v[52:55], v[8:11], 0
    v_xor_b32 v29, s17, v50
    v_bitop3_b32 v29, v29, v54, s17 bitop3:0xf6
    v_and_b32 v29, 1, v29
    v_cmp_ne_u32 vcc, 0, v29
    s_and_b64 vcc, vcc, s[28:29]
    s_cbranch_scc0 bok_63
    buffer_load_dwordx2 v[50:51], v30, s[8:11], s25 offen offset:0 sc1
    buffer_load_dwordx2 v[54:55], v30, s[8:11], s25 offen offset:512 sc1
    s_sub_u32 s45, s45, 1
    s_cselect_b64 s[28:29], 0, s[28:29]
    s_waitcnt vmcnt(2)
    v_mfma_f32_16x16x32_bf16 v[56:59], v[72:75], v[8:11], 0
    v_mfma_f32_16x16x32_bf16 v[60:63], v[76:79], v[8:11], 0
    v_xor_b32 v29, s17, v74
    v_bitop3_b32 v29, v29, v78, s17 bitop3:0xf6
    v_and_b32 v29, 1, v29
    v_cmp_ne_u32 vcc, 0, v29
    s_and_b64 vcc, vcc, s[28:29]
    s_cbranch_scc0 bok_63
    s_branch bpoll_62
vpoll_53:
    buffer_load_dwordx2 v[126:127], v30, s[8:11], s25 offen offset:1024 sc1
    s_waitcnt vmcnt(0)
    v_mfma_f32_16x16x32_bf16 v[72:75], v[12:15], v[124:127], 0
    v_xor_b32 v29, s17, v126
    v_and_b32 v29, 1, v29
    s_nop 5
    s_cmp_eq_u32 s44, 63
    s_branch vpoll2_54
smax_55:
    v_max3_f32 v53, v48, v49, v50
    v_max3_f32 v53, v53, v51, v52
    s_nop 0
    s_nop 0
    v_max_f32_dpp v53, v53, v53 row_ror:8 row_mask:0xf bank_mask:0xf
    v_mov_b32 v54, v53
    s_nop 0
    s_nop 0
    v_permlane16_swap_b32 v54, v53
    v_max_f32 v53, v53, v54
    v_mov_b32 v54, v53
    s_nop 0
    s_nop 0
    v_permlane32_swap_b32 v54, v53
    v_max_f32 v53, v53, v54
    v_mul_f32 v53, s55, v53
    v_fma_f32 v48, v48, s55, -v53
    v_fma_f32 v49, v49, s55, -v53
    v_fma_f32 v50, v50, s55, -v53
    v_fma_f32 v51, v51, s55, -v53
    v_fma_f32 v52, v52, s55, -v53
    s_branch smaxb_56
xslow_48:
xpoll_68:
    s_mov_b64 exec, vcc
    buffer_load_dwordx4 v[48:51], v16, s[8:11], s26 offen offset:0 sc1
    buffer_load_dwordx4 v[52:55], v16, s[8:11], s26 offen offset:256 sc1
    buffer_load_dwordx4 v[56:59], v16, s[8:11], s26 offen offset:2048 sc1
    buffer_load_dwordx4 v[60:63], v16, s[8:11], s26 offen offset:2304 sc1
    buffer_load_dwordx4 v[64:67], v16, s[8:11], s24 offen offset:0 sc1
    buffer_load_dwordx4 v[68:71], v16, s[8:11], s24 offen offset:256 sc1
    buffer_load_dwordx4 v[72:75], v16, s[8:11], s24 offen offset:2048 sc1
    buffer_load_dwordx4 v[76:79], v16, s[8:11], s24 offen offset:2304 sc1
    s_mov_b64 exec, -1
    s_sub_u32 s45, s45, 1
    s_cselect_b64 s[28:29], 0, s[28:29]
    s_waitcnt vmcnt(4)
    v_xor_b32 v29, s16, v48
    v_mfma_f32_16x16x32_bf16 v[112:115], v[48:51], v[4:7], 0
    v_mfma_f32_16x16x32_bf16 v[116:119], v[52:55], v[4:7], 0
    v_bitop3_b32 v29, v29, v52, s16 bitop3:0xf6
    v_mfma_f32_16x16x32_bf16 v[120:123], v[56:59], v[4:7], 0
    v_bitop3_b32 v29, v29, v56, s16 bitop3:0xf6
    v_mfma_f32_16x16x32_bf16 v[124:127], v[60:63], v[4:7], 0
    v_bitop3_b32 v29, v29, v60, s16 bitop3:0xf6
    s_waitcnt vmcnt(3)
    v_mfma_f32_16x16x32_bf16 v[112:115], v[64:67], v[4:7], v[112:115]
    v_bitop3_b32 v29, v29, v64, s16 bitop3:0xf6
    s_waitcnt vmcnt(2)
    v_mfma_f32_16x16x32_bf16 v[116:119], v[68:71], v[4:7], v[116:119]
    v_bitop3_b32 v29, v29, v68, s16 bitop3:0xf6
    s_waitcnt vmcnt(1)
    v_mfma_f32_16x16x32_bf16 v[120:123], v[72:75], v[4:7], v[120:123]
    v_bitop3_b32 v29, v29, v72, s16 bitop3:0xf6
    s_waitcnt vmcnt(0)
    v_mfma_f32_16x16x32_bf16 v[124:127], v[76:79], v[4:7], v[124:127]
    v_bitop3_b32 v29, v29, v76, s16 bitop3:0xf6
    v_and_b32 v29, s19, v29
    v_cmp_ne_u32 vcc, 0, v29
    s_and_b64 vcc, vcc, s[28:29]
    s_cbranch_scc0 xok_49
    s_branch xpoll_68
xslow_60:
xpoll_69:
    s_mov_b64 exec, vcc
    buffer_load_dwordx4 v[48:51], v16, s[8:11], s26 offen offset:0 sc1
    buffer_load_dwordx4 v[52:55], v16, s[8:11], s26 offen offset:256 sc1
    buffer_load_dwordx4 v[56:59], v16, s[8:11], s26 offen offset:2048 sc1
    buffer_load_dwordx4 v[60:63], v16, s[8:11], s26 offen offset:2304 sc1
    buffer_load_dwordx4 v[64:67], v16, s[8:11], s24 offen offset:0 sc1
    buffer_load_dwordx4 v[68:71], v16, s[8:11], s24 offen offset:256 sc1
    buffer_load_dwordx4 v[72:75], v16, s[8:11], s24 offen offset:2048 sc1
    buffer_load_dwordx4 v[76:79], v16, s[8:11], s24 offen offset:2304 sc1
    s_mov_b64 exec, -1
    s_sub_u32 s45, s45, 1
    s_cselect_b64 s[28:29], 0, s[28:29]
    s_waitcnt vmcnt(4)
    v_xor_b32 v29, s16, v48
    v_mfma_f32_16x16x32_bf16 v[112:115], v[48:51], v[4:7], 0
    v_mfma_f32_16x16x32_bf16 v[116:119], v[52:55], v[4:7], 0
    v_bitop3_b32 v29, v29, v52, s16 bitop3:0xf6
    v_mfma_f32_16x16x32_bf16 v[120:123], v[56:59], v[4:7], 0
    v_bitop3_b32 v29, v29, v56, s16 bitop3:0xf6
    v_mfma_f32_16x16x32_bf16 v[124:127], v[60:63], v[4:7], 0
    v_bitop3_b32 v29, v29, v60, s16 bitop3:0xf6
    s_waitcnt vmcnt(3)
    v_mfma_f32_16x16x32_bf16 v[112:115], v[64:67], v[4:7], v[112:115]
    v_bitop3_b32 v29, v29, v64, s16 bitop3:0xf6
    s_waitcnt vmcnt(2)
    v_mfma_f32_16x16x32_bf16 v[116:119], v[68:71], v[4:7], v[116:119]
    v_bitop3_b32 v29, v29, v68, s16 bitop3:0xf6
    s_waitcnt vmcnt(1)
    v_mfma_f32_16x16x32_bf16 v[120:123], v[72:75], v[4:7], v[120:123]
    v_bitop3_b32 v29, v29, v72, s16 bitop3:0xf6
    s_waitcnt vmcnt(0)
    v_mfma_f32_16x16x32_bf16 v[124:127], v[76:79], v[4:7], v[124:127]
    v_bitop3_b32 v29, v29, v76, s16 bitop3:0xf6
    v_and_b32 v29, s19, v29
    v_cmp_ne_u32 vcc, 0, v29
    s_and_b64 vcc, vcc, s[28:29]
    s_cbranch_scc0 xok_61
    s_branch xpoll_69
ookb_41:
    s_mov_b64 exec, -1
    s_waitcnt lgkmcnt(0)
    v_smfmac_f32_16x16x64_bf16 v[64:67], v[56:59], v[240:247], v1
    v_smfmac_f32_16x16x64_bf16 v[68:71], v[56:59], v[248:255], v1
    v_smfmac_f32_16x16x64_bf16 v[64:67], v[60:63], v[112:119], v1
    v_smfmac_f32_16x16x64_bf16 v[68:71], v[60:63], v[120:127], v1
    v_smfmac_f32_16x16x64_bf16 v[72:75], v[56:59], v[80:87], v1
    v_smfmac_f32_16x16x64_bf16 v[76:79], v[56:59], v[88:95], v1
    s_waitcnt vmcnt(0)
    v_smfmac_f32_16x16x64_bf16 v[64:67], v[48:51], v[176:183], v1
    v_smfmac_f32_16x16x64_bf16 v[68:71], v[48:51], v[184:191], v1
    v_smfmac_f32_16x16x64_bf16 v[64:67], v[52:55], v[208:215], v1
    v_smfmac_f32_16x16x64_bf16 v[68:71], v[52:55], v[216:223], v1
    v_smfmac_f32_16x16x64_bf16 v[72:75], v[60:63], v[32:39], v1
    v_xor_b32 v29, s18, v48
    v_smfmac_f32_16x16x64_bf16 v[76:79], v[60:63], v[40:47], v1
    v_bitop3_b32 v29, v29, v52, s18 bitop3:0xf6
    v_smfmac_f32_16x16x64_bf16 v[72:75], v[48:51], v[192:199], v1
    v_and_b32 v29, 1, v29
    v_smfmac_f32_16x16x64_bf16 v[76:79], v[48:51], v[200:207], v1
    v_cmp_ne_u32 vcc, 0, v29
    v_smfmac_f32_16x16x64_bf16 v[72:75], v[52:55], v[224:231], v1
    v_permlane32_swap_b32 v64, v68
    v_smfmac_f32_16x16x64_bf16 v[76:79], v[52:55], v[232:239], v1
    v_permlane32_swap_b32 v65, v69
    s_branch ofin_42
oslow_40:
    buffer_load_dwordx4 v[56:59], v2, s[8:11], s50 offen offset:2048 sc1
    buffer_load_dwordx4 v[60:63], v2, s[8:11], s50 offen offset:3072 sc1
    s_nop 5
    v_mov_b32 v64, 0
    v_mov_b32 v65, 0
    v_mov_b32 v66, 0
    v_mov_b32 v67, 0
    v_mov_b32 v68, 0
    v_mov_b32 v69, 0
    v_mov_b32 v70, 0
    v_mov_b32 v71, 0
    v_mov_b32 v72, 0
    v_mov_b32 v73, 0
    v_mov_b32 v74, 0
    v_mov_b32 v75, 0
    v_mov_b32 v76, 0
    v_mov_b32 v77, 0
    v_mov_b32 v78, 0
    v_mov_b32 v79, 0
    s_branch opoll2_43
stub_57:
    s_sub_u32 s45, s45, 1
    s_cselect_b64 s[28:29], 0, s[28:29]
    s_cmp_lg_u32 s28, 0
    s_cbranch_scc1 vpoll_53
    s_cmp_eq_u32 s44, 63
    s_branch back_58
ub_recdone:
    s_waitcnt lgkmcnt(0)
    s_mov_b32 s89, 17
    s_barrier
    s_branch ub_next
ub_done:
ub_exit:
    s_endpgm
.p2align 2
ub_table:
    .long 0xc0008
    .long 0xd0108
    .long 0xe0018
    .long 0xf0118
    .long 0x100208
    .long 0x110408
    .long 0x140218
    .long 0x150418
    .long 0x180308
    .long 0x190508
    .long 0x1a0318
    .long 0x1b0518
    .long 0x5
    .long 0x100
    .long 0x15
    .long 0x110
    .long 0x105
    .long 0x120608
    .long 0x130708
    .long 0x200
    .long 0x115
    .long 0x160618
    .long 0x170718
    .long 0x210
    .long 0x205
    .long 0x215
    .long 0x305
    .long 0x315
    .long 0x300
    .long 0x310
    .long 0x2
    .long 0x12
    .long 0x1
    .long 0x11
    .long 0x102
    .long 0x112
    .long 0x202
    .long 0x212
    .long 0x302
    .long 0x312
    .long 0x400
    .long 0x410
    .long 0x402
    .long 0x412
    .long 0x502
    .long 0x512
    .long 0x6
    .long 0x16
    .long 0x106
    .long 0x116
    .long 0x206
    .long 0x216
    .long 0x306
    .long 0x316
    .long 0x602
    .long 0x612
    .long 0x101
    .long 0x111
    .long 0x500
    .long 0x510
    .long 0x600
    .long 0x610
    .long 0x201
    .long 0x211
    .long 0x700
    .long 0x710
    .long 0x406
    .long 0x416
    .long 0x3
    .long 0x13
    .long 0x506
    .long 0x516
    .long 0x103
    .long 0x113
    .long 0x203
    .long 0x213
    .long 0x303
    .long 0x313
    .long 0x606
    .long 0x616
    .long 0x706
    .long 0x716
    .long 0x301
    .long 0x311
    .long 0x806
    .long 0x816
    .long 0x906
    .long 0x916
    .long 0xa06
    .long 0xa16
    .long 0xb06
    .long 0xb16
    .long 0x4
    .long 0x14
    .long 0x104
    .long 0x114
    .long 0x204
    .long 0x214
    .long 0x7
    .long 0x17
    .long 0x107
    .long 0x117
    .long 0xc06
    .long 0xc16
    .long 0xd06
    .long 0xd16
    .long 0x307
    .long 0x317
    .long 0xe06
    .long 0xe16
    .long 0xf06
    .long 0xf16
.section .rodata,"a"
.p2align 6
.amdhsa_kernel parallel_sum__memory_aug_recurrent_mem_tr__glu_gated_swiglu__prompt_kernel
  .amdhsa_next_free_vgpr 512
  .amdhsa_next_free_sgpr 102
  .amdhsa_accum_offset 256
  .amdhsa_group_segment_fixed_size 0
  .amdhsa_kernarg_size 112
  .amdhsa_user_sgpr_count 2
  .amdhsa_user_sgpr_kernarg_segment_ptr 1
  .amdhsa_system_sgpr_workgroup_id_x 1
  .amdhsa_float_denorm_mode_32 3
  .amdhsa_float_denorm_mode_16_64 3
.end_amdhsa_kernel
```
